```python
import torch

def _softmax(x, axis=-1):
    return torch.softmax(x, dim=axis)

def _gelu(x):
    return torch.nn.functional.gelu(x, approximate='tanh')

def _silu(x):
    return torch.nn.functional.silu(x)

def _sigmoid(x):
    return torch.sigmoid(x)

def _layernorm(x, axis=-1, eps=1e-05):
    m = x.mean(dim=axis, keepdim=True)
    v = x.var(dim=axis, keepdim=True, unbiased=False)
    return (x - m) / torch.sqrt(v + eps)

def _scatter_add(tgt, idx, src, axis=0):
    return tgt.clone().index_add_(axis, idx, src)

def _segment_sum(src, seg, n):
    out = torch.zeros((n,) + src.shape[1:], dtype=src.dtype)
    return out.index_add_(0, seg, src)

def _pad(x, pw):
    flat = tuple((v for pair in reversed(pw) for v in pair))
    return torch.nn.functional.pad(x, flat)
kernel_name = 'concat_heads__sliding_local_dilated__memory_aug_recurrent_mem_tr__prompt'

def setup_inputs():

    _w = lambda a: (lambda t: t.to(torch.bfloat16) if t.is_floating_point() else t)(torch.as_tensor(a))

    def _A_setup():
        B, S, D = (1, 2048, 512)
        return {'x': _w((lambda *s: torch.randn(*s, dtype=torch.bfloat16) * 0.2)(B, S, D)), 'wqkv': _w((lambda *s: torch.randn(*s, dtype=torch.bfloat16) * 0.2)(D, 3 * D)), 'wo': _w((lambda *s: torch.randn(*s, dtype=torch.bfloat16) * 0.05)(D, D))}
    _A_in = _A_setup()

    def _B_setup():
        B, S, Dm = (1, 2048, 512)
        H, Dh = (32, 128)
        M, seg = (8, 32)
        seg = min(seg, S)
        S = S // seg * seg
        return {'x': _w((lambda *s: torch.randn(*s, dtype=torch.bfloat16) * 0.05)(B, S, Dm)), 'mem0': _w((lambda *s: torch.randn(*s, dtype=torch.bfloat16) * 1.6)(B, M, Dm)), 'Wq': _w((lambda *s: torch.randn(*s, dtype=torch.bfloat16) * 0.8)(Dm, H, Dh) * Dm ** (-0.5)), 'Wk': _w((lambda *s: torch.randn(*s, dtype=torch.bfloat16) * 0.8)(Dm, H, Dh) * Dm ** (-0.5)), 'Wv': _w((lambda *s: torch.randn(*s, dtype=torch.bfloat16) * 1.6)(Dm, H, Dh) * Dm ** (-0.5)), 'Wo': _w((lambda *s: torch.randn(*s, dtype=torch.bfloat16) * 1.6)(H, Dh, Dm) * (H * Dh) ** (-0.5)), 'seg_len': seg}
    _B_in = _B_setup()
    return {'A_x': _A_in['x'], 'A_wqkv': _A_in['wqkv'], 'A_wo': _A_in['wo'], 'B_x': _B_in['x'], 'B_mem0': _B_in['mem0'], 'B_Wq': _B_in['Wq'], 'B_Wk': _B_in['Wk'], 'B_Wv': _B_in['Wv'], 'B_Wo': _B_in['Wo'], 'B_seg_len': _B_in['seg_len']}

def reference(A_x, A_wqkv, A_wo, B_x, B_mem0, B_Wq, B_Wk, B_Wv, B_Wo, B_seg_len):

    def _A_ref(x, wqkv, wo):
        B, S, D = x.shape
        H = 32
        Dh = D // H
        W, dil = (8, 2)
        qkv = (lambda x, *d: x.permute(*d))((x @ wqkv).reshape(B, S, 3, H, Dh), 2, 0, 3, 1, 4)
        q, k, v = (qkv[0], qkv[1], qkv[2])
        scale = Dh ** (-0.5)
        pos = torch.arange(S)
        off = torch.arange(W) * dil
        idx = pos[:, None] - off[None, :]
        mask = idx >= 0
        idx_c = torch.where(mask, idx, 0).reshape(-1)
        kg = k[:, :, idx_c, :].reshape(B, H, S, W, Dh)
        vg = v[:, :, idx_c, :].reshape(B, H, S, W, Dh)
        logits = torch.einsum('bhsd,bhswd->bhsw', q, kg) * scale
        logits = torch.where(mask[None, None, :, :], logits, -1000000000.0)
        attn = _softmax(logits, axis=-1)
        o = torch.einsum('bhsw,bhswd->bhsd', attn, vg)
        return (lambda x, *d: x.permute(*d))(o, 0, 2, 1, 3).reshape(B, S, D) @ wo

    def _B_ref(x, mem0, Wq, Wk, Wv, Wo, seg_len):
        B, S, Dm = x.shape
        H, Dh = (Wq.shape[1], Wq.shape[2])
        M = mem0.shape[1]
        scale = Dh ** (-0.5)
        n_seg = S // seg_len
        L = M + seg_len
        idx = torch.arange(L)
        mask = (idx[:, None] < M) | (idx[:, None] >= idx[None, :])
        mem = mem0
        outs = []
        for s in range(n_seg):
            xs = x[:, s * seg_len:(s + 1) * seg_len, :].clone()
            h = torch.concatenate([mem, xs], axis=1)
            q = torch.einsum('btd,dhe->bhte', h, Wq)
            k = torch.einsum('btd,dhe->bhte', h, Wk)
            v = torch.einsum('btd,dhe->bhte', h, Wv)
            scores = torch.einsum('bhqe,bhke->bhqk', q, k) * scale
            scores = torch.where(mask[None, None], scores, -1000000000.0)
            p = _softmax(scores, axis=-1)
            o = torch.einsum('bhqk,bhke->bhqe', p, v)
            o = torch.einsum('bhte,hed->btd', o, Wo)
            mem = o[:, :M, :].clone()
            outs.append(o[:, M:, :])
        return torch.concatenate(outs, axis=1)
    a = _A_ref(A_x, A_wqkv, A_wo)
    b = _B_ref(B_x, B_mem0, B_Wq, B_Wk, B_Wv, B_Wo, B_seg_len)
    return torch.concatenate([a, b], axis=-1)
```

```asm
; @launch grid=(256,1,1) block=(256,1,1) lds=163840
.amdgcn_target "amdgcn-amd-amdhsa--gfx950"
.text
.globl concat_heads__sliding_local_dilated__memory_aug_recurrent_mem_tr__prompt_kernel
.p2align 8
.type concat_heads__sliding_local_dilated__memory_aug_recurrent_mem_tr__prompt_kernel,@function
concat_heads__sliding_local_dilated__memory_aug_recurrent_mem_tr__prompt_kernel:
  s_cmp_ge_u32 s2, 256
  s_cbranch_scc1 L_end
  s_load_dwordx16 s[20:35], s[0:1], 0
  s_load_dwordx8 s[36:43], s[0:1], 64
  s_load_dwordx2 s[44:45], s[0:1], 96
  s_getreg_b32 s48, hwreg(HW_REG_XCC_ID, 0, 3)
  v_lshrrev_b32 v1, 6, v0
  s_nop 0
  v_readfirstlane_b32 s46, v1
  s_mov_b32 s49, 400000
  s_waitcnt lgkmcnt(0)
  s_xor_b32 s48, s48, 3
  s_mov_b32 s4, s44
  s_and_b32 s5, s45, 0xffff
  s_mov_b32 s6, 268435456
  s_mov_b32 s7, 0x20000
  s_mov_b32 s8, s42
  s_and_b32 s9, s43, 0xffff
  s_mov_b32 s10, 256
  s_mov_b32 s11, 0x20000
  s_lshr_b32 s50, s2, 3
  s_lshl_b32 s47, s48, 5
  s_add_u32 s47, s47, s50
  s_mov_b32 s101, 0
  s_cmp_lg_u32 s46, 0
  s_cbranch_scc1 L_dispatch
  s_lshl_b32 s51, 1, s50
  s_lshl_b32 s52, s48, 2
  v_mov_b32 v127, s51
  s_mov_b64 exec, 1
  buffer_atomic_or v127, off, s[8:11], s52 sc0
  s_mov_b64 exec, -1
  v_mov_b32 v3, 0
  v_lshlrev_b32 v4, 2, v0
  s_lshl_b32 s51, s2, 8
  s_add_u32 s51, s51, 84475904
  buffer_store_dword v3, v4, s[4:7], s51 offen sc1
L_dispatch:
  s_mov_b32 s79, s47
  s_mov_b32 s16, 0
  s_cmp_ge_u32 s47, 32
  s_cbranch_scc1 L_worker
L_chain:
  v_and_b32 v16, 63, v0
  v_lshlrev_b32 v0, 4, v16
  s_and_b32 s68, s46, 1
  s_lshr_b32 s69, s46, 1
  s_lshl_b32 s52, s68, 7
  v_xor_b32 v23, s52, v0
  s_lshl_b32 s52, s79, 17
  s_lshl_b32 s60, s68, 14
  s_add_u32 s52, s52, s60
  s_lshl_b32 s60, s69, 13
  s_add_u32 s52, s52, s60
  s_lshl_b32 s51, s79, 8
  s_lshl_b32 s60, s46, 17
  s_add_u32 s51, s51, s60
  s_lshl_b32 s60, s46, 12
  s_mov_b32 s12, s36
  s_and_b32 s13, s37, 0xffff
  s_mov_b32 s14, 4194304
  s_mov_b32 s15, 0x20000
  s_add_u32 s68, s52, 0
  s_add_u32 m0, s60, 114688
  v_xor_b32 v30, 0, v23
  buffer_load_dwordx4 v30, s[12:15], s68 offen  lds
  s_add_u32 s68, s52, 1024
  s_add_u32 m0, s60, 115712
  v_xor_b32 v30, 32, v23
  buffer_load_dwordx4 v30, s[12:15], s68 offen  lds
  s_add_u32 s68, s52, 4096
  s_add_u32 m0, s60, 116736
  v_xor_b32 v30, 64, v23
  buffer_load_dwordx4 v30, s[12:15], s68 offen  lds
  s_add_u32 s68, s52, 5120
  s_add_u32 m0, s60, 117760
  v_xor_b32 v30, 96, v23
  buffer_load_dwordx4 v30, s[12:15], s68 offen  lds
  s_add_u32 s68, s52, 2048
  s_add_u32 m0, s60, 131072
  v_xor_b32 v30, 0, v23
  buffer_load_dwordx4 v30, s[12:15], s68 offen  lds
  s_add_u32 s68, s52, 3072
  s_add_u32 m0, s60, 132096
  v_xor_b32 v30, 32, v23
  buffer_load_dwordx4 v30, s[12:15], s68 offen  lds
  s_add_u32 s68, s52, 6144
  s_add_u32 m0, s60, 133120
  v_xor_b32 v30, 64, v23
  buffer_load_dwordx4 v30, s[12:15], s68 offen  lds
  s_add_u32 s68, s52, 7168
  s_add_u32 m0, s60, 134144
  v_xor_b32 v30, 96, v23
  buffer_load_dwordx4 v30, s[12:15], s68 offen  lds
  s_add_u32 s68, s52, 32768
  s_add_u32 m0, s60, 147456
  v_xor_b32 v30, 0, v23
  buffer_load_dwordx4 v30, s[12:15], s68 offen  lds
  s_add_u32 s68, s52, 33792
  s_add_u32 m0, s60, 148480
  v_xor_b32 v30, 32, v23
  buffer_load_dwordx4 v30, s[12:15], s68 offen  lds
  s_add_u32 s68, s52, 36864
  s_add_u32 m0, s60, 149504
  v_xor_b32 v30, 64, v23
  buffer_load_dwordx4 v30, s[12:15], s68 offen  lds
  s_add_u32 s68, s52, 37888
  s_add_u32 m0, s60, 150528
  v_xor_b32 v30, 96, v23
  buffer_load_dwordx4 v30, s[12:15], s68 offen  lds
  s_add_u32 s68, s52, 34816
  s_add_u32 m0, s60, 0
  v_xor_b32 v30, 0, v23
  buffer_load_dwordx4 v30, s[12:15], s68 offen  lds
  s_add_u32 s68, s52, 35840
  s_add_u32 m0, s60, 1024
  v_xor_b32 v30, 32, v23
  buffer_load_dwordx4 v30, s[12:15], s68 offen  lds
  s_add_u32 s68, s52, 38912
  s_add_u32 m0, s60, 2048
  v_xor_b32 v30, 64, v23
  buffer_load_dwordx4 v30, s[12:15], s68 offen  lds
  s_add_u32 s68, s52, 39936
  s_add_u32 m0, s60, 3072
  v_xor_b32 v30, 96, v23
  buffer_load_dwordx4 v30, s[12:15], s68 offen  lds
  s_add_u32 s68, s52, 65536
  s_add_u32 m0, s60, 65536
  v_xor_b32 v30, 0, v23
  buffer_load_dwordx4 v30, s[12:15], s68 offen  lds
  s_add_u32 s68, s52, 66560
  s_add_u32 m0, s60, 66560
  v_xor_b32 v30, 32, v23
  buffer_load_dwordx4 v30, s[12:15], s68 offen  lds
  s_add_u32 s68, s52, 69632
  s_add_u32 m0, s60, 67584
  v_xor_b32 v30, 64, v23
  buffer_load_dwordx4 v30, s[12:15], s68 offen  lds
  s_add_u32 s68, s52, 70656
  s_add_u32 m0, s60, 68608
  v_xor_b32 v30, 96, v23
  buffer_load_dwordx4 v30, s[12:15], s68 offen  lds
  s_add_u32 s68, s52, 67584
  s_add_u32 m0, s60, 81920
  v_xor_b32 v30, 0, v23
  buffer_load_dwordx4 v30, s[12:15], s68 offen  lds
  s_add_u32 s68, s52, 68608
  s_add_u32 m0, s60, 82944
  v_xor_b32 v30, 32, v23
  buffer_load_dwordx4 v30, s[12:15], s68 offen  lds
  s_add_u32 s68, s52, 71680
  s_add_u32 m0, s60, 83968
  v_xor_b32 v30, 64, v23
  buffer_load_dwordx4 v30, s[12:15], s68 offen  lds
  s_add_u32 s68, s52, 72704
  s_add_u32 m0, s60, 84992
  v_xor_b32 v30, 96, v23
  buffer_load_dwordx4 v30, s[12:15], s68 offen  lds
  v_lshrrev_b32 v28, 4, v16
  v_and_b32 v29, 15, v16
  s_lshl_b32 s68, s46, 10
  v_add_u32 v9, s68, v0
  v_lshlrev_b32 v19, 2, v16
  v_lshrrev_b32 v30, 2, v16
  v_lshlrev_b32 v30, 12, v30
  v_and_b32 v31, 3, v16
  v_lshl_add_u32 v1, v31, 4, v30
  v_and_b32 v30, 1, v16
  v_lshlrev_b32 v30, 5, v30
  v_lshl_add_u32 v30, v28, 3, v30
  v_and_b32 v31, 4, v16
  v_add_u32 v30, v30, v31
  v_and_b32 v31, 8, v16
  v_cmp_ne_u32 s[18:19], 0, v31
  v_lshl_add_u32 v30, v31, 11, v30
  v_and_b32 v31, 2, v16
  v_lshl_add_u32 v2, v31, 29, v30
  s_mov_b32 s84, s28
  s_and_b32 s85, s29, 0xffff
  s_mov_b32 s86, 8192
  s_mov_b32 s87, 0x20000
  v_and_b32 v30, 1, v16
  v_lshlrev_b32 v15, 10, v30
  v_lshl_add_u32 v15, v28, 1, v15
  v_bfe_u32 v30, v16, 2, 1
  v_lshl_add_u32 v15, v30, 6, v15
  s_and_b32 s68, s79, 6
  s_lshl_b32 s68, s68, 10
  s_lshr_b32 s69, s79, 3
  s_lshl_b32 s69, s69, 8
  s_add_u32 s68, s68, s69
  s_and_b32 s69, s46, 1
  s_lshl_b32 s69, s69, 7
  s_add_u32 s68, s68, s69
  s_lshr_b32 s69, s46, 1
  s_lshl_b32 s69, s69, 3
  s_add_u32 s68, s68, s69
  s_and_b32 s69, s79, 1
  s_lshl_b32 s69, s69, 4
  s_add_u32 s68, s68, s69
  buffer_load_ushort v20, v15, s[84:87], s68 offen
  buffer_load_ushort v21, v15, s[84:87], s68 offen offset:32
  s_lshl_b32 s68, s46, 8
  s_add_u32 s68, s68, 8192
  v_mul_u32_u24 v30, 1088, v28
  v_lshl_add_u32 v30, v29, 3, v30
  v_add_u32 v3, s68, v30
  v_and_b32 v31, 3, v16
  v_mul_u32_u24 v30, 1088, v31
  v_lshrrev_b32 v31, 5, v16
  v_lshl_add_u32 v30, v31, 7, v30
  v_bfe_u32 v31, v16, 2, 3
  v_lshl_add_u32 v30, v31, 3, v30
  v_add_u32 v4, 8192, v30
  v_lshlrev_b32 v30, 9, v28
  v_lshl_add_u32 v30, v29, 4, v30
  v_add_u32 v5, 16384, v30
  s_lshl_b32 s68, s46, 9
  s_add_u32 s68, s68, 12544
  v_lshrrev_b32 v30, 5, v16
  v_lshlrev_b32 v30, 8, v30
  v_and_b32 v31, 16, v16
  v_add_u32 v30, v30, v31
  v_and_b32 v31, 12, v16
  v_lshl_add_u32 v30, v31, 4, v30
  v_and_b32 v31, 1, v16
  v_lshl_add_u32 v30, v31, 5, v30
  v_add_u32 v30, s68, v30
  v_and_b32 v31, 2, v16
  v_lshlrev_b32 v12, 3, v31
  v_xor_b32 v30, v30, v12
  v_lshlrev_b32 v31, 12, v31
  v_sub_u32 v6, v30, v31
  s_add_u32 s68, s60, 32768
  v_add_u32 v7, s68, v0
  v_add_u32 v8, 0x10000, v7
  v_and_b32 v30, 1, v16
  v_cmp_ne_u32 vcc, 0, v30
  v_mov_b32 v30, 0x4444
  v_mov_b32 v31, 0xeeee
  v_cndmask_b32 v10, v30, v31, vcc
  v_mov_b32 v30, 0x3f80
  v_mov_b32 v31, 0x3f800000
  v_cndmask_b32 v11, v30, v31, vcc
  v_lshrrev_b32 v30, 1, v29
  v_cmp_eq_u32 s[70:71], 0, v30
  v_cmp_eq_u32 s[72:73], 1, v30
  v_cmp_eq_u32 s[74:75], 2, v30
  v_cmp_eq_u32 s[76:77], 3, v30
  v_lshlrev_b32 v12, 13, v28
  v_lshlrev_b32 v30, 2, v28
  v_xor_b32 v30, v30, v29
  v_lshl_add_u32 v12, v30, 4, v12
  v_bfe_u32 v30, v16, 2, 1
  v_lshlrev_b32 v13, 12, v30
  v_bfe_u32 v30, v16, 5, 1
  v_lshl_add_u32 v13, v30, 10, v13
  v_bfe_u32 v30, v16, 3, 1
  v_lshl_add_u32 v13, v30, 9, v13
  v_bfe_u32 v30, v16, 4, 1
  v_lshl_add_u32 v13, v30, 8, v13
  v_and_b32 v30, 3, v16
  v_lshl_add_u32 v13, v30, 3, v13
  v_bfe_u32 v31, v13, 8, 2
  v_xor_b32 v31, s46, v31
  v_lshl_add_u32 v13, v31, 6, v13
  v_lshrrev_b32 v31, 2, v16
  v_lshlrev_b32 v14, 10, v31
  v_lshl_add_u32 v14, v30, 3, v14
  s_lshl_b32 s68, s46, 8
  v_add_u32 v14, s68, v14
  v_and_b32 v31, 7, v31
  v_lshl_add_u32 v14, v31, 5, v14
  s_lshl_b32 s68, s46, 11
  s_lshl_b32 s69, s79, 13
  s_add_u32 s63, s68, s69
  s_add_u32 s63, s63, 83886080
  s_lshl_b32 s68, s46, 16
  s_lshl_b32 s69, s79, 6
  s_add_u32 s62, s68, s69
  s_add_u32 s62, s62, 83886080
  s_lshl_b32 s68, s16, 18
  s_add_u32 s62, s62, s68
  s_add_u32 s63, s63, s68
  s_lshl_b32 s56, s16, 15
  s_add_u32 s56, s56, 84410368
  s_cmp_eq_u32 s16, 0
  s_cselect_b32 s50, 0, 0
  s_and_b32 s68, s46, 1
  s_lshl_b32 s61, s68, 12
  s_and_b32 s68, s79, 24
  s_lshl_b32 s68, s68, 7
  s_add_u32 s61, s61, s68
  s_and_b32 s68, s79, 1
  s_lshl_b32 s68, s68, 9
  s_add_u32 s61, s61, s68
  s_lshr_b32 s68, s46, 1
  s_lshl_b32 s68, s68, 8
  s_add_u32 s61, s61, s68
  s_and_b32 s68, s79, 6
  s_lshl_b32 s68, s68, 5
  s_add_u32 s61, s61, s68
  s_add_u32 s61, s61, s56
  s_mul_i32 s57, s79, 1572864
  s_lshl_b32 s68, s46, 11
  s_add_u32 s57, s57, s68
  s_add_u32 s57, s57, 8192
  s_lshl_b32 s59, s79, 18
  s_lshl_b32 s68, s46, 10
  s_add_u32 s59, s59, s68
  s_add_u32 s59, s59, 75497472
  s_lshl_b32 s64, s79, 8
  s_add_u32 s64, s64, 84475904
  s_lshl_b32 s65, s79, 7
  s_lshl_b32 s68, s46, 2
  s_add_u32 s65, s65, s68
  s_add_u32 s65, s65, 84486144
  s_mov_b32 s58, 0x3e0293ee
  s_lshl_b32 s55, s46, 11
  s_add_u32 s55, s55, 16384
  s_mul_i32 s68, s50, 24576
  s_add_u32 s57, s57, s68
  s_mov_b32 s78, 1
  s_and_b32 s68, s50, 1
  v_mov_b32 v24, s68
  v_mov_b32 v25, s68
  v_mov_b32 v26, s68
  v_mov_b32 v27, s68
  v_mov_b32 v22, -1
  s_add_u32 s69, s61, 8192
  buffer_store_dwordx4 v[24:27], v0, s[4:7], s63 offen sc1
  buffer_store_dwordx4 v[24:27], v0, s[4:7], s63 offen offset:1024 sc1
  buffer_store_dword v22, v2, s[4:7], s69 offen sc1
  s_cmp_lg_u32 s46, 0
  s_cbranch_scc1 L_cf_ch
  s_waitcnt vmcnt(29)
  v_readfirstlane_b32 s1, v127
  s_cmp_lg_u32 s101, 0
  s_cselect_b32 s1, 0, s1
  s_bitcmp1_b32 s1, s47
  s_cbranch_scc1 L_reclaim
  v_mov_b32 v127, s47
  v_mov_b32 v126, 33408
  ds_write_b32 v126, v127
  v_mov_b32 v127, 1
  s_mov_b64 exec, 1
  buffer_atomic_add v127, off, s[8:11], 0 offset:128
  s_mov_b64 exec, -1
  s_waitcnt lgkmcnt(0)
L_cf_ch:
  s_barrier
  v_mov_b32 v126, 33408
  ds_read_b32 v126, v126
  s_waitcnt lgkmcnt(0)
  v_readfirstlane_b32 s0, v126
  s_nop 0
  s_cmp_lg_u32 s0, s47
  s_cbranch_scc1 L_restart
  s_waitcnt vmcnt(25)
  s_barrier
  s_add_u32 s68, s52, 98304
  s_add_u32 m0, s60, 98304
  v_xor_b32 v30, 0, v23
  buffer_load_dwordx4 v30, s[12:15], s68 offen  lds
  s_add_u32 s68, s52, 99328
  s_add_u32 m0, s60, 99328
  v_xor_b32 v30, 32, v23
  buffer_load_dwordx4 v30, s[12:15], s68 offen  lds
  s_add_u32 s68, s52, 102400
  s_add_u32 m0, s60, 100352
  v_xor_b32 v30, 64, v23
  buffer_load_dwordx4 v30, s[12:15], s68 offen  lds
  s_add_u32 s68, s52, 103424
  s_add_u32 m0, s60, 101376
  v_xor_b32 v30, 96, v23
  buffer_load_dwordx4 v30, s[12:15], s68 offen  lds
  v_add_u32 v29, 114688, v14
  v_xor_b32 v31, 0, v29
  ds_read_b64_tr_b16 v[176:177], v31
  v_xor_b32 v31, 32, v29
  ds_read_b64_tr_b16 v[192:193], v31
  v_xor_b32 v31, 64, v29
  ds_read_b64_tr_b16 v[208:209], v31
  v_xor_b32 v31, 96, v29
  ds_read_b64_tr_b16 v[224:225], v31
  v_xor_b32 v31, 128, v29
  ds_read_b64_tr_b16 v[240:241], v31
  v_xor_b32 v31, 160, v29
  ds_read_b64_tr_b16 v[48:49], v31
  v_xor_b32 v31, 192, v29
  ds_read_b64_tr_b16 v[64:65], v31
  v_xor_b32 v31, 224, v29
  ds_read_b64_tr_b16 v[32:33], v31
  s_waitcnt vmcnt(25)
  s_waitcnt lgkmcnt(0)
  s_barrier
  s_add_u32 s68, s52, 100352
  s_add_u32 m0, s60, 114688
  v_xor_b32 v30, 0, v23
  buffer_load_dwordx4 v30, s[12:15], s68 offen  lds
  s_add_u32 s68, s52, 101376
  s_add_u32 m0, s60, 115712
  v_xor_b32 v30, 32, v23
  buffer_load_dwordx4 v30, s[12:15], s68 offen  lds
  s_add_u32 s68, s52, 104448
  s_add_u32 m0, s60, 116736
  v_xor_b32 v30, 64, v23
  buffer_load_dwordx4 v30, s[12:15], s68 offen  lds
  s_add_u32 s68, s52, 105472
  s_add_u32 m0, s60, 117760
  v_xor_b32 v30, 96, v23
  buffer_load_dwordx4 v30, s[12:15], s68 offen  lds
  v_add_u32 v29, 131072, v14
  v_xor_b32 v31, 0, v29
  ds_read_b64_tr_b16 v[178:179], v31
  v_xor_b32 v31, 32, v29
  ds_read_b64_tr_b16 v[194:195], v31
  v_xor_b32 v31, 64, v29
  ds_read_b64_tr_b16 v[210:211], v31
  v_xor_b32 v31, 96, v29
  ds_read_b64_tr_b16 v[226:227], v31
  v_xor_b32 v31, 128, v29
  ds_read_b64_tr_b16 v[242:243], v31
  v_xor_b32 v31, 160, v29
  ds_read_b64_tr_b16 v[50:51], v31
  v_xor_b32 v31, 192, v29
  ds_read_b64_tr_b16 v[66:67], v31
  v_xor_b32 v31, 224, v29
  ds_read_b64_tr_b16 v[34:35], v31
  s_waitcnt vmcnt(25)
  s_waitcnt lgkmcnt(0)
  s_barrier
  s_mov_b32 s12, s30
  s_and_b32 s13, s31, 0xffff
  s_mov_b32 s14, 4194304
  s_mov_b32 s15, 0x20000
  s_add_u32 s68, s51, 0
  s_add_u32 m0, s60, 131072
  s_nop 0
  buffer_load_dwordx4 v12, s[12:15], s68 offen  lds
  s_add_u32 s68, s51, 32768
  s_add_u32 m0, s60, 132096
  s_nop 0
  buffer_load_dwordx4 v12, s[12:15], s68 offen  lds
  s_add_u32 s68, s51, 65536
  s_add_u32 m0, s60, 133120
  s_nop 0
  buffer_load_dwordx4 v12, s[12:15], s68 offen  lds
  s_add_u32 s68, s51, 98304
  s_add_u32 m0, s60, 134144
  s_nop 0
  buffer_load_dwordx4 v12, s[12:15], s68 offen  lds
  v_add_u32 v29, 147456, v14
  v_xor_b32 v31, 0, v29
  ds_read_b64_tr_b16 v[180:181], v31
  v_xor_b32 v31, 32, v29
  ds_read_b64_tr_b16 v[196:197], v31
  v_xor_b32 v31, 64, v29
  ds_read_b64_tr_b16 v[212:213], v31
  v_xor_b32 v31, 96, v29
  ds_read_b64_tr_b16 v[228:229], v31
  v_xor_b32 v31, 128, v29
  ds_read_b64_tr_b16 v[244:245], v31
  v_xor_b32 v31, 160, v29
  ds_read_b64_tr_b16 v[52:53], v31
  v_xor_b32 v31, 192, v29
  ds_read_b64_tr_b16 v[68:69], v31
  v_xor_b32 v31, 224, v29
  ds_read_b64_tr_b16 v[36:37], v31
  s_waitcnt vmcnt(25)
  s_waitcnt lgkmcnt(0)
  s_barrier
  s_add_u32 s68, s51, 1048576
  s_add_u32 m0, s60, 147456
  s_nop 0
  buffer_load_dwordx4 v12, s[12:15], s68 offen  lds
  s_add_u32 s68, s51, 1081344
  s_add_u32 m0, s60, 148480
  s_nop 0
  buffer_load_dwordx4 v12, s[12:15], s68 offen  lds
  s_add_u32 s68, s51, 1114112
  s_add_u32 m0, s60, 149504
  s_nop 0
  buffer_load_dwordx4 v12, s[12:15], s68 offen  lds
  s_add_u32 s68, s51, 1146880
  s_add_u32 m0, s60, 150528
  s_nop 0
  buffer_load_dwordx4 v12, s[12:15], s68 offen  lds
  v_add_u32 v29, 0, v14
  v_xor_b32 v31, 0, v29
  ds_read_b64_tr_b16 v[182:183], v31
  v_xor_b32 v31, 32, v29
  ds_read_b64_tr_b16 v[198:199], v31
  v_xor_b32 v31, 64, v29
  ds_read_b64_tr_b16 v[214:215], v31
  v_xor_b32 v31, 96, v29
  ds_read_b64_tr_b16 v[230:231], v31
  v_xor_b32 v31, 128, v29
  ds_read_b64_tr_b16 v[246:247], v31
  v_xor_b32 v31, 160, v29
  ds_read_b64_tr_b16 v[54:55], v31
  v_xor_b32 v31, 192, v29
  ds_read_b64_tr_b16 v[70:71], v31
  v_xor_b32 v31, 224, v29
  ds_read_b64_tr_b16 v[38:39], v31
  s_waitcnt vmcnt(25)
  s_waitcnt lgkmcnt(0)
  s_barrier
  s_add_u32 s68, s51, 2097152
  s_add_u32 m0, s60, 0
  s_nop 0
  buffer_load_dwordx4 v12, s[12:15], s68 offen  lds
  s_add_u32 s68, s51, 2129920
  s_add_u32 m0, s60, 1024
  s_nop 0
  buffer_load_dwordx4 v12, s[12:15], s68 offen  lds
  s_add_u32 s68, s51, 2162688
  s_add_u32 m0, s60, 2048
  s_nop 0
  buffer_load_dwordx4 v12, s[12:15], s68 offen  lds
  s_add_u32 s68, s51, 2195456
  s_add_u32 m0, s60, 3072
  s_nop 0
  buffer_load_dwordx4 v12, s[12:15], s68 offen  lds
  v_add_u32 v29, 65536, v14
  v_xor_b32 v31, 0, v29
  ds_read_b64_tr_b16 v[184:185], v31
  v_xor_b32 v31, 32, v29
  ds_read_b64_tr_b16 v[200:201], v31
  v_xor_b32 v31, 64, v29
  ds_read_b64_tr_b16 v[216:217], v31
  v_xor_b32 v31, 96, v29
  ds_read_b64_tr_b16 v[232:233], v31
  v_xor_b32 v31, 128, v29
  ds_read_b64_tr_b16 v[248:249], v31
  v_xor_b32 v31, 160, v29
  ds_read_b64_tr_b16 v[56:57], v31
  v_xor_b32 v31, 192, v29
  ds_read_b64_tr_b16 v[72:73], v31
  v_xor_b32 v31, 224, v29
  ds_read_b64_tr_b16 v[40:41], v31
  s_waitcnt vmcnt(25)
  s_waitcnt lgkmcnt(0)
  s_barrier
  s_add_u32 s68, s51, 3145728
  s_add_u32 m0, s60, 65536
  s_nop 0
  buffer_load_dwordx4 v12, s[12:15], s68 offen  lds
  s_add_u32 s68, s51, 3178496
  s_add_u32 m0, s60, 66560
  s_nop 0
  buffer_load_dwordx4 v12, s[12:15], s68 offen  lds
  s_add_u32 s68, s51, 3211264
  s_add_u32 m0, s60, 67584
  s_nop 0
  buffer_load_dwordx4 v12, s[12:15], s68 offen  lds
  s_add_u32 s68, s51, 3244032
  s_add_u32 m0, s60, 68608
  s_nop 0
  buffer_load_dwordx4 v12, s[12:15], s68 offen  lds
  v_add_u32 v29, 81920, v14
  v_xor_b32 v31, 0, v29
  ds_read_b64_tr_b16 v[186:187], v31
  v_xor_b32 v31, 32, v29
  ds_read_b64_tr_b16 v[202:203], v31
  v_xor_b32 v31, 64, v29
  ds_read_b64_tr_b16 v[218:219], v31
  v_xor_b32 v31, 96, v29
  ds_read_b64_tr_b16 v[234:235], v31
  v_xor_b32 v31, 128, v29
  ds_read_b64_tr_b16 v[250:251], v31
  v_xor_b32 v31, 160, v29
  ds_read_b64_tr_b16 v[58:59], v31
  v_xor_b32 v31, 192, v29
  ds_read_b64_tr_b16 v[74:75], v31
  v_xor_b32 v31, 224, v29
  ds_read_b64_tr_b16 v[42:43], v31
  s_waitcnt vmcnt(20)
  s_waitcnt lgkmcnt(0)
  s_barrier
  v_lshl_or_b32 v20, v21, 16, v20
  v_min_u32 v20, -2, v20
  v_cndmask_b32 v20, v20, -1, s[18:19]
  s_cmp_lg_u32 s50, 0
  s_cselect_b32 s68, -1, 0
  v_or_b32 v20, s68, v20
  buffer_store_dword v20, v2, s[4:7], s61 offen sc1
  s_add_u32 s68, s51, 524288
  s_add_u32 m0, s60, 81920
  s_nop 0
  buffer_load_dwordx4 v12, s[12:15], s68 offen  lds
  s_add_u32 s68, s51, 557056
  s_add_u32 m0, s60, 82944
  s_nop 0
  buffer_load_dwordx4 v12, s[12:15], s68 offen  lds
  s_add_u32 s68, s51, 589824
  s_add_u32 m0, s60, 83968
  s_nop 0
  buffer_load_dwordx4 v12, s[12:15], s68 offen  lds
  s_add_u32 s68, s51, 622592
  s_add_u32 m0, s60, 84992
  s_nop 0
  buffer_load_dwordx4 v12, s[12:15], s68 offen  lds
  v_add_u32 v29, 98304, v14
  v_xor_b32 v31, 0, v29
  ds_read_b64_tr_b16 v[188:189], v31
  v_xor_b32 v31, 32, v29
  ds_read_b64_tr_b16 v[204:205], v31
  v_xor_b32 v31, 64, v29
  ds_read_b64_tr_b16 v[220:221], v31
  v_xor_b32 v31, 96, v29
  ds_read_b64_tr_b16 v[236:237], v31
  v_xor_b32 v31, 128, v29
  ds_read_b64_tr_b16 v[252:253], v31
  v_xor_b32 v31, 160, v29
  ds_read_b64_tr_b16 v[60:61], v31
  v_xor_b32 v31, 192, v29
  ds_read_b64_tr_b16 v[76:77], v31
  v_xor_b32 v31, 224, v29
  ds_read_b64_tr_b16 v[44:45], v31
  s_waitcnt vmcnt(21)
  s_waitcnt lgkmcnt(0)
  s_barrier
  s_add_u32 s68, s51, 1572864
  s_add_u32 m0, s60, 98304
  s_nop 0
  buffer_load_dwordx4 v12, s[12:15], s68 offen  lds
  s_add_u32 s68, s51, 1605632
  s_add_u32 m0, s60, 99328
  s_nop 0
  buffer_load_dwordx4 v12, s[12:15], s68 offen  lds
  s_add_u32 s68, s51, 1638400
  s_add_u32 m0, s60, 100352
  s_nop 0
  buffer_load_dwordx4 v12, s[12:15], s68 offen  lds
  s_add_u32 s68, s51, 1671168
  s_add_u32 m0, s60, 101376
  s_nop 0
  buffer_load_dwordx4 v12, s[12:15], s68 offen  lds
  v_add_u32 v29, 114688, v14
  v_xor_b32 v31, 0, v29
  ds_read_b64_tr_b16 v[190:191], v31
  v_xor_b32 v31, 32, v29
  ds_read_b64_tr_b16 v[206:207], v31
  v_xor_b32 v31, 64, v29
  ds_read_b64_tr_b16 v[222:223], v31
  v_xor_b32 v31, 96, v29
  ds_read_b64_tr_b16 v[238:239], v31
  v_xor_b32 v31, 128, v29
  ds_read_b64_tr_b16 v[254:255], v31
  v_xor_b32 v31, 160, v29
  ds_read_b64_tr_b16 v[62:63], v31
  v_xor_b32 v31, 192, v29
  ds_read_b64_tr_b16 v[78:79], v31
  v_xor_b32 v31, 224, v29
  ds_read_b64_tr_b16 v[46:47], v31
  s_waitcnt vmcnt(21)
  s_waitcnt lgkmcnt(0)
  s_barrier
  s_add_u32 s68, s51, 2621440
  s_add_u32 m0, s60, 114688
  s_nop 0
  buffer_load_dwordx4 v12, s[12:15], s68 offen  lds
  s_add_u32 s68, s51, 2654208
  s_add_u32 m0, s60, 115712
  s_nop 0
  buffer_load_dwordx4 v12, s[12:15], s68 offen  lds
  s_add_u32 s68, s51, 2686976
  s_add_u32 m0, s60, 116736
  s_nop 0
  buffer_load_dwordx4 v12, s[12:15], s68 offen  lds
  s_add_u32 s68, s51, 2719744
  s_add_u32 m0, s60, 117760
  s_nop 0
  buffer_load_dwordx4 v12, s[12:15], s68 offen  lds
  ds_write_b128 v7, v[48:51] offset:0
  ds_write_b128 v7, v[52:55] offset:1024
  ds_write_b128 v7, v[56:59] offset:2048
  ds_write_b128 v7, v[60:63] offset:3072
  ds_write_b128 v7, v[64:67] offset:16384
  ds_write_b128 v7, v[68:71] offset:17408
  ds_write_b128 v7, v[72:75] offset:18432
  ds_write_b128 v7, v[76:79] offset:19456
  s_waitcnt lgkmcnt(0)
  v_add_u32 v29, 131072, v13
  s_cmp_eq_u32 s46, 1
  s_cbranch_scc1 L_cs8_1
  s_cmp_eq_u32 s46, 2
  s_cbranch_scc1 L_cs8_2
  s_cmp_eq_u32 s46, 3
  s_cbranch_scc1 L_cs8_3
  ds_read_b64_tr_b16 v[48:49], v29 offset:0
  ds_read_b64_tr_b16 v[50:51], v29 offset:8192
  ds_read_b64_tr_b16 v[52:53], v29 offset:2048
  ds_read_b64_tr_b16 v[54:55], v29 offset:10240
  ds_read_b64_tr_b16 v[56:57], v29 offset:32
  ds_read_b64_tr_b16 v[58:59], v29 offset:8224
  ds_read_b64_tr_b16 v[60:61], v29 offset:2080
  ds_read_b64_tr_b16 v[62:63], v29 offset:10272
  s_branch L_cs8_e
L_cs8_1:
  ds_read_b64_tr_b16 a[0:1], v29 offset:0
  ds_read_b64_tr_b16 a[2:3], v29 offset:8192
  ds_read_b64_tr_b16 a[4:5], v29 offset:2048
  ds_read_b64_tr_b16 a[6:7], v29 offset:10240
  ds_read_b64_tr_b16 a[32:33], v29 offset:32
  ds_read_b64_tr_b16 a[34:35], v29 offset:8224
  ds_read_b64_tr_b16 a[36:37], v29 offset:2080
  ds_read_b64_tr_b16 a[38:39], v29 offset:10272
  s_branch L_cs8_e
L_cs8_2:
  ds_read_b64_tr_b16 a[16:17], v29 offset:0
  ds_read_b64_tr_b16 a[18:19], v29 offset:8192
  ds_read_b64_tr_b16 a[20:21], v29 offset:2048
  ds_read_b64_tr_b16 a[22:23], v29 offset:10240
  ds_read_b64_tr_b16 a[48:49], v29 offset:32
  ds_read_b64_tr_b16 a[50:51], v29 offset:8224
  ds_read_b64_tr_b16 a[52:53], v29 offset:2080
  ds_read_b64_tr_b16 a[54:55], v29 offset:10272
  s_branch L_cs8_e
L_cs8_3:
  ds_read_b64_tr_b16 a[24:25], v29 offset:0
  ds_read_b64_tr_b16 a[26:27], v29 offset:8192
  ds_read_b64_tr_b16 a[28:29], v29 offset:2048
  ds_read_b64_tr_b16 a[30:31], v29 offset:10240
  ds_read_b64_tr_b16 a[64:65], v29 offset:32
  ds_read_b64_tr_b16 a[66:67], v29 offset:8224
  ds_read_b64_tr_b16 a[68:69], v29 offset:2080
  ds_read_b64_tr_b16 a[70:71], v29 offset:10272
L_cs8_e:
  s_waitcnt vmcnt(21)
  s_waitcnt lgkmcnt(0)
  s_barrier
  s_add_u32 s68, s51, 3670016
  s_add_u32 m0, s60, 131072
  s_nop 0
  buffer_load_dwordx4 v12, s[12:15], s68 offen  lds
  s_add_u32 s68, s51, 3702784
  s_add_u32 m0, s60, 132096
  s_nop 0
  buffer_load_dwordx4 v12, s[12:15], s68 offen  lds
  s_add_u32 s68, s51, 3735552
  s_add_u32 m0, s60, 133120
  s_nop 0
  buffer_load_dwordx4 v12, s[12:15], s68 offen  lds
  s_add_u32 s68, s51, 3768320
  s_add_u32 m0, s60, 134144
  s_nop 0
  buffer_load_dwordx4 v12, s[12:15], s68 offen  lds
  v_add_u32 v29, 147456, v13
  s_cmp_eq_u32 s46, 1
  s_cbranch_scc1 L_cs9_1
  s_cmp_eq_u32 s46, 2
  s_cbranch_scc1 L_cs9_2
  s_cmp_eq_u32 s46, 3
  s_cbranch_scc1 L_cs9_3
  ds_read_b64_tr_b16 a[0:1], v29 offset:0
  ds_read_b64_tr_b16 a[2:3], v29 offset:8192
  ds_read_b64_tr_b16 a[4:5], v29 offset:2048
  ds_read_b64_tr_b16 a[6:7], v29 offset:10240
  ds_read_b64_tr_b16 a[32:33], v29 offset:32
  ds_read_b64_tr_b16 a[34:35], v29 offset:8224
  ds_read_b64_tr_b16 a[36:37], v29 offset:2080
  ds_read_b64_tr_b16 a[38:39], v29 offset:10272
  s_branch L_cs9_e
L_cs9_1:
  ds_read_b64_tr_b16 v[48:49], v29 offset:0
  ds_read_b64_tr_b16 v[50:51], v29 offset:8192
  ds_read_b64_tr_b16 v[52:53], v29 offset:2048
  ds_read_b64_tr_b16 v[54:55], v29 offset:10240
  ds_read_b64_tr_b16 v[56:57], v29 offset:32
  ds_read_b64_tr_b16 v[58:59], v29 offset:8224
  ds_read_b64_tr_b16 v[60:61], v29 offset:2080
  ds_read_b64_tr_b16 v[62:63], v29 offset:10272
  s_branch L_cs9_e
L_cs9_2:
  ds_read_b64_tr_b16 a[24:25], v29 offset:0
  ds_read_b64_tr_b16 a[26:27], v29 offset:8192
  ds_read_b64_tr_b16 a[28:29], v29 offset:2048
  ds_read_b64_tr_b16 a[30:31], v29 offset:10240
  ds_read_b64_tr_b16 a[64:65], v29 offset:32
  ds_read_b64_tr_b16 a[66:67], v29 offset:8224
  ds_read_b64_tr_b16 a[68:69], v29 offset:2080
  ds_read_b64_tr_b16 a[70:71], v29 offset:10272
  s_branch L_cs9_e
L_cs9_3:
  ds_read_b64_tr_b16 a[16:17], v29 offset:0
  ds_read_b64_tr_b16 a[18:19], v29 offset:8192
  ds_read_b64_tr_b16 a[20:21], v29 offset:2048
  ds_read_b64_tr_b16 a[22:23], v29 offset:10240
  ds_read_b64_tr_b16 a[48:49], v29 offset:32
  ds_read_b64_tr_b16 a[50:51], v29 offset:8224
  ds_read_b64_tr_b16 a[52:53], v29 offset:2080
  ds_read_b64_tr_b16 a[54:55], v29 offset:10272
L_cs9_e:
  s_waitcnt vmcnt(21)
  s_waitcnt lgkmcnt(0)
  s_barrier
  s_mov_b32 s12, s32
  s_and_b32 s13, s33, 0xffff
  s_mov_b32 s14, 4194304
  s_mov_b32 s15, 0x20000
  s_add_u32 s68, s51, 0
  s_add_u32 m0, s60, 147456
  s_nop 0
  buffer_load_dwordx4 v12, s[12:15], s68 offen  lds
  s_add_u32 s68, s51, 32768
  s_add_u32 m0, s60, 148480
  s_nop 0
  buffer_load_dwordx4 v12, s[12:15], s68 offen  lds
  s_add_u32 s68, s51, 65536
  s_add_u32 m0, s60, 149504
  s_nop 0
  buffer_load_dwordx4 v12, s[12:15], s68 offen  lds
  s_add_u32 s68, s51, 98304
  s_add_u32 m0, s60, 150528
  s_nop 0
  buffer_load_dwordx4 v12, s[12:15], s68 offen  lds
  v_add_u32 v29, 0, v13
  s_cmp_eq_u32 s46, 1
  s_cbranch_scc1 L_cs10_1
  s_cmp_eq_u32 s46, 2
  s_cbranch_scc1 L_cs10_2
  s_cmp_eq_u32 s46, 3
  s_cbranch_scc1 L_cs10_3
  ds_read_b64_tr_b16 a[16:17], v29 offset:0
  ds_read_b64_tr_b16 a[18:19], v29 offset:8192
  ds_read_b64_tr_b16 a[20:21], v29 offset:2048
  ds_read_b64_tr_b16 a[22:23], v29 offset:10240
  ds_read_b64_tr_b16 a[48:49], v29 offset:32
  ds_read_b64_tr_b16 a[50:51], v29 offset:8224
  ds_read_b64_tr_b16 a[52:53], v29 offset:2080
  ds_read_b64_tr_b16 a[54:55], v29 offset:10272
  s_branch L_cs10_e
L_cs10_1:
  ds_read_b64_tr_b16 a[24:25], v29 offset:0
  ds_read_b64_tr_b16 a[26:27], v29 offset:8192
  ds_read_b64_tr_b16 a[28:29], v29 offset:2048
  ds_read_b64_tr_b16 a[30:31], v29 offset:10240
  ds_read_b64_tr_b16 a[64:65], v29 offset:32
  ds_read_b64_tr_b16 a[66:67], v29 offset:8224
  ds_read_b64_tr_b16 a[68:69], v29 offset:2080
  ds_read_b64_tr_b16 a[70:71], v29 offset:10272
  s_branch L_cs10_e
L_cs10_2:
  ds_read_b64_tr_b16 v[48:49], v29 offset:0
  ds_read_b64_tr_b16 v[50:51], v29 offset:8192
  ds_read_b64_tr_b16 v[52:53], v29 offset:2048
  ds_read_b64_tr_b16 v[54:55], v29 offset:10240
  ds_read_b64_tr_b16 v[56:57], v29 offset:32
  ds_read_b64_tr_b16 v[58:59], v29 offset:8224
  ds_read_b64_tr_b16 v[60:61], v29 offset:2080
  ds_read_b64_tr_b16 v[62:63], v29 offset:10272
  s_branch L_cs10_e
L_cs10_3:
  ds_read_b64_tr_b16 a[0:1], v29 offset:0
  ds_read_b64_tr_b16 a[2:3], v29 offset:8192
  ds_read_b64_tr_b16 a[4:5], v29 offset:2048
  ds_read_b64_tr_b16 a[6:7], v29 offset:10240
  ds_read_b64_tr_b16 a[32:33], v29 offset:32
  ds_read_b64_tr_b16 a[34:35], v29 offset:8224
  ds_read_b64_tr_b16 a[36:37], v29 offset:2080
  ds_read_b64_tr_b16 a[38:39], v29 offset:10272
L_cs10_e:
  s_waitcnt vmcnt(21)
  s_waitcnt lgkmcnt(0)
  s_barrier
  s_add_u32 s68, s51, 1048576
  s_add_u32 m0, s60, 0
  s_nop 0
  buffer_load_dwordx4 v12, s[12:15], s68 offen  lds
  s_add_u32 s68, s51, 1081344
  s_add_u32 m0, s60, 1024
  s_nop 0
  buffer_load_dwordx4 v12, s[12:15], s68 offen  lds
  s_add_u32 s68, s51, 1114112
  s_add_u32 m0, s60, 2048
  s_nop 0
  buffer_load_dwordx4 v12, s[12:15], s68 offen  lds
  s_add_u32 s68, s51, 1146880
  s_add_u32 m0, s60, 3072
  s_nop 0
  buffer_load_dwordx4 v12, s[12:15], s68 offen  lds
  v_add_u32 v29, 65536, v13
  s_cmp_eq_u32 s46, 1
  s_cbranch_scc1 L_cs11_1
  s_cmp_eq_u32 s46, 2
  s_cbranch_scc1 L_cs11_2
  s_cmp_eq_u32 s46, 3
  s_cbranch_scc1 L_cs11_3
  ds_read_b64_tr_b16 a[24:25], v29 offset:0
  ds_read_b64_tr_b16 a[26:27], v29 offset:8192
  ds_read_b64_tr_b16 a[28:29], v29 offset:2048
  ds_read_b64_tr_b16 a[30:31], v29 offset:10240
  ds_read_b64_tr_b16 a[64:65], v29 offset:32
  ds_read_b64_tr_b16 a[66:67], v29 offset:8224
  ds_read_b64_tr_b16 a[68:69], v29 offset:2080
  ds_read_b64_tr_b16 a[70:71], v29 offset:10272
  s_branch L_cs11_e
L_cs11_1:
  ds_read_b64_tr_b16 a[16:17], v29 offset:0
  ds_read_b64_tr_b16 a[18:19], v29 offset:8192
  ds_read_b64_tr_b16 a[20:21], v29 offset:2048
  ds_read_b64_tr_b16 a[22:23], v29 offset:10240
  ds_read_b64_tr_b16 a[48:49], v29 offset:32
  ds_read_b64_tr_b16 a[50:51], v29 offset:8224
  ds_read_b64_tr_b16 a[52:53], v29 offset:2080
  ds_read_b64_tr_b16 a[54:55], v29 offset:10272
  s_branch L_cs11_e
L_cs11_2:
  ds_read_b64_tr_b16 a[0:1], v29 offset:0
  ds_read_b64_tr_b16 a[2:3], v29 offset:8192
  ds_read_b64_tr_b16 a[4:5], v29 offset:2048
  ds_read_b64_tr_b16 a[6:7], v29 offset:10240
  ds_read_b64_tr_b16 a[32:33], v29 offset:32
  ds_read_b64_tr_b16 a[34:35], v29 offset:8224
  ds_read_b64_tr_b16 a[36:37], v29 offset:2080
  ds_read_b64_tr_b16 a[38:39], v29 offset:10272
  s_branch L_cs11_e
L_cs11_3:
  ds_read_b64_tr_b16 v[48:49], v29 offset:0
  ds_read_b64_tr_b16 v[50:51], v29 offset:8192
  ds_read_b64_tr_b16 v[52:53], v29 offset:2048
  ds_read_b64_tr_b16 v[54:55], v29 offset:10240
  ds_read_b64_tr_b16 v[56:57], v29 offset:32
  ds_read_b64_tr_b16 v[58:59], v29 offset:8224
  ds_read_b64_tr_b16 v[60:61], v29 offset:2080
  ds_read_b64_tr_b16 v[62:63], v29 offset:10272
L_cs11_e:
  s_waitcnt vmcnt(20)
  s_waitcnt lgkmcnt(0)
  s_barrier
  s_cmp_lg_u32 s46, 0
  s_cbranch_scc1 L_cs_in
  s_sub_u32 s68, s16, 1
  s_and_b32 s68, s68, s48
  s_mov_b32 s69, 0x10000
  s_cselect_b32 s68, 0x1010000, s69
  v_mov_b32 v28, s68
  s_mov_b64 exec, 1
  buffer_atomic_add v28, off, s[8:11], 0 offset:128
  s_mov_b64 exec, -1
L_cs_in:
  s_add_u32 s68, s51, 2097152
  s_add_u32 m0, s60, 65536
  s_nop 0
  buffer_load_dwordx4 v12, s[12:15], s68 offen  lds
  s_add_u32 s68, s51, 2129920
  s_add_u32 m0, s60, 66560
  s_nop 0
  buffer_load_dwordx4 v12, s[12:15], s68 offen  lds
  s_add_u32 s68, s51, 2162688
  s_add_u32 m0, s60, 67584
  s_nop 0
  buffer_load_dwordx4 v12, s[12:15], s68 offen  lds
  s_add_u32 s68, s51, 2195456
  s_add_u32 m0, s60, 68608
  s_nop 0
  buffer_load_dwordx4 v12, s[12:15], s68 offen  lds
  v_add_u32 v29, 81920, v13
  s_cmp_eq_u32 s46, 1
  s_cbranch_scc1 L_cs12_1
  s_cmp_eq_u32 s46, 2
  s_cbranch_scc1 L_cs12_2
  s_cmp_eq_u32 s46, 3
  s_cbranch_scc1 L_cs12_3
  ds_read_b64_tr_b16 v[80:81], v29 offset:0
  ds_read_b64_tr_b16 v[82:83], v29 offset:8192
  ds_read_b64_tr_b16 v[84:85], v29 offset:2048
  ds_read_b64_tr_b16 v[86:87], v29 offset:10240
  ds_read_b64_tr_b16 v[88:89], v29 offset:32
  ds_read_b64_tr_b16 v[90:91], v29 offset:8224
  ds_read_b64_tr_b16 v[92:93], v29 offset:2080
  ds_read_b64_tr_b16 v[94:95], v29 offset:10272
  s_branch L_cs12_e
L_cs12_1:
  ds_read_b64_tr_b16 a[8:9], v29 offset:0
  ds_read_b64_tr_b16 a[10:11], v29 offset:8192
  ds_read_b64_tr_b16 a[12:13], v29 offset:2048
  ds_read_b64_tr_b16 a[14:15], v29 offset:10240
  ds_read_b64_tr_b16 a[40:41], v29 offset:32
  ds_read_b64_tr_b16 a[42:43], v29 offset:8224
  ds_read_b64_tr_b16 a[44:45], v29 offset:2080
  ds_read_b64_tr_b16 a[46:47], v29 offset:10272
  s_branch L_cs12_e
L_cs12_2:
  ds_read_b64_tr_b16 v[112:113], v29 offset:0
  ds_read_b64_tr_b16 v[114:115], v29 offset:8192
  ds_read_b64_tr_b16 v[116:117], v29 offset:2048
  ds_read_b64_tr_b16 v[118:119], v29 offset:10240
  ds_read_b64_tr_b16 a[56:57], v29 offset:32
  ds_read_b64_tr_b16 a[58:59], v29 offset:8224
  ds_read_b64_tr_b16 a[60:61], v29 offset:2080
  ds_read_b64_tr_b16 a[62:63], v29 offset:10272
  s_branch L_cs12_e
L_cs12_3:
  ds_read_b64_tr_b16 v[120:121], v29 offset:0
  ds_read_b64_tr_b16 v[122:123], v29 offset:8192
  ds_read_b64_tr_b16 v[124:125], v29 offset:2048
  ds_read_b64_tr_b16 v[126:127], v29 offset:10240
  ds_read_b64_tr_b16 a[72:73], v29 offset:32
  ds_read_b64_tr_b16 a[74:75], v29 offset:8224
  ds_read_b64_tr_b16 a[76:77], v29 offset:2080
  ds_read_b64_tr_b16 a[78:79], v29 offset:10272
L_cs12_e:
  s_waitcnt vmcnt(20)
  s_waitcnt lgkmcnt(0)
  s_barrier
  s_add_u32 s68, s51, 3145728
  s_add_u32 m0, s60, 81920
  s_nop 0
  buffer_load_dwordx4 v12, s[12:15], s68 offen  lds
  s_add_u32 s68, s51, 3178496
  s_add_u32 m0, s60, 82944
  s_nop 0
  buffer_load_dwordx4 v12, s[12:15], s68 offen  lds
  s_add_u32 s68, s51, 3211264
  s_add_u32 m0, s60, 83968
  s_nop 0
  buffer_load_dwordx4 v12, s[12:15], s68 offen  lds
  s_add_u32 s68, s51, 3244032
  s_add_u32 m0, s60, 84992
  s_nop 0
  buffer_load_dwordx4 v12, s[12:15], s68 offen  lds
  v_add_u32 v29, 98304, v13
  s_cmp_eq_u32 s46, 1
  s_cbranch_scc1 L_cs13_1
  s_cmp_eq_u32 s46, 2
  s_cbranch_scc1 L_cs13_2
  s_cmp_eq_u32 s46, 3
  s_cbranch_scc1 L_cs13_3
  ds_read_b64_tr_b16 a[8:9], v29 offset:0
  ds_read_b64_tr_b16 a[10:11], v29 offset:8192
  ds_read_b64_tr_b16 a[12:13], v29 offset:2048
  ds_read_b64_tr_b16 a[14:15], v29 offset:10240
  ds_read_b64_tr_b16 a[40:41], v29 offset:32
  ds_read_b64_tr_b16 a[42:43], v29 offset:8224
  ds_read_b64_tr_b16 a[44:45], v29 offset:2080
  ds_read_b64_tr_b16 a[46:47], v29 offset:10272
  s_branch L_cs13_e
L_cs13_1:
  ds_read_b64_tr_b16 v[80:81], v29 offset:0
  ds_read_b64_tr_b16 v[82:83], v29 offset:8192
  ds_read_b64_tr_b16 v[84:85], v29 offset:2048
  ds_read_b64_tr_b16 v[86:87], v29 offset:10240
  ds_read_b64_tr_b16 v[88:89], v29 offset:32
  ds_read_b64_tr_b16 v[90:91], v29 offset:8224
  ds_read_b64_tr_b16 v[92:93], v29 offset:2080
  ds_read_b64_tr_b16 v[94:95], v29 offset:10272
  s_branch L_cs13_e
L_cs13_2:
  ds_read_b64_tr_b16 v[120:121], v29 offset:0
  ds_read_b64_tr_b16 v[122:123], v29 offset:8192
  ds_read_b64_tr_b16 v[124:125], v29 offset:2048
  ds_read_b64_tr_b16 v[126:127], v29 offset:10240
  ds_read_b64_tr_b16 a[72:73], v29 offset:32
  ds_read_b64_tr_b16 a[74:75], v29 offset:8224
  ds_read_b64_tr_b16 a[76:77], v29 offset:2080
  ds_read_b64_tr_b16 a[78:79], v29 offset:10272
  s_branch L_cs13_e
L_cs13_3:
  ds_read_b64_tr_b16 v[112:113], v29 offset:0
  ds_read_b64_tr_b16 v[114:115], v29 offset:8192
  ds_read_b64_tr_b16 v[116:117], v29 offset:2048
  ds_read_b64_tr_b16 v[118:119], v29 offset:10240
  ds_read_b64_tr_b16 a[56:57], v29 offset:32
  ds_read_b64_tr_b16 a[58:59], v29 offset:8224
  ds_read_b64_tr_b16 a[60:61], v29 offset:2080
  ds_read_b64_tr_b16 a[62:63], v29 offset:10272
L_cs13_e:
  s_waitcnt vmcnt(20)
  s_waitcnt lgkmcnt(0)
  s_barrier
  s_add_u32 s68, s51, 524288
  s_add_u32 m0, s60, 98304
  s_nop 0
  buffer_load_dwordx4 v12, s[12:15], s68 offen  lds
  s_add_u32 s68, s51, 557056
  s_add_u32 m0, s60, 99328
  s_nop 0
  buffer_load_dwordx4 v12, s[12:15], s68 offen  lds
  s_add_u32 s68, s51, 589824
  s_add_u32 m0, s60, 100352
  s_nop 0
  buffer_load_dwordx4 v12, s[12:15], s68 offen  lds
  s_add_u32 s68, s51, 622592
  s_add_u32 m0, s60, 101376
  s_nop 0
  buffer_load_dwordx4 v12, s[12:15], s68 offen  lds
  v_add_u32 v29, 114688, v13
  s_cmp_eq_u32 s46, 1
  s_cbranch_scc1 L_cs14_1
  s_cmp_eq_u32 s46, 2
  s_cbranch_scc1 L_cs14_2
  s_cmp_eq_u32 s46, 3
  s_cbranch_scc1 L_cs14_3
  ds_read_b64_tr_b16 v[112:113], v29 offset:0
  ds_read_b64_tr_b16 v[114:115], v29 offset:8192
  ds_read_b64_tr_b16 v[116:117], v29 offset:2048
  ds_read_b64_tr_b16 v[118:119], v29 offset:10240
  ds_read_b64_tr_b16 a[56:57], v29 offset:32
  ds_read_b64_tr_b16 a[58:59], v29 offset:8224
  ds_read_b64_tr_b16 a[60:61], v29 offset:2080
  ds_read_b64_tr_b16 a[62:63], v29 offset:10272
  s_branch L_cs14_e
L_cs14_1:
  ds_read_b64_tr_b16 v[120:121], v29 offset:0
  ds_read_b64_tr_b16 v[122:123], v29 offset:8192
  ds_read_b64_tr_b16 v[124:125], v29 offset:2048
  ds_read_b64_tr_b16 v[126:127], v29 offset:10240
  ds_read_b64_tr_b16 a[72:73], v29 offset:32
  ds_read_b64_tr_b16 a[74:75], v29 offset:8224
  ds_read_b64_tr_b16 a[76:77], v29 offset:2080
  ds_read_b64_tr_b16 a[78:79], v29 offset:10272
  s_branch L_cs14_e
L_cs14_2:
  ds_read_b64_tr_b16 v[80:81], v29 offset:0
  ds_read_b64_tr_b16 v[82:83], v29 offset:8192
  ds_read_b64_tr_b16 v[84:85], v29 offset:2048
  ds_read_b64_tr_b16 v[86:87], v29 offset:10240
  ds_read_b64_tr_b16 v[88:89], v29 offset:32
  ds_read_b64_tr_b16 v[90:91], v29 offset:8224
  ds_read_b64_tr_b16 v[92:93], v29 offset:2080
  ds_read_b64_tr_b16 v[94:95], v29 offset:10272
  s_branch L_cs14_e
L_cs14_3:
  ds_read_b64_tr_b16 a[8:9], v29 offset:0
  ds_read_b64_tr_b16 a[10:11], v29 offset:8192
  ds_read_b64_tr_b16 a[12:13], v29 offset:2048
  ds_read_b64_tr_b16 a[14:15], v29 offset:10240
  ds_read_b64_tr_b16 a[40:41], v29 offset:32
  ds_read_b64_tr_b16 a[42:43], v29 offset:8224
  ds_read_b64_tr_b16 a[44:45], v29 offset:2080
  ds_read_b64_tr_b16 a[46:47], v29 offset:10272
L_cs14_e:
  s_waitcnt vmcnt(20)
  s_waitcnt lgkmcnt(0)
  s_barrier
  s_add_u32 s68, s51, 1572864
  s_add_u32 m0, s60, 114688
  s_nop 0
  buffer_load_dwordx4 v12, s[12:15], s68 offen  lds
  s_add_u32 s68, s51, 1605632
  s_add_u32 m0, s60, 115712
  s_nop 0
  buffer_load_dwordx4 v12, s[12:15], s68 offen  lds
  s_add_u32 s68, s51, 1638400
  s_add_u32 m0, s60, 116736
  s_nop 0
  buffer_load_dwordx4 v12, s[12:15], s68 offen  lds
  s_add_u32 s68, s51, 1671168
  s_add_u32 m0, s60, 117760
  s_nop 0
  buffer_load_dwordx4 v12, s[12:15], s68 offen  lds
  v_add_u32 v29, 131072, v13
  s_cmp_eq_u32 s46, 1
  s_cbranch_scc1 L_cs15_1
  s_cmp_eq_u32 s46, 2
  s_cbranch_scc1 L_cs15_2
  s_cmp_eq_u32 s46, 3
  s_cbranch_scc1 L_cs15_3
  ds_read_b64_tr_b16 v[120:121], v29 offset:0
  ds_read_b64_tr_b16 v[122:123], v29 offset:8192
  ds_read_b64_tr_b16 v[124:125], v29 offset:2048
  ds_read_b64_tr_b16 v[126:127], v29 offset:10240
  ds_read_b64_tr_b16 a[72:73], v29 offset:32
  ds_read_b64_tr_b16 a[74:75], v29 offset:8224
  ds_read_b64_tr_b16 a[76:77], v29 offset:2080
  ds_read_b64_tr_b16 a[78:79], v29 offset:10272
  s_branch L_cs15_e
L_cs15_1:
  ds_read_b64_tr_b16 v[112:113], v29 offset:0
  ds_read_b64_tr_b16 v[114:115], v29 offset:8192
  ds_read_b64_tr_b16 v[116:117], v29 offset:2048
  ds_read_b64_tr_b16 v[118:119], v29 offset:10240
  ds_read_b64_tr_b16 a[56:57], v29 offset:32
  ds_read_b64_tr_b16 a[58:59], v29 offset:8224
  ds_read_b64_tr_b16 a[60:61], v29 offset:2080
  ds_read_b64_tr_b16 a[62:63], v29 offset:10272
  s_branch L_cs15_e
L_cs15_2:
  ds_read_b64_tr_b16 a[8:9], v29 offset:0
  ds_read_b64_tr_b16 a[10:11], v29 offset:8192
  ds_read_b64_tr_b16 a[12:13], v29 offset:2048
  ds_read_b64_tr_b16 a[14:15], v29 offset:10240
  ds_read_b64_tr_b16 a[40:41], v29 offset:32
  ds_read_b64_tr_b16 a[42:43], v29 offset:8224
  ds_read_b64_tr_b16 a[44:45], v29 offset:2080
  ds_read_b64_tr_b16 a[46:47], v29 offset:10272
  s_branch L_cs15_e
L_cs15_3:
  ds_read_b64_tr_b16 v[80:81], v29 offset:0
  ds_read_b64_tr_b16 v[82:83], v29 offset:8192
  ds_read_b64_tr_b16 v[84:85], v29 offset:2048
  ds_read_b64_tr_b16 v[86:87], v29 offset:10240
  ds_read_b64_tr_b16 v[88:89], v29 offset:32
  ds_read_b64_tr_b16 v[90:91], v29 offset:8224
  ds_read_b64_tr_b16 v[92:93], v29 offset:2080
  ds_read_b64_tr_b16 v[94:95], v29 offset:10272
L_cs15_e:
  s_waitcnt vmcnt(20)
  s_waitcnt lgkmcnt(0)
  s_barrier
  s_add_u32 s68, s51, 2621440
  s_add_u32 m0, s60, 131072
  s_nop 0
  buffer_load_dwordx4 v12, s[12:15], s68 offen  lds
  s_add_u32 s68, s51, 2654208
  s_add_u32 m0, s60, 132096
  s_nop 0
  buffer_load_dwordx4 v12, s[12:15], s68 offen  lds
  s_add_u32 s68, s51, 2686976
  s_add_u32 m0, s60, 133120
  s_nop 0
  buffer_load_dwordx4 v12, s[12:15], s68 offen  lds
  s_add_u32 s68, s51, 2719744
  s_add_u32 m0, s60, 134144
  s_nop 0
  buffer_load_dwordx4 v12, s[12:15], s68 offen  lds
  buffer_load_dword v17, off, s[8:11], 0 offset:128 sc1
  v_add_u32 v29, 147456, v13
  s_cmp_eq_u32 s46, 1
  s_cbranch_scc1 L_cs16_1
  s_cmp_eq_u32 s46, 2
  s_cbranch_scc1 L_cs16_2
  s_cmp_eq_u32 s46, 3
  s_cbranch_scc1 L_cs16_3
  ds_read_b64_tr_b16 v[64:65], v29 offset:0
  ds_read_b64_tr_b16 v[66:67], v29 offset:8192
  ds_read_b64_tr_b16 v[68:69], v29 offset:2048
  ds_read_b64_tr_b16 v[70:71], v29 offset:10240
  ds_read_b64_tr_b16 v[72:73], v29 offset:32
  ds_read_b64_tr_b16 v[74:75], v29 offset:8224
  ds_read_b64_tr_b16 v[76:77], v29 offset:2080
  ds_read_b64_tr_b16 v[78:79], v29 offset:10272
  s_branch L_cs16_e
L_cs16_1:
  ds_read_b64_tr_b16 a[80:81], v29 offset:0
  ds_read_b64_tr_b16 a[82:83], v29 offset:8192
  ds_read_b64_tr_b16 a[84:85], v29 offset:2048
  ds_read_b64_tr_b16 a[86:87], v29 offset:10240
  ds_read_b64_tr_b16 a[128:129], v29 offset:32
  ds_read_b64_tr_b16 a[130:131], v29 offset:8224
  ds_read_b64_tr_b16 a[132:133], v29 offset:2080
  ds_read_b64_tr_b16 a[134:135], v29 offset:10272
  s_branch L_cs16_e
L_cs16_2:
  ds_read_b64_tr_b16 a[96:97], v29 offset:0
  ds_read_b64_tr_b16 a[98:99], v29 offset:8192
  ds_read_b64_tr_b16 a[100:101], v29 offset:2048
  ds_read_b64_tr_b16 a[102:103], v29 offset:10240
  ds_read_b64_tr_b16 a[144:145], v29 offset:32
  ds_read_b64_tr_b16 a[146:147], v29 offset:8224
  ds_read_b64_tr_b16 a[148:149], v29 offset:2080
  ds_read_b64_tr_b16 a[150:151], v29 offset:10272
  s_branch L_cs16_e
L_cs16_3:
  ds_read_b64_tr_b16 a[112:113], v29 offset:0
  ds_read_b64_tr_b16 a[114:115], v29 offset:8192
  ds_read_b64_tr_b16 a[116:117], v29 offset:2048
  ds_read_b64_tr_b16 a[118:119], v29 offset:10240
  ds_read_b64_tr_b16 a[160:161], v29 offset:32
  ds_read_b64_tr_b16 a[162:163], v29 offset:8224
  ds_read_b64_tr_b16 a[164:165], v29 offset:2080
  ds_read_b64_tr_b16 a[166:167], v29 offset:10272
L_cs16_e:
  s_waitcnt vmcnt(21)
  s_waitcnt lgkmcnt(0)
  s_barrier
  s_add_u32 s68, s51, 3670016
  s_add_u32 m0, s60, 147456
  s_nop 0
  buffer_load_dwordx4 v12, s[12:15], s68 offen  lds
  s_add_u32 s68, s51, 3702784
  s_add_u32 m0, s60, 148480
  s_nop 0
  buffer_load_dwordx4 v12, s[12:15], s68 offen  lds
  s_add_u32 s68, s51, 3735552
  s_add_u32 m0, s60, 149504
  s_nop 0
  buffer_load_dwordx4 v12, s[12:15], s68 offen  lds
  s_add_u32 s68, s51, 3768320
  s_add_u32 m0, s60, 150528
  s_nop 0
  buffer_load_dwordx4 v12, s[12:15], s68 offen  lds
  v_add_u32 v29, 0, v13
  s_cmp_eq_u32 s46, 1
  s_cbranch_scc1 L_cs17_1
  s_cmp_eq_u32 s46, 2
  s_cbranch_scc1 L_cs17_2
  s_cmp_eq_u32 s46, 3
  s_cbranch_scc1 L_cs17_3
  ds_read_b64_tr_b16 a[80:81], v29 offset:0
  ds_read_b64_tr_b16 a[82:83], v29 offset:8192
  ds_read_b64_tr_b16 a[84:85], v29 offset:2048
  ds_read_b64_tr_b16 a[86:87], v29 offset:10240
  ds_read_b64_tr_b16 a[128:129], v29 offset:32
  ds_read_b64_tr_b16 a[130:131], v29 offset:8224
  ds_read_b64_tr_b16 a[132:133], v29 offset:2080
  ds_read_b64_tr_b16 a[134:135], v29 offset:10272
  s_branch L_cs17_e
L_cs17_1:
  ds_read_b64_tr_b16 v[64:65], v29 offset:0
  ds_read_b64_tr_b16 v[66:67], v29 offset:8192
  ds_read_b64_tr_b16 v[68:69], v29 offset:2048
  ds_read_b64_tr_b16 v[70:71], v29 offset:10240
  ds_read_b64_tr_b16 v[72:73], v29 offset:32
  ds_read_b64_tr_b16 v[74:75], v29 offset:8224
  ds_read_b64_tr_b16 v[76:77], v29 offset:2080
  ds_read_b64_tr_b16 v[78:79], v29 offset:10272
  s_branch L_cs17_e
L_cs17_2:
  ds_read_b64_tr_b16 a[112:113], v29 offset:0
  ds_read_b64_tr_b16 a[114:115], v29 offset:8192
  ds_read_b64_tr_b16 a[116:117], v29 offset:2048
  ds_read_b64_tr_b16 a[118:119], v29 offset:10240
  ds_read_b64_tr_b16 a[160:161], v29 offset:32
  ds_read_b64_tr_b16 a[162:163], v29 offset:8224
  ds_read_b64_tr_b16 a[164:165], v29 offset:2080
  ds_read_b64_tr_b16 a[166:167], v29 offset:10272
  s_branch L_cs17_e
L_cs17_3:
  ds_read_b64_tr_b16 a[96:97], v29 offset:0
  ds_read_b64_tr_b16 a[98:99], v29 offset:8192
  ds_read_b64_tr_b16 a[100:101], v29 offset:2048
  ds_read_b64_tr_b16 a[102:103], v29 offset:10240
  ds_read_b64_tr_b16 a[144:145], v29 offset:32
  ds_read_b64_tr_b16 a[146:147], v29 offset:8224
  ds_read_b64_tr_b16 a[148:149], v29 offset:2080
  ds_read_b64_tr_b16 a[150:151], v29 offset:10272
L_cs17_e:
  s_waitcnt vmcnt(21)
  s_waitcnt lgkmcnt(0)
  s_barrier
  s_mov_b32 s12, s34
  s_and_b32 s13, s35, 0xffff
  s_mov_b32 s14, 4194304
  s_mov_b32 s15, 0x20000
  s_add_u32 s68, s51, 0
  s_add_u32 m0, s60, 0
  s_nop 0
  buffer_load_dwordx4 v12, s[12:15], s68 offen  lds
  s_add_u32 s68, s51, 32768
  s_add_u32 m0, s60, 1024
  s_nop 0
  buffer_load_dwordx4 v12, s[12:15], s68 offen  lds
  s_add_u32 s68, s51, 65536
  s_add_u32 m0, s60, 2048
  s_nop 0
  buffer_load_dwordx4 v12, s[12:15], s68 offen  lds
  s_add_u32 s68, s51, 98304
  s_add_u32 m0, s60, 3072
  s_nop 0
  buffer_load_dwordx4 v12, s[12:15], s68 offen  lds
  v_add_u32 v29, 65536, v13
  s_cmp_eq_u32 s46, 1
  s_cbranch_scc1 L_cs18_1
  s_cmp_eq_u32 s46, 2
  s_cbranch_scc1 L_cs18_2
  s_cmp_eq_u32 s46, 3
  s_cbranch_scc1 L_cs18_3
  ds_read_b64_tr_b16 a[96:97], v29 offset:0
  ds_read_b64_tr_b16 a[98:99], v29 offset:8192
  ds_read_b64_tr_b16 a[100:101], v29 offset:2048
  ds_read_b64_tr_b16 a[102:103], v29 offset:10240
  ds_read_b64_tr_b16 a[144:145], v29 offset:32
  ds_read_b64_tr_b16 a[146:147], v29 offset:8224
  ds_read_b64_tr_b16 a[148:149], v29 offset:2080
  ds_read_b64_tr_b16 a[150:151], v29 offset:10272
  s_branch L_cs18_e
L_cs18_1:
  ds_read_b64_tr_b16 a[112:113], v29 offset:0
  ds_read_b64_tr_b16 a[114:115], v29 offset:8192
  ds_read_b64_tr_b16 a[116:117], v29 offset:2048
  ds_read_b64_tr_b16 a[118:119], v29 offset:10240
  ds_read_b64_tr_b16 a[160:161], v29 offset:32
  ds_read_b64_tr_b16 a[162:163], v29 offset:8224
  ds_read_b64_tr_b16 a[164:165], v29 offset:2080
  ds_read_b64_tr_b16 a[166:167], v29 offset:10272
  s_branch L_cs18_e
L_cs18_2:
  ds_read_b64_tr_b16 v[64:65], v29 offset:0
  ds_read_b64_tr_b16 v[66:67], v29 offset:8192
  ds_read_b64_tr_b16 v[68:69], v29 offset:2048
  ds_read_b64_tr_b16 v[70:71], v29 offset:10240
  ds_read_b64_tr_b16 v[72:73], v29 offset:32
  ds_read_b64_tr_b16 v[74:75], v29 offset:8224
  ds_read_b64_tr_b16 v[76:77], v29 offset:2080
  ds_read_b64_tr_b16 v[78:79], v29 offset:10272
  s_branch L_cs18_e
L_cs18_3:
  ds_read_b64_tr_b16 a[80:81], v29 offset:0
  ds_read_b64_tr_b16 a[82:83], v29 offset:8192
  ds_read_b64_tr_b16 a[84:85], v29 offset:2048
  ds_read_b64_tr_b16 a[86:87], v29 offset:10240
  ds_read_b64_tr_b16 a[128:129], v29 offset:32
  ds_read_b64_tr_b16 a[130:131], v29 offset:8224
  ds_read_b64_tr_b16 a[132:133], v29 offset:2080
  ds_read_b64_tr_b16 a[134:135], v29 offset:10272
L_cs18_e:
  s_waitcnt vmcnt(21)
  s_waitcnt lgkmcnt(0)
  s_barrier
  s_add_u32 s68, s51, 1048576
  s_add_u32 m0, s60, 65536
  s_nop 0
  buffer_load_dwordx4 v12, s[12:15], s68 offen  lds
  s_add_u32 s68, s51, 1081344
  s_add_u32 m0, s60, 66560
  s_nop 0
  buffer_load_dwordx4 v12, s[12:15], s68 offen  lds
  s_add_u32 s68, s51, 1114112
  s_add_u32 m0, s60, 67584
  s_nop 0
  buffer_load_dwordx4 v12, s[12:15], s68 offen  lds
  s_add_u32 s68, s51, 1146880
  s_add_u32 m0, s60, 68608
  s_nop 0
  buffer_load_dwordx4 v12, s[12:15], s68 offen  lds
  v_add_u32 v29, 81920, v13
  s_cmp_eq_u32 s46, 1
  s_cbranch_scc1 L_cs19_1
  s_cmp_eq_u32 s46, 2
  s_cbranch_scc1 L_cs19_2
  s_cmp_eq_u32 s46, 3
  s_cbranch_scc1 L_cs19_3
  ds_read_b64_tr_b16 a[112:113], v29 offset:0
  ds_read_b64_tr_b16 a[114:115], v29 offset:8192
  ds_read_b64_tr_b16 a[116:117], v29 offset:2048
  ds_read_b64_tr_b16 a[118:119], v29 offset:10240
  ds_read_b64_tr_b16 a[160:161], v29 offset:32
  ds_read_b64_tr_b16 a[162:163], v29 offset:8224
  ds_read_b64_tr_b16 a[164:165], v29 offset:2080
  ds_read_b64_tr_b16 a[166:167], v29 offset:10272
  s_branch L_cs19_e
L_cs19_1:
  ds_read_b64_tr_b16 a[96:97], v29 offset:0
  ds_read_b64_tr_b16 a[98:99], v29 offset:8192
  ds_read_b64_tr_b16 a[100:101], v29 offset:2048
  ds_read_b64_tr_b16 a[102:103], v29 offset:10240
  ds_read_b64_tr_b16 a[144:145], v29 offset:32
  ds_read_b64_tr_b16 a[146:147], v29 offset:8224
  ds_read_b64_tr_b16 a[148:149], v29 offset:2080
  ds_read_b64_tr_b16 a[150:151], v29 offset:10272
  s_branch L_cs19_e
L_cs19_2:
  ds_read_b64_tr_b16 a[80:81], v29 offset:0
  ds_read_b64_tr_b16 a[82:83], v29 offset:8192
  ds_read_b64_tr_b16 a[84:85], v29 offset:2048
  ds_read_b64_tr_b16 a[86:87], v29 offset:10240
  ds_read_b64_tr_b16 a[128:129], v29 offset:32
  ds_read_b64_tr_b16 a[130:131], v29 offset:8224
  ds_read_b64_tr_b16 a[132:133], v29 offset:2080
  ds_read_b64_tr_b16 a[134:135], v29 offset:10272
  s_branch L_cs19_e
L_cs19_3:
  ds_read_b64_tr_b16 v[64:65], v29 offset:0
  ds_read_b64_tr_b16 v[66:67], v29 offset:8192
  ds_read_b64_tr_b16 v[68:69], v29 offset:2048
  ds_read_b64_tr_b16 v[70:71], v29 offset:10240
  ds_read_b64_tr_b16 v[72:73], v29 offset:32
  ds_read_b64_tr_b16 v[74:75], v29 offset:8224
  ds_read_b64_tr_b16 v[76:77], v29 offset:2080
  ds_read_b64_tr_b16 v[78:79], v29 offset:10272
L_cs19_e:
  s_waitcnt vmcnt(21)
  s_waitcnt lgkmcnt(0)
  s_barrier
  s_add_u32 s68, s51, 2097152
  s_add_u32 m0, s60, 81920
  s_nop 0
  buffer_load_dwordx4 v12, s[12:15], s68 offen  lds
  s_add_u32 s68, s51, 2129920
  s_add_u32 m0, s60, 82944
  s_nop 0
  buffer_load_dwordx4 v12, s[12:15], s68 offen  lds
  s_add_u32 s68, s51, 2162688
  s_add_u32 m0, s60, 83968
  s_nop 0
  buffer_load_dwordx4 v12, s[12:15], s68 offen  lds
  s_add_u32 s68, s51, 2195456
  s_add_u32 m0, s60, 84992
  s_nop 0
  buffer_load_dwordx4 v12, s[12:15], s68 offen  lds
  v_add_u32 v29, 98304, v13
  s_cmp_eq_u32 s46, 1
  s_cbranch_scc1 L_cs20_1
  s_cmp_eq_u32 s46, 2
  s_cbranch_scc1 L_cs20_2
  s_cmp_eq_u32 s46, 3
  s_cbranch_scc1 L_cs20_3
  ds_read_b64_tr_b16 v[96:97], v29 offset:0
  ds_read_b64_tr_b16 v[98:99], v29 offset:8192
  ds_read_b64_tr_b16 v[100:101], v29 offset:2048
  ds_read_b64_tr_b16 v[102:103], v29 offset:10240
  ds_read_b64_tr_b16 v[104:105], v29 offset:32
  ds_read_b64_tr_b16 v[106:107], v29 offset:8224
  ds_read_b64_tr_b16 v[108:109], v29 offset:2080
  ds_read_b64_tr_b16 v[110:111], v29 offset:10272
  s_branch L_cs20_e
L_cs20_1:
  ds_read_b64_tr_b16 a[88:89], v29 offset:0
  ds_read_b64_tr_b16 a[90:91], v29 offset:8192
  ds_read_b64_tr_b16 a[92:93], v29 offset:2048
  ds_read_b64_tr_b16 a[94:95], v29 offset:10240
  ds_read_b64_tr_b16 a[136:137], v29 offset:32
  ds_read_b64_tr_b16 a[138:139], v29 offset:8224
  ds_read_b64_tr_b16 a[140:141], v29 offset:2080
  ds_read_b64_tr_b16 a[142:143], v29 offset:10272
  s_branch L_cs20_e
L_cs20_2:
  ds_read_b64_tr_b16 a[104:105], v29 offset:0
  ds_read_b64_tr_b16 a[106:107], v29 offset:8192
  ds_read_b64_tr_b16 a[108:109], v29 offset:2048
  ds_read_b64_tr_b16 a[110:111], v29 offset:10240
  ds_read_b64_tr_b16 a[152:153], v29 offset:32
  ds_read_b64_tr_b16 a[154:155], v29 offset:8224
  ds_read_b64_tr_b16 a[156:157], v29 offset:2080
  ds_read_b64_tr_b16 a[158:159], v29 offset:10272
  s_branch L_cs20_e
L_cs20_3:
  ds_read_b64_tr_b16 a[120:121], v29 offset:0
  ds_read_b64_tr_b16 a[122:123], v29 offset:8192
  ds_read_b64_tr_b16 a[124:125], v29 offset:2048
  ds_read_b64_tr_b16 a[126:127], v29 offset:10240
  ds_read_b64_tr_b16 a[168:169], v29 offset:32
  ds_read_b64_tr_b16 a[170:171], v29 offset:8224
  ds_read_b64_tr_b16 a[172:173], v29 offset:2080
  ds_read_b64_tr_b16 a[174:175], v29 offset:10272
L_cs20_e:
  s_waitcnt vmcnt(21)
  s_waitcnt lgkmcnt(0)
  s_barrier
  s_add_u32 s68, s51, 3145728
  s_add_u32 m0, s60, 98304
  s_nop 0
  buffer_load_dwordx4 v12, s[12:15], s68 offen  lds
  s_add_u32 s68, s51, 3178496
  s_add_u32 m0, s60, 99328
  s_nop 0
  buffer_load_dwordx4 v12, s[12:15], s68 offen  lds
  s_add_u32 s68, s51, 3211264
  s_add_u32 m0, s60, 100352
  s_nop 0
  buffer_load_dwordx4 v12, s[12:15], s68 offen  lds
  s_add_u32 s68, s51, 3244032
  s_add_u32 m0, s60, 101376
  s_nop 0
  buffer_load_dwordx4 v12, s[12:15], s68 offen  lds
  v_add_u32 v29, 114688, v13
  s_cmp_eq_u32 s46, 1
  s_cbranch_scc1 L_cs21_1
  s_cmp_eq_u32 s46, 2
  s_cbranch_scc1 L_cs21_2
  s_cmp_eq_u32 s46, 3
  s_cbranch_scc1 L_cs21_3
  ds_read_b64_tr_b16 a[88:89], v29 offset:0
  ds_read_b64_tr_b16 a[90:91], v29 offset:8192
  ds_read_b64_tr_b16 a[92:93], v29 offset:2048
  ds_read_b64_tr_b16 a[94:95], v29 offset:10240
  ds_read_b64_tr_b16 a[136:137], v29 offset:32
  ds_read_b64_tr_b16 a[138:139], v29 offset:8224
  ds_read_b64_tr_b16 a[140:141], v29 offset:2080
  ds_read_b64_tr_b16 a[142:143], v29 offset:10272
  s_branch L_cs21_e
L_cs21_1:
  ds_read_b64_tr_b16 v[96:97], v29 offset:0
  ds_read_b64_tr_b16 v[98:99], v29 offset:8192
  ds_read_b64_tr_b16 v[100:101], v29 offset:2048
  ds_read_b64_tr_b16 v[102:103], v29 offset:10240
  ds_read_b64_tr_b16 v[104:105], v29 offset:32
  ds_read_b64_tr_b16 v[106:107], v29 offset:8224
  ds_read_b64_tr_b16 v[108:109], v29 offset:2080
  ds_read_b64_tr_b16 v[110:111], v29 offset:10272
  s_branch L_cs21_e
L_cs21_2:
  ds_read_b64_tr_b16 a[120:121], v29 offset:0
  ds_read_b64_tr_b16 a[122:123], v29 offset:8192
  ds_read_b64_tr_b16 a[124:125], v29 offset:2048
  ds_read_b64_tr_b16 a[126:127], v29 offset:10240
  ds_read_b64_tr_b16 a[168:169], v29 offset:32
  ds_read_b64_tr_b16 a[170:171], v29 offset:8224
  ds_read_b64_tr_b16 a[172:173], v29 offset:2080
  ds_read_b64_tr_b16 a[174:175], v29 offset:10272
  s_branch L_cs21_e
L_cs21_3:
  ds_read_b64_tr_b16 a[104:105], v29 offset:0
  ds_read_b64_tr_b16 a[106:107], v29 offset:8192
  ds_read_b64_tr_b16 a[108:109], v29 offset:2048
  ds_read_b64_tr_b16 a[110:111], v29 offset:10240
  ds_read_b64_tr_b16 a[152:153], v29 offset:32
  ds_read_b64_tr_b16 a[154:155], v29 offset:8224
  ds_read_b64_tr_b16 a[156:157], v29 offset:2080
  ds_read_b64_tr_b16 a[158:159], v29 offset:10272
L_cs21_e:
  s_waitcnt vmcnt(21)
  s_waitcnt lgkmcnt(0)
  s_barrier
  s_add_u32 s68, s51, 524288
  s_add_u32 m0, s60, 114688
  s_nop 0
  buffer_load_dwordx4 v12, s[12:15], s68 offen  lds
  s_add_u32 s68, s51, 557056
  s_add_u32 m0, s60, 115712
  s_nop 0
  buffer_load_dwordx4 v12, s[12:15], s68 offen  lds
  s_add_u32 s68, s51, 589824
  s_add_u32 m0, s60, 116736
  s_nop 0
  buffer_load_dwordx4 v12, s[12:15], s68 offen  lds
  s_add_u32 s68, s51, 622592
  s_add_u32 m0, s60, 117760
  s_nop 0
  buffer_load_dwordx4 v12, s[12:15], s68 offen  lds
  v_add_u32 v29, 131072, v13
  s_cmp_eq_u32 s46, 1
  s_cbranch_scc1 L_cs22_1
  s_cmp_eq_u32 s46, 2
  s_cbranch_scc1 L_cs22_2
  s_cmp_eq_u32 s46, 3
  s_cbranch_scc1 L_cs22_3
  ds_read_b64_tr_b16 a[104:105], v29 offset:0
  ds_read_b64_tr_b16 a[106:107], v29 offset:8192
  ds_read_b64_tr_b16 a[108:109], v29 offset:2048
  ds_read_b64_tr_b16 a[110:111], v29 offset:10240
  ds_read_b64_tr_b16 a[152:153], v29 offset:32
  ds_read_b64_tr_b16 a[154:155], v29 offset:8224
  ds_read_b64_tr_b16 a[156:157], v29 offset:2080
  ds_read_b64_tr_b16 a[158:159], v29 offset:10272
  s_branch L_cs22_e
L_cs22_1:
  ds_read_b64_tr_b16 a[120:121], v29 offset:0
  ds_read_b64_tr_b16 a[122:123], v29 offset:8192
  ds_read_b64_tr_b16 a[124:125], v29 offset:2048
  ds_read_b64_tr_b16 a[126:127], v29 offset:10240
  ds_read_b64_tr_b16 a[168:169], v29 offset:32
  ds_read_b64_tr_b16 a[170:171], v29 offset:8224
  ds_read_b64_tr_b16 a[172:173], v29 offset:2080
  ds_read_b64_tr_b16 a[174:175], v29 offset:10272
  s_branch L_cs22_e
L_cs22_2:
  ds_read_b64_tr_b16 v[96:97], v29 offset:0
  ds_read_b64_tr_b16 v[98:99], v29 offset:8192
  ds_read_b64_tr_b16 v[100:101], v29 offset:2048
  ds_read_b64_tr_b16 v[102:103], v29 offset:10240
  ds_read_b64_tr_b16 v[104:105], v29 offset:32
  ds_read_b64_tr_b16 v[106:107], v29 offset:8224
  ds_read_b64_tr_b16 v[108:109], v29 offset:2080
  ds_read_b64_tr_b16 v[110:111], v29 offset:10272
  s_branch L_cs22_e
L_cs22_3:
  ds_read_b64_tr_b16 a[88:89], v29 offset:0
  ds_read_b64_tr_b16 a[90:91], v29 offset:8192
  ds_read_b64_tr_b16 a[92:93], v29 offset:2048
  ds_read_b64_tr_b16 a[94:95], v29 offset:10240
  ds_read_b64_tr_b16 a[136:137], v29 offset:32
  ds_read_b64_tr_b16 a[138:139], v29 offset:8224
  ds_read_b64_tr_b16 a[140:141], v29 offset:2080
  ds_read_b64_tr_b16 a[142:143], v29 offset:10272
L_cs22_e:
  s_waitcnt vmcnt(20)
  s_waitcnt lgkmcnt(0)
  s_barrier
  s_add_u32 s68, s51, 1572864
  s_add_u32 m0, s60, 131072
  s_nop 0
  buffer_load_dwordx4 v12, s[12:15], s68 offen  lds
  s_add_u32 s68, s51, 1605632
  s_add_u32 m0, s60, 132096
  s_nop 0
  buffer_load_dwordx4 v12, s[12:15], s68 offen  lds
  s_add_u32 s68, s51, 1638400
  s_add_u32 m0, s60, 133120
  s_nop 0
  buffer_load_dwordx4 v12, s[12:15], s68 offen  lds
  s_add_u32 s68, s51, 1671168
  s_add_u32 m0, s60, 134144
  s_nop 0
  buffer_load_dwordx4 v12, s[12:15], s68 offen  lds
  v_readfirstlane_b32 s67, v17
  buffer_load_dword v18, v19, s[4:7], s64 offen sc1
  s_add_u32 m0, s60, 24576
  s_lshr_b32 m0, m0, 1
  s_add_u32 m0, m0, 12288
  s_lshl_b32 s69, s79, 10
  s_add_u32 s69, s69, s56
  buffer_load_dwordx4 v0, s[4:7], s63 offen sc1 lds
  buffer_load_dwordx4 v0, s[4:7], s63 offen offset:1024 sc1 lds
  buffer_load_dwordx4 v0, s[4:7], s69 offen sc1 lds
  v_add_u32 v29, 147456, v13
  s_cmp_eq_u32 s46, 1
  s_cbranch_scc1 L_cs23_1
  s_cmp_eq_u32 s46, 2
  s_cbranch_scc1 L_cs23_2
  s_cmp_eq_u32 s46, 3
  s_cbranch_scc1 L_cs23_3
  ds_read_b64_tr_b16 a[120:121], v29 offset:0
  ds_read_b64_tr_b16 a[122:123], v29 offset:8192
  ds_read_b64_tr_b16 a[124:125], v29 offset:2048
  ds_read_b64_tr_b16 a[126:127], v29 offset:10240
  ds_read_b64_tr_b16 a[168:169], v29 offset:32
  ds_read_b64_tr_b16 a[170:171], v29 offset:8224
  ds_read_b64_tr_b16 a[172:173], v29 offset:2080
  ds_read_b64_tr_b16 a[174:175], v29 offset:10272
  s_branch L_cs23_e
L_cs23_1:
  ds_read_b64_tr_b16 a[104:105], v29 offset:0
  ds_read_b64_tr_b16 a[106:107], v29 offset:8192
  ds_read_b64_tr_b16 a[108:109], v29 offset:2048
  ds_read_b64_tr_b16 a[110:111], v29 offset:10240
  ds_read_b64_tr_b16 a[152:153], v29 offset:32
  ds_read_b64_tr_b16 a[154:155], v29 offset:8224
  ds_read_b64_tr_b16 a[156:157], v29 offset:2080
  ds_read_b64_tr_b16 a[158:159], v29 offset:10272
  s_branch L_cs23_e
L_cs23_2:
  ds_read_b64_tr_b16 a[88:89], v29 offset:0
  ds_read_b64_tr_b16 a[90:91], v29 offset:8192
  ds_read_b64_tr_b16 a[92:93], v29 offset:2048
  ds_read_b64_tr_b16 a[94:95], v29 offset:10240
  ds_read_b64_tr_b16 a[136:137], v29 offset:32
  ds_read_b64_tr_b16 a[138:139], v29 offset:8224
  ds_read_b64_tr_b16 a[140:141], v29 offset:2080
  ds_read_b64_tr_b16 a[142:143], v29 offset:10272
  s_branch L_cs23_e
L_cs23_3:
  ds_read_b64_tr_b16 v[96:97], v29 offset:0
  ds_read_b64_tr_b16 v[98:99], v29 offset:8192
  ds_read_b64_tr_b16 v[100:101], v29 offset:2048
  ds_read_b64_tr_b16 v[102:103], v29 offset:10240
  ds_read_b64_tr_b16 v[104:105], v29 offset:32
  ds_read_b64_tr_b16 v[106:107], v29 offset:8224
  ds_read_b64_tr_b16 v[108:109], v29 offset:2080
  ds_read_b64_tr_b16 v[110:111], v29 offset:10272
L_cs23_e:
  s_waitcnt vmcnt(24)
  s_waitcnt lgkmcnt(0)
  s_barrier
  s_add_u32 s68, s51, 2621440
  s_add_u32 m0, s60, 147456
  s_nop 0
  buffer_load_dwordx4 v12, s[12:15], s68 offen  lds
  s_add_u32 s68, s51, 2654208
  s_add_u32 m0, s60, 148480
  s_nop 0
  buffer_load_dwordx4 v12, s[12:15], s68 offen  lds
  s_add_u32 s68, s51, 2686976
  s_add_u32 m0, s60, 149504
  s_nop 0
  buffer_load_dwordx4 v12, s[12:15], s68 offen  lds
  s_add_u32 s68, s51, 2719744
  s_add_u32 m0, s60, 150528
  s_nop 0
  buffer_load_dwordx4 v12, s[12:15], s68 offen  lds
  v_add_u32 v29, 0, v13
  s_cmp_eq_u32 s46, 1
  s_cbranch_scc1 L_cs24_1
  s_cmp_eq_u32 s46, 2
  s_cbranch_scc1 L_cs24_2
  s_cmp_eq_u32 s46, 3
  s_cbranch_scc1 L_cs24_3
  ds_read_b64_tr_b16 a[176:177], v29 offset:0
  ds_read_b64_tr_b16 a[178:179], v29 offset:8192
  ds_read_b64_tr_b16 a[180:181], v29 offset:2048
  ds_read_b64_tr_b16 a[182:183], v29 offset:10240
  ds_read_b64_tr_b16 a[240:241], v29 offset:32
  ds_read_b64_tr_b16 a[242:243], v29 offset:8224
  ds_read_b64_tr_b16 a[244:245], v29 offset:2080
  ds_read_b64_tr_b16 a[246:247], v29 offset:10272
  s_branch L_cs24_e
L_cs24_1:
  ds_read_b64_tr_b16 a[192:193], v29 offset:0
  ds_read_b64_tr_b16 a[194:195], v29 offset:8192
  ds_read_b64_tr_b16 a[196:197], v29 offset:2048
  ds_read_b64_tr_b16 a[198:199], v29 offset:10240
  ds_read_b64_tr_b16 v[128:129], v29 offset:32
  ds_read_b64_tr_b16 v[130:131], v29 offset:8224
  ds_read_b64_tr_b16 v[132:133], v29 offset:2080
  ds_read_b64_tr_b16 v[134:135], v29 offset:10272
  s_branch L_cs24_e
L_cs24_2:
  ds_read_b64_tr_b16 a[208:209], v29 offset:0
  ds_read_b64_tr_b16 a[210:211], v29 offset:8192
  ds_read_b64_tr_b16 a[212:213], v29 offset:2048
  ds_read_b64_tr_b16 a[214:215], v29 offset:10240
  ds_read_b64_tr_b16 v[144:145], v29 offset:32
  ds_read_b64_tr_b16 v[146:147], v29 offset:8224
  ds_read_b64_tr_b16 v[148:149], v29 offset:2080
  ds_read_b64_tr_b16 v[150:151], v29 offset:10272
  s_branch L_cs24_e
L_cs24_3:
  ds_read_b64_tr_b16 a[224:225], v29 offset:0
  ds_read_b64_tr_b16 a[226:227], v29 offset:8192
  ds_read_b64_tr_b16 a[228:229], v29 offset:2048
  ds_read_b64_tr_b16 a[230:231], v29 offset:10240
  ds_read_b64_tr_b16 v[160:161], v29 offset:32
  ds_read_b64_tr_b16 v[162:163], v29 offset:8224
  ds_read_b64_tr_b16 v[164:165], v29 offset:2080
  ds_read_b64_tr_b16 v[166:167], v29 offset:10272
L_cs24_e:
  s_waitcnt vmcnt(24)
  s_waitcnt lgkmcnt(0)
  s_barrier
  s_add_u32 s68, s51, 3670016
  s_add_u32 m0, s60, 0
  s_nop 0
  buffer_load_dwordx4 v12, s[12:15], s68 offen  lds
  s_add_u32 s68, s51, 3702784
  s_add_u32 m0, s60, 1024
  s_nop 0
  buffer_load_dwordx4 v12, s[12:15], s68 offen  lds
  s_add_u32 s68, s51, 3735552
  s_add_u32 m0, s60, 2048
  s_nop 0
  buffer_load_dwordx4 v12, s[12:15], s68 offen  lds
  s_add_u32 s68, s51, 3768320
  s_add_u32 m0, s60, 3072
  s_nop 0
  buffer_load_dwordx4 v12, s[12:15], s68 offen  lds
  v_add_u32 v29, 65536, v13
  s_cmp_eq_u32 s46, 1
  s_cbranch_scc1 L_cs25_1
  s_cmp_eq_u32 s46, 2
  s_cbranch_scc1 L_cs25_2
  s_cmp_eq_u32 s46, 3
  s_cbranch_scc1 L_cs25_3
  ds_read_b64_tr_b16 a[192:193], v29 offset:0
  ds_read_b64_tr_b16 a[194:195], v29 offset:8192
  ds_read_b64_tr_b16 a[196:197], v29 offset:2048
  ds_read_b64_tr_b16 a[198:199], v29 offset:10240
  ds_read_b64_tr_b16 v[128:129], v29 offset:32
  ds_read_b64_tr_b16 v[130:131], v29 offset:8224
  ds_read_b64_tr_b16 v[132:133], v29 offset:2080
  ds_read_b64_tr_b16 v[134:135], v29 offset:10272
  s_branch L_cs25_e
L_cs25_1:
  ds_read_b64_tr_b16 a[176:177], v29 offset:0
  ds_read_b64_tr_b16 a[178:179], v29 offset:8192
  ds_read_b64_tr_b16 a[180:181], v29 offset:2048
  ds_read_b64_tr_b16 a[182:183], v29 offset:10240
  ds_read_b64_tr_b16 a[240:241], v29 offset:32
  ds_read_b64_tr_b16 a[242:243], v29 offset:8224
  ds_read_b64_tr_b16 a[244:245], v29 offset:2080
  ds_read_b64_tr_b16 a[246:247], v29 offset:10272
  s_branch L_cs25_e
L_cs25_2:
  ds_read_b64_tr_b16 a[224:225], v29 offset:0
  ds_read_b64_tr_b16 a[226:227], v29 offset:8192
  ds_read_b64_tr_b16 a[228:229], v29 offset:2048
  ds_read_b64_tr_b16 a[230:231], v29 offset:10240
  ds_read_b64_tr_b16 v[160:161], v29 offset:32
  ds_read_b64_tr_b16 v[162:163], v29 offset:8224
  ds_read_b64_tr_b16 v[164:165], v29 offset:2080
  ds_read_b64_tr_b16 v[166:167], v29 offset:10272
  s_branch L_cs25_e
L_cs25_3:
  ds_read_b64_tr_b16 a[208:209], v29 offset:0
  ds_read_b64_tr_b16 a[210:211], v29 offset:8192
  ds_read_b64_tr_b16 a[212:213], v29 offset:2048
  ds_read_b64_tr_b16 a[214:215], v29 offset:10240
  ds_read_b64_tr_b16 v[144:145], v29 offset:32
  ds_read_b64_tr_b16 v[146:147], v29 offset:8224
  ds_read_b64_tr_b16 v[148:149], v29 offset:2080
  ds_read_b64_tr_b16 v[150:151], v29 offset:10272
L_cs25_e:
  s_waitcnt vmcnt(24)
  s_waitcnt lgkmcnt(0)
  s_barrier
  ds_write_b128 v7, v[32:35] offset:32768
  ds_write_b128 v7, v[36:39] offset:33792
  ds_write_b128 v7, v[40:43] offset:34816
  ds_write_b128 v7, v[44:47] offset:35840
  v_add_u32 v29, 81920, v13
  s_cmp_eq_u32 s46, 1
  s_cbranch_scc1 L_cs26_1
  s_cmp_eq_u32 s46, 2
  s_cbranch_scc1 L_cs26_2
  s_cmp_eq_u32 s46, 3
  s_cbranch_scc1 L_cs26_3
  ds_read_b64_tr_b16 a[208:209], v29 offset:0
  ds_read_b64_tr_b16 a[210:211], v29 offset:8192
  ds_read_b64_tr_b16 a[212:213], v29 offset:2048
  ds_read_b64_tr_b16 a[214:215], v29 offset:10240
  ds_read_b64_tr_b16 v[144:145], v29 offset:32
  ds_read_b64_tr_b16 v[146:147], v29 offset:8224
  ds_read_b64_tr_b16 v[148:149], v29 offset:2080
  ds_read_b64_tr_b16 v[150:151], v29 offset:10272
  s_branch L_cs26_e
L_cs26_1:
  ds_read_b64_tr_b16 a[224:225], v29 offset:0
  ds_read_b64_tr_b16 a[226:227], v29 offset:8192
  ds_read_b64_tr_b16 a[228:229], v29 offset:2048
  ds_read_b64_tr_b16 a[230:231], v29 offset:10240
  ds_read_b64_tr_b16 v[160:161], v29 offset:32
  ds_read_b64_tr_b16 v[162:163], v29 offset:8224
  ds_read_b64_tr_b16 v[164:165], v29 offset:2080
  ds_read_b64_tr_b16 v[166:167], v29 offset:10272
  s_branch L_cs26_e
L_cs26_2:
  ds_read_b64_tr_b16 a[176:177], v29 offset:0
  ds_read_b64_tr_b16 a[178:179], v29 offset:8192
  ds_read_b64_tr_b16 a[180:181], v29 offset:2048
  ds_read_b64_tr_b16 a[182:183], v29 offset:10240
  ds_read_b64_tr_b16 a[240:241], v29 offset:32
  ds_read_b64_tr_b16 a[242:243], v29 offset:8224
  ds_read_b64_tr_b16 a[244:245], v29 offset:2080
  ds_read_b64_tr_b16 a[246:247], v29 offset:10272
  s_branch L_cs26_e
L_cs26_3:
  ds_read_b64_tr_b16 a[192:193], v29 offset:0
  ds_read_b64_tr_b16 a[194:195], v29 offset:8192
  ds_read_b64_tr_b16 a[196:197], v29 offset:2048
  ds_read_b64_tr_b16 a[198:199], v29 offset:10240
  ds_read_b64_tr_b16 v[128:129], v29 offset:32
  ds_read_b64_tr_b16 v[130:131], v29 offset:8224
  ds_read_b64_tr_b16 v[132:133], v29 offset:2080
  ds_read_b64_tr_b16 v[134:135], v29 offset:10272
L_cs26_e:
  s_waitcnt vmcnt(20)
  s_waitcnt lgkmcnt(0)
  s_barrier
  v_mov_b32 v20, 2139193217
  v_mov_b32 v21, 2139193217
  v_mov_b32 v22, 2139193217
  v_mov_b32 v23, 2139193217
  s_add_u32 s68, s59, 245760
  buffer_store_dwordx4 v[20:23], v0, s[4:7], s68 offen sc1
  s_add_u32 s68, s59, 249856
  buffer_store_dwordx4 v[20:23], v0, s[4:7], s68 offen sc1
  s_add_u32 s68, s59, 253952
  buffer_store_dwordx4 v[20:23], v0, s[4:7], s68 offen sc1
  s_add_u32 s68, s59, 258048
  buffer_store_dwordx4 v[20:23], v0, s[4:7], s68 offen sc1
  ds_write_b128 v7, v[48:51] offset:49152
  ds_write_b128 v7, v[52:55] offset:50176
  ds_write_b128 v7, v[56:59] offset:51200
  ds_write_b128 v7, v[60:63] offset:52224
  v_add_u32 v29, 98304, v13
  s_cmp_eq_u32 s46, 1
  s_cbranch_scc1 L_cs27_1
  s_cmp_eq_u32 s46, 2
  s_cbranch_scc1 L_cs27_2
  s_cmp_eq_u32 s46, 3
  s_cbranch_scc1 L_cs27_3
  ds_read_b64_tr_b16 a[224:225], v29 offset:0
  ds_read_b64_tr_b16 a[226:227], v29 offset:8192
  ds_read_b64_tr_b16 a[228:229], v29 offset:2048
  ds_read_b64_tr_b16 a[230:231], v29 offset:10240
  ds_read_b64_tr_b16 v[160:161], v29 offset:32
  ds_read_b64_tr_b16 v[162:163], v29 offset:8224
  ds_read_b64_tr_b16 v[164:165], v29 offset:2080
  ds_read_b64_tr_b16 v[166:167], v29 offset:10272
  s_branch L_cs27_e
L_cs27_1:
  ds_read_b64_tr_b16 a[208:209], v29 offset:0
  ds_read_b64_tr_b16 a[210:211], v29 offset:8192
  ds_read_b64_tr_b16 a[212:213], v29 offset:2048
  ds_read_b64_tr_b16 a[214:215], v29 offset:10240
  ds_read_b64_tr_b16 v[144:145], v29 offset:32
  ds_read_b64_tr_b16 v[146:147], v29 offset:8224
  ds_read_b64_tr_b16 v[148:149], v29 offset:2080
  ds_read_b64_tr_b16 v[150:151], v29 offset:10272
  s_branch L_cs27_e
L_cs27_2:
  ds_read_b64_tr_b16 a[192:193], v29 offset:0
  ds_read_b64_tr_b16 a[194:195], v29 offset:8192
  ds_read_b64_tr_b16 a[196:197], v29 offset:2048
  ds_read_b64_tr_b16 a[198:199], v29 offset:10240
  ds_read_b64_tr_b16 v[128:129], v29 offset:32
  ds_read_b64_tr_b16 v[130:131], v29 offset:8224
  ds_read_b64_tr_b16 v[132:133], v29 offset:2080
  ds_read_b64_tr_b16 v[134:135], v29 offset:10272
  s_branch L_cs27_e
L_cs27_3:
  ds_read_b64_tr_b16 a[176:177], v29 offset:0
  ds_read_b64_tr_b16 a[178:179], v29 offset:8192
  ds_read_b64_tr_b16 a[180:181], v29 offset:2048
  ds_read_b64_tr_b16 a[182:183], v29 offset:10240
  ds_read_b64_tr_b16 a[240:241], v29 offset:32
  ds_read_b64_tr_b16 a[242:243], v29 offset:8224
  ds_read_b64_tr_b16 a[244:245], v29 offset:2080
  ds_read_b64_tr_b16 a[246:247], v29 offset:10272
L_cs27_e:
  s_waitcnt vmcnt(20)
  s_waitcnt lgkmcnt(0)
  s_barrier
  ds_write_b128 v8, v[64:67] offset:0
  ds_write_b128 v8, v[68:71] offset:1024
  ds_write_b128 v8, v[72:75] offset:2048
  ds_write_b128 v8, v[76:79] offset:3072
  v_add_u32 v29, 114688, v13
  s_cmp_eq_u32 s46, 1
  s_cbranch_scc1 L_cs28_1
  s_cmp_eq_u32 s46, 2
  s_cbranch_scc1 L_cs28_2
  s_cmp_eq_u32 s46, 3
  s_cbranch_scc1 L_cs28_3
  ds_read_b64_tr_b16 a[184:185], v29 offset:0
  ds_read_b64_tr_b16 a[186:187], v29 offset:8192
  ds_read_b64_tr_b16 a[188:189], v29 offset:2048
  ds_read_b64_tr_b16 a[190:191], v29 offset:10240
  ds_read_b64_tr_b16 a[248:249], v29 offset:32
  ds_read_b64_tr_b16 a[250:251], v29 offset:8224
  ds_read_b64_tr_b16 a[252:253], v29 offset:2080
  ds_read_b64_tr_b16 a[254:255], v29 offset:10272
  s_branch L_cs28_e
L_cs28_1:
  ds_read_b64_tr_b16 a[200:201], v29 offset:0
  ds_read_b64_tr_b16 a[202:203], v29 offset:8192
  ds_read_b64_tr_b16 a[204:205], v29 offset:2048
  ds_read_b64_tr_b16 a[206:207], v29 offset:10240
  ds_read_b64_tr_b16 v[136:137], v29 offset:32
  ds_read_b64_tr_b16 v[138:139], v29 offset:8224
  ds_read_b64_tr_b16 v[140:141], v29 offset:2080
  ds_read_b64_tr_b16 v[142:143], v29 offset:10272
  s_branch L_cs28_e
L_cs28_2:
  ds_read_b64_tr_b16 a[216:217], v29 offset:0
  ds_read_b64_tr_b16 a[218:219], v29 offset:8192
  ds_read_b64_tr_b16 a[220:221], v29 offset:2048
  ds_read_b64_tr_b16 a[222:223], v29 offset:10240
  ds_read_b64_tr_b16 v[152:153], v29 offset:32
  ds_read_b64_tr_b16 v[154:155], v29 offset:8224
  ds_read_b64_tr_b16 v[156:157], v29 offset:2080
  ds_read_b64_tr_b16 v[158:159], v29 offset:10272
  s_branch L_cs28_e
L_cs28_3:
  ds_read_b64_tr_b16 a[232:233], v29 offset:0
  ds_read_b64_tr_b16 a[234:235], v29 offset:8192
  ds_read_b64_tr_b16 a[236:237], v29 offset:2048
  ds_read_b64_tr_b16 a[238:239], v29 offset:10240
  ds_read_b64_tr_b16 v[168:169], v29 offset:32
  ds_read_b64_tr_b16 v[170:171], v29 offset:8224
  ds_read_b64_tr_b16 v[172:173], v29 offset:2080
  ds_read_b64_tr_b16 v[174:175], v29 offset:10272
L_cs28_e:
  s_waitcnt vmcnt(16)
  s_waitcnt lgkmcnt(0)
  s_barrier
  buffer_load_dword v27, v19, s[4:7], s64 offen sc1
  ds_write_b128 v8, v[80:83] offset:16384
  ds_write_b128 v8, v[84:87] offset:17408
  ds_write_b128 v8, v[88:91] offset:18432
  ds_write_b128 v8, v[92:95] offset:19456
  v_add_u32 v29, 131072, v13
  s_cmp_eq_u32 s46, 1
  s_cbranch_scc1 L_cs29_1
  s_cmp_eq_u32 s46, 2
  s_cbranch_scc1 L_cs29_2
  s_cmp_eq_u32 s46, 3
  s_cbranch_scc1 L_cs29_3
  ds_read_b64_tr_b16 a[200:201], v29 offset:0
  ds_read_b64_tr_b16 a[202:203], v29 offset:8192
  ds_read_b64_tr_b16 a[204:205], v29 offset:2048
  ds_read_b64_tr_b16 a[206:207], v29 offset:10240
  ds_read_b64_tr_b16 v[136:137], v29 offset:32
  ds_read_b64_tr_b16 v[138:139], v29 offset:8224
  ds_read_b64_tr_b16 v[140:141], v29 offset:2080
  ds_read_b64_tr_b16 v[142:143], v29 offset:10272
  s_branch L_cs29_e
L_cs29_1:
  ds_read_b64_tr_b16 a[184:185], v29 offset:0
  ds_read_b64_tr_b16 a[186:187], v29 offset:8192
  ds_read_b64_tr_b16 a[188:189], v29 offset:2048
  ds_read_b64_tr_b16 a[190:191], v29 offset:10240
  ds_read_b64_tr_b16 a[248:249], v29 offset:32
  ds_read_b64_tr_b16 a[250:251], v29 offset:8224
  ds_read_b64_tr_b16 a[252:253], v29 offset:2080
  ds_read_b64_tr_b16 a[254:255], v29 offset:10272
  s_branch L_cs29_e
L_cs29_2:
  ds_read_b64_tr_b16 a[232:233], v29 offset:0
  ds_read_b64_tr_b16 a[234:235], v29 offset:8192
  ds_read_b64_tr_b16 a[236:237], v29 offset:2048
  ds_read_b64_tr_b16 a[238:239], v29 offset:10240
  ds_read_b64_tr_b16 v[168:169], v29 offset:32
  ds_read_b64_tr_b16 v[170:171], v29 offset:8224
  ds_read_b64_tr_b16 v[172:173], v29 offset:2080
  ds_read_b64_tr_b16 v[174:175], v29 offset:10272
  s_branch L_cs29_e
L_cs29_3:
  ds_read_b64_tr_b16 a[216:217], v29 offset:0
  ds_read_b64_tr_b16 a[218:219], v29 offset:8192
  ds_read_b64_tr_b16 a[220:221], v29 offset:2048
  ds_read_b64_tr_b16 a[222:223], v29 offset:10240
  ds_read_b64_tr_b16 v[152:153], v29 offset:32
  ds_read_b64_tr_b16 v[154:155], v29 offset:8224
  ds_read_b64_tr_b16 v[156:157], v29 offset:2080
  ds_read_b64_tr_b16 v[158:159], v29 offset:10272
L_cs29_e:
  s_waitcnt vmcnt(9)
  s_waitcnt lgkmcnt(0)
  s_barrier
  v_cmp_ne_u32 s[98:99], 0, v18
  s_nop 0
  s_lshr_b32 s78, s98, s50
  s_and_b32 s78, s78, 3
  s_cmp_eq_u32 s78, 3
  s_cselect_b32 s78, 1, 0
  s_and_b32 s68, s67, 0xffffff
  s_cmp_eq_u32 s68, 2097408
  s_cselect_b32 s78, s78, 0
  s_lshl_b32 s68, s46, 11
  s_add_u32 m0, s68, 16384
  s_nop 0
  buffer_load_dwordx4 v0, s[4:7], s57 offen sc1 lds
  buffer_load_dwordx4 v0, s[4:7], s57 offen offset:1024 sc1 lds
  s_add_u32 m0, m0, 8192
  s_add_u32 s68, s57, 8192
  buffer_load_dwordx4 v0, s[4:7], s68 offen sc1 lds
  buffer_load_dwordx4 v0, s[4:7], s68 offen offset:1024 sc1 lds
  ds_write_b128 v8, v[96:99] offset:32768
  ds_write_b128 v8, v[100:103] offset:33792
  ds_write_b128 v8, v[104:107] offset:34816
  ds_write_b128 v8, v[108:111] offset:35840
  v_add_u32 v29, 147456, v13
  s_cmp_eq_u32 s46, 1
  s_cbranch_scc1 L_cs30_1
  s_cmp_eq_u32 s46, 2
  s_cbranch_scc1 L_cs30_2
  s_cmp_eq_u32 s46, 3
  s_cbranch_scc1 L_cs30_3
  ds_read_b64_tr_b16 a[216:217], v29 offset:0
  ds_read_b64_tr_b16 a[218:219], v29 offset:8192
  ds_read_b64_tr_b16 a[220:221], v29 offset:2048
  ds_read_b64_tr_b16 a[222:223], v29 offset:10240
  ds_read_b64_tr_b16 v[152:153], v29 offset:32
  ds_read_b64_tr_b16 v[154:155], v29 offset:8224
  ds_read_b64_tr_b16 v[156:157], v29 offset:2080
  ds_read_b64_tr_b16 v[158:159], v29 offset:10272
  s_branch L_cs30_e
L_cs30_1:
  ds_read_b64_tr_b16 a[232:233], v29 offset:0
  ds_read_b64_tr_b16 a[234:235], v29 offset:8192
  ds_read_b64_tr_b16 a[236:237], v29 offset:2048
  ds_read_b64_tr_b16 a[238:239], v29 offset:10240
  ds_read_b64_tr_b16 v[168:169], v29 offset:32
  ds_read_b64_tr_b16 v[170:171], v29 offset:8224
  ds_read_b64_tr_b16 v[172:173], v29 offset:2080
  ds_read_b64_tr_b16 v[174:175], v29 offset:10272
  s_branch L_cs30_e
L_cs30_2:
  ds_read_b64_tr_b16 a[184:185], v29 offset:0
  ds_read_b64_tr_b16 a[186:187], v29 offset:8192
  ds_read_b64_tr_b16 a[188:189], v29 offset:2048
  ds_read_b64_tr_b16 a[190:191], v29 offset:10240
  ds_read_b64_tr_b16 a[248:249], v29 offset:32
  ds_read_b64_tr_b16 a[250:251], v29 offset:8224
  ds_read_b64_tr_b16 a[252:253], v29 offset:2080
  ds_read_b64_tr_b16 a[254:255], v29 offset:10272
  s_branch L_cs30_e
L_cs30_3:
  ds_read_b64_tr_b16 a[200:201], v29 offset:0
  ds_read_b64_tr_b16 a[202:203], v29 offset:8192
  ds_read_b64_tr_b16 a[204:205], v29 offset:2048
  ds_read_b64_tr_b16 a[206:207], v29 offset:10240
  ds_read_b64_tr_b16 v[136:137], v29 offset:32
  ds_read_b64_tr_b16 v[138:139], v29 offset:8224
  ds_read_b64_tr_b16 v[140:141], v29 offset:2080
  ds_read_b64_tr_b16 v[142:143], v29 offset:10272
L_cs30_e:
  s_waitcnt vmcnt(9)
  s_waitcnt lgkmcnt(0)
  s_barrier
  ds_write_b128 v8, v[112:115] offset:49152
  ds_write_b128 v8, v[116:119] offset:50176
  ds_write_b128 v8, v[120:123] offset:51200
  ds_write_b128 v8, v[124:127] offset:52224
  v_add_u32 v29, 0, v13
  s_cmp_eq_u32 s46, 1
  s_cbranch_scc1 L_cs31_1
  s_cmp_eq_u32 s46, 2
  s_cbranch_scc1 L_cs31_2
  s_cmp_eq_u32 s46, 3
  s_cbranch_scc1 L_cs31_3
  ds_read_b64_tr_b16 a[232:233], v29 offset:0
  ds_read_b64_tr_b16 a[234:235], v29 offset:8192
  ds_read_b64_tr_b16 a[236:237], v29 offset:2048
  ds_read_b64_tr_b16 a[238:239], v29 offset:10240
  ds_read_b64_tr_b16 v[168:169], v29 offset:32
  ds_read_b64_tr_b16 v[170:171], v29 offset:8224
  ds_read_b64_tr_b16 v[172:173], v29 offset:2080
  ds_read_b64_tr_b16 v[174:175], v29 offset:10272
  s_branch L_cs31_e
L_cs31_1:
  ds_read_b64_tr_b16 a[216:217], v29 offset:0
  ds_read_b64_tr_b16 a[218:219], v29 offset:8192
  ds_read_b64_tr_b16 a[220:221], v29 offset:2048
  ds_read_b64_tr_b16 a[222:223], v29 offset:10240
  ds_read_b64_tr_b16 v[152:153], v29 offset:32
  ds_read_b64_tr_b16 v[154:155], v29 offset:8224
  ds_read_b64_tr_b16 v[156:157], v29 offset:2080
  ds_read_b64_tr_b16 v[158:159], v29 offset:10272
  s_branch L_cs31_e
L_cs31_2:
  ds_read_b64_tr_b16 a[200:201], v29 offset:0
  ds_read_b64_tr_b16 a[202:203], v29 offset:8192
  ds_read_b64_tr_b16 a[204:205], v29 offset:2048
  ds_read_b64_tr_b16 a[206:207], v29 offset:10240
  ds_read_b64_tr_b16 v[136:137], v29 offset:32
  ds_read_b64_tr_b16 v[138:139], v29 offset:8224
  ds_read_b64_tr_b16 v[140:141], v29 offset:2080
  ds_read_b64_tr_b16 v[142:143], v29 offset:10272
  s_branch L_cs31_e
L_cs31_3:
  ds_read_b64_tr_b16 a[184:185], v29 offset:0
  ds_read_b64_tr_b16 a[186:187], v29 offset:8192
  ds_read_b64_tr_b16 a[188:189], v29 offset:2048
  ds_read_b64_tr_b16 a[190:191], v29 offset:10240
  ds_read_b64_tr_b16 a[248:249], v29 offset:32
  ds_read_b64_tr_b16 a[250:251], v29 offset:8224
  ds_read_b64_tr_b16 a[252:253], v29 offset:2080
  ds_read_b64_tr_b16 a[254:255], v29 offset:10272
L_cs31_e:
  s_waitcnt lgkmcnt(0)
  s_cmp_lg_u32 s78, 0
  s_cbranch_scc1 L_cs_ready
  s_and_b32 s68, s67, 0xffffff
  s_cmp_eq_u32 s68, 2097408
  s_cbranch_scc1 L_cs_p3
L_cs_p1:
  s_sleep 8
  buffer_load_dword v28, off, s[8:11], 0 offset:128 sc1
  s_sub_u32 s49, s49, 1
  s_cbranch_scc1 L_end
  s_waitcnt vmcnt(0)
  v_readfirstlane_b32 s67, v28
  s_nop 0
  s_and_b32 s68, s67, 0xffffff
  s_cmp_eq_u32 s68, 2097408
  s_cbranch_scc0 L_cs_p1
L_cs_p2:
  s_sleep 4
  buffer_load_dword v27, v19, s[4:7], s64 offen sc1
  s_sub_u32 s49, s49, 1
  s_cbranch_scc1 L_end
L_cs_p3:
  s_waitcnt vmcnt(0)
  v_cmp_ne_u32 s[98:99], 0, v27
  s_nop 0
  s_lshr_b32 s68, s98, s50
  s_and_b32 s68, s68, 3
  s_cmp_eq_u32 s68, 3
  s_cbranch_scc0 L_cs_p2
  s_lshl_b32 s68, s46, 11
  s_add_u32 m0, s68, 16384
  s_nop 0
  buffer_load_dwordx4 v0, s[4:7], s57 offen sc1 lds
  buffer_load_dwordx4 v0, s[4:7], s57 offen offset:1024 sc1 lds
L_cs_ready:
  v_mov_b32 v17, 0
  v_mov_b32 v18, 0
  s_add_u32 s38, s50, 1
  s_cmp_eq_u32 s16, 0
  s_cselect_b32 s39, 255, 0
  s_lshl_b32 s68, s50, 12
  s_add_u32 s59, s59, s68
  s_and_b32 s68, s50, 2
  s_lshl_b32 s68, s68, 13
  v_xor_b32 v2, s68, v2
  s_mov_b32 s66, 0
  s_and_b32 s68, s50, 3
  s_lshl_b32 s68, s68, 13
  s_add_u32 s51, s68, s56
  s_add_u32 s60, s51, 4096
  s_and_b32 s68, s68, 0x2000
  s_add_u32 s3, s61, s68
  s_lshl_b32 s53, s68, 1
  s_sub_u32 s96, s57, s66
  s_add_u32 s96, s96, -8192
  s_add_u32 s57, s57, 24576
  s_add_u32 s97, s57, 8192
  s_xor_b32 s68, s66, 0x2000
  s_add_u32 m0, s68, s55
  s_cmp_gt_u32 s50, s38
  s_cselect_b32 s68, 4096, 0
  s_add_u32 s59, s59, s68
  s_add_u32 s17, s50, 1
  s_max_u32 s52, s50, 1
  s_sub_u32 s52, s52, 1
  s_and_b32 s100, s17, 1
  ds_read_b128 v[88:91], v8 offset:2048
  v_mov_b64 v[64:65], 0
  v_mov_b64 v[66:67], 0
  ds_read_b128 v[92:95], v8 offset:3072
  v_mov_b64 v[68:69], 0
  v_mov_b64 v[70:71], 0
  ds_read_b128 v[96:99], v8 offset:16384
  v_mov_b64 v[72:73], 0
  v_mov_b64 v[74:75], 0
  ds_read_b128 v[100:103], v8 offset:17408
  v_mov_b64 v[76:77], 0
  v_mov_b64 v[78:79], 0
  ds_read_b128 v[104:107], v8 offset:18432
  v_mov_b64 v[80:81], 0
  v_mov_b64 v[82:83], 0
  ds_read_b128 v[108:111], v8 offset:19456
  v_mov_b64 v[84:85], 0
  v_mov_b64 v[86:87], 0
  ds_read_b128 v[112:115], v8 offset:32768
  v_lshlrev_b32 v19, 1, v0
  v_mov_b32 v28, s52
  ds_read_b128 v[116:119], v8 offset:33792
  ds_read_b128 v[120:123], v8 offset:34816
  ds_read_b128 v[124:127], v8 offset:35840
  buffer_load_dwordx4 v[32:35], v9, s[4:7], s51 offen sc1
  buffer_load_dwordx4 v[36:39], v9, s[4:7], s60 offen sc1
  ds_read_b128 v[40:43], v7 offset:49152
  v_xor_b32 v2, s53, v2
  ds_read_b128 v[44:47], v7 offset:50176
  v_xor_b32 v29, 1024, v9
  ds_read_b128 v[48:51], v7 offset:51200
  v_xor_b32 v30, 2048, v9
  ds_read_b128 v[52:55], v7 offset:52224
  v_xor_b32 v31, 3072, v9
  ds_read_b128 v[56:59], v8 offset:0
  ds_read_b128 v[60:63], v8 offset:1024
  s_waitcnt vmcnt(0) lgkmcnt(0)
  s_barrier
  s_lshr_b32 s68, s67, 24
  s_mov_b32 s67, 0
  s_or_b32 s68, s68, s16
  s_cbranch_scc1 L_step_s
  s_branch L_step_f
.p2align 8
  s_nop 0
  s_nop 0
  s_nop 0
  s_nop 0
  s_nop 0
  s_nop 0
  s_nop 0
  s_nop 0

L_step_f:
  s_waitcnt vmcnt(2)
L_chkE_f:
  v_max3_u32 v16, v32, v33, v34
  v_max_u32 v16, v16, v35
  v_cmp_eq_u32 vcc, -1, v16
  ds_write_b128 v9, v[32:35]
  s_cbranch_vccnz L_retE_f
L_okE_f:
  v_smfmac_f32_16x16x64_bf16 v[64:67], v[32:35], v[40:47], v10
  buffer_load_dwordx4 v[36:39], v9, s[4:7], s60 offen sc1
L_okE2_f:
  v_smfmac_f32_16x16x64_bf16 v[68:71], v[32:35], v[48:55], v10
  v_smfmac_f32_16x16x64_bf16 v[72:75], v[32:35], v[56:63], v10
  s_waitcnt lgkmcnt(0)
  s_barrier
  ds_read_b128 v[40:43], v29 offset:0
  ds_read_b128 v[48:51], v30 offset:0
  v_smfmac_f32_16x16x64_bf16 v[76:79], v[32:35], v[88:95], v10
  ds_read_b128 v[56:59], v31 offset:0
  s_waitcnt vmcnt(1)
  v_max3_u32 v16, v36, v37, v38
  v_smfmac_f32_16x16x64_bf16 v[80:83], v[32:35], a[176:183], v10
  v_max_u32 v16, v16, v39
  v_smfmac_f32_16x16x64_bf16 v[84:87], v[32:35], a[240:247], v10
  v_cmp_eq_u32 vcc, -1, v16
  ds_write_b128 v9, v[36:39] offset:4096
  s_cbranch_vccnz L_retL_f
L_okL_f:
  v_smfmac_f32_16x16x64_bf16 v[64:67], v[36:39], v[96:103], v10
  v_smfmac_f32_16x16x64_bf16 v[68:71], v[36:39], v[104:111], v10
  buffer_load_dwordx4 v[20:23], v5, s[4:7], s96 offen sc1
  v_smfmac_f32_16x16x64_bf16 v[72:75], v[36:39], v[112:119], v10
  ds_read_b128 v[88:91], v8 offset:49152
  v_smfmac_f32_16x16x64_bf16 v[76:79], v[36:39], v[120:127], v10
  ds_read_b128 v[92:95], v8 offset:50176
  s_waitcnt lgkmcnt(3)
  v_smfmac_f32_16x16x64_bf16 v[64:67], v[40:43], a[0:7], v10
  buffer_load_dwordx4 v[24:27], v5, s[4:7], s96 offen offset:256 sc1
  ds_read_b128 v[96:99], v8 offset:51200
  v_smfmac_f32_16x16x64_bf16 v[68:71], v[40:43], a[32:39], v10
  s_waitcnt lgkmcnt(3)
  v_smfmac_f32_16x16x64_bf16 v[72:75], v[40:43], a[80:87], v10
  s_barrier
  v_smfmac_f32_16x16x64_bf16 v[76:79], v[40:43], a[128:135], v10
  buffer_load_dwordx4 v0, s[4:7], s57 offen sc1 lds
  ds_read_b128 v[44:47], v29 offset:4096
  v_smfmac_f32_16x16x64_bf16 v[64:67], v[48:51], a[16:23], v10
  ds_read_b128 v[52:55], v30 offset:4096
  v_smfmac_f32_16x16x64_bf16 v[68:71], v[48:51], a[48:55], v10
  ds_read_b128 v[60:63], v31 offset:4096
  v_lshrrev_b32 v31, 2, v0
  v_smfmac_f32_16x16x64_bf16 v[72:75], v[48:51], a[96:103], v10
  v_smfmac_f32_16x16x64_bf16 v[76:79], v[48:51], a[144:151], v10
  buffer_load_dwordx4 v0, s[4:7], s57 offen offset:1024 sc1 lds
  s_movk_i32 m0, 14592
  ds_read_b128 v[100:103], v8 offset:52224
  v_smfmac_f32_16x16x64_bf16 v[64:67], v[56:59], a[24:31], v10
  ds_read_b128 v[104:107], v5 offset:0
  v_smfmac_f32_16x16x64_bf16 v[68:71], v[56:59], a[64:71], v10
  ds_read_b128 v[108:111], v5 offset:2048
  v_smfmac_f32_16x16x64_bf16 v[72:75], v[56:59], a[112:119], v10
  buffer_load_dword v19, s[4:7], s97 offen sc1 lds
  v_smfmac_f32_16x16x64_bf16 v[76:79], v[56:59], a[160:167], v10
  ds_read_b128 v[112:115], v5 offset:4096
  s_waitcnt lgkmcnt(3)
  v_smfmac_f32_16x16x64_bf16 v[64:67], v[44:47], a[8:15], v10
  ds_read_b128 v[116:119], v5 offset:6144
  v_smfmac_f32_16x16x64_bf16 v[64:67], v[52:55], v[88:95], v10
  buffer_store_dwordx4 v[12:15], v0, s[4:7], s59 offen sc1
  ds_read_b128 v[120:123], v5 offset:256
  v_smfmac_f32_16x16x64_bf16 v[64:67], v[60:63], v[96:103], v10
  ds_read_b128 v[124:127], v5 offset:2304
  v_smfmac_f32_16x16x64_bf16 v[68:71], v[44:47], a[40:47], v10
  s_waitcnt vmcnt(4)
  s_nop 0
  v_smfmac_f32_16x16x64_bf16 v[68:71], v[52:55], a[56:63], v10
  buffer_load_dword v31, v31, s[4:7], s64 offen sc1
  v_smfmac_f32_16x16x64_bf16 v[68:71], v[60:63], a[72:79], v10
  s_nop 0
  v_add_f32 v64, v64, v65
  v_smfmac_f32_16x16x64_bf16 v[72:75], v[44:47], a[88:95], v10
  s_nop 0
  v_add_f32 v66, v66, v67
  v_smfmac_f32_16x16x64_bf16 v[72:75], v[52:55], a[104:111], v10
  s_mov_b64 exec, 1
  buffer_store_dword v28, off, s[4:7], s65 sc1
  s_mov_b64 exec, -1
  v_cvt_pk_bf16_f32 v65, v64, v66
  v_smfmac_f32_16x16x64_bf16 v[72:75], v[60:63], a[120:127], v10
  v_add_f32 v68, v68, v69
  v_smfmac_f32_16x16x64_bf16 v[76:79], v[44:47], a[136:143], v10
  s_nop 0
  v_add_f32 v70, v70, v71
  v_smfmac_f32_16x16x64_bf16 v[76:79], v[52:55], a[152:159], v10
  s_nop 0
  v_cvt_pk_bf16_f32 v69, v68, v70
  v_smfmac_f32_16x16x64_bf16 v[76:79], v[60:63], a[168:175], v10
  ds_write2_b32 v3, v65, v69 offset0:0 offset1:32
  v_add_f32 v72, v72, v73
  v_smfmac_f32_16x16x64_bf16 v[80:83], v[36:39], a[184:191], v10
  s_nop 0
  v_add_f32 v74, v74, v75
  v_smfmac_f32_16x16x64_bf16 v[84:87], v[36:39], a[248:255], v10
  s_nop 0
  v_cvt_pk_bf16_f32 v12, v72, v74
  v_add_f32 v76, v76, v77
  v_smfmac_f32_16x16x64_bf16 v[80:83], v[40:43], a[192:199], v10
  v_add_f32 v78, v78, v79
  v_cvt_pk_bf16_f32 v13, v76, v78
  v_smfmac_f32_16x16x64_bf16 v[84:87], v[40:43], v[128:135], v10
  ds_write2_b32 v3, v12, v13 offset0:1 offset1:33
  v_mov_b64 v[32:33], 0
  v_smfmac_f32_16x16x64_bf16 v[80:83], v[44:47], a[200:207], v10
  v_mov_b64 v[34:35], 0
  v_smfmac_f32_16x16x64_bf16 v[84:87], v[44:47], v[136:143], v10
  v_mov_b64 v[36:37], 0
  v_smfmac_f32_16x16x64_bf16 v[80:83], v[48:51], a[208:215], v10
  v_mov_b64 v[38:39], 0
  v_smfmac_f32_16x16x64_bf16 v[84:87], v[48:51], v[144:151], v10
  s_waitcnt lgkmcnt(0)
  v_mov_b64 v[40:41], 0
  v_smfmac_f32_16x16x64_bf16 v[80:83], v[52:55], a[216:223], v10
  s_barrier
  v_smfmac_f32_16x16x64_bf16 v[84:87], v[52:55], v[152:159], v10
  ds_read_b64_tr_b16 v[88:89], v4 offset:0
  ds_read_b64_tr_b16 v[90:91], v4 offset:64
  v_mov_b64 v[42:43], 0
  v_smfmac_f32_16x16x64_bf16 v[80:83], v[56:59], a[224:231], v10
  ds_read_b64_tr_b16 v[92:93], v4 offset:256
  v_mov_b64 v[44:45], 0
  v_smfmac_f32_16x16x64_bf16 v[80:83], v[60:63], a[232:239], v10
  ds_read_b64_tr_b16 v[94:95], v4 offset:320
  v_mov_b64 v[46:47], 0
  v_smfmac_f32_16x16x64_bf16 v[84:87], v[56:59], v[160:167], v10
  ds_read_b64_tr_b16 v[96:97], v4 offset:512
  v_mov_b64 v[48:49], 0
  v_smfmac_f32_16x16x64_bf16 v[84:87], v[60:63], v[168:175], v10
  ds_read_b64_tr_b16 v[98:99], v4 offset:576
  s_waitcnt lgkmcnt(4)
  v_mov_b64 v[50:51], 0
  v_mfma_f32_16x16x32_bf16 v[64:67], v[104:107], v[88:91], 0
  ds_read_b64_tr_b16 v[100:101], v4 offset:768
  v_mov_b64 v[52:53], 0
  v_mfma_f32_16x16x32_bf16 v[68:71], v[120:123], v[88:91], 0
  ds_read_b64_tr_b16 v[102:103], v4 offset:832
  v_mov_b64 v[54:55], 0
  v_mfma_f32_16x16x32_bf16 v[72:75], v[88:91], v[88:91], 0
  s_waitcnt lgkmcnt(4)
  v_add_f32 v80, v80, v81
  v_mfma_f32_16x16x32_bf16 v[64:67], v[108:111], v[92:95], v[64:67]
  ds_read_b128 v[104:107], v5 offset:4352
  v_add_f32 v82, v82, v83
  v_mfma_f32_16x16x32_bf16 v[68:71], v[124:127], v[92:95], v[68:71]
  ds_read_b128 v[108:111], v5 offset:6400
  v_cvt_pk_bf16_f32 v14, v80, v82
  v_mfma_f32_16x16x32_bf16 v[72:75], v[92:95], v[92:95], v[72:75]
  s_waitcnt lgkmcnt(2)
  v_add_f32 v84, v84, v85
  v_mfma_f32_16x16x32_bf16 v[64:67], v[112:115], v[96:99], v[64:67]
  v_add_f32 v86, v86, v87
  v_cvt_pk_bf16_f32 v15, v84, v86
  v_mfma_f32_16x16x32_bf16 v[64:67], v[116:119], v[100:103], v[64:67]
  v_mov_b64 v[56:57], 0
  v_mov_b64 v[58:59], 0
  v_mfma_f32_16x16x32_bf16 v[72:75], v[96:99], v[96:99], v[72:75]
  v_mov_b64 v[60:61], 0
  v_mov_b64 v[62:63], 0
  v_mfma_f32_16x16x32_bf16 v[72:75], v[100:103], v[100:103], v[72:75]
  s_waitcnt lgkmcnt(0)
  s_nop 1
  v_mfma_f32_16x16x32_bf16 v[68:71], v[104:107], v[96:99], v[68:71]
  v_max3_f32 v28, v64, v65, v66
  v_mfma_f32_16x16x32_bf16 v[68:71], v[108:111], v[100:103], v[68:71]
  ds_read_b128 v[104:107], v7 offset:0
  s_add_u32 s50, s50, 1
  ds_read_b128 v[108:111], v7 offset:1024
  s_mov_b32 s54, s100
  ds_read_b128 v[112:115], v7 offset:2048
  ds_read_b128 v[116:119], v7 offset:3072
  v_max3_f32 v28, v28, v67, v74
  v_max_f32 v28, v28, v75
  v_max3_f32 v28, v28, v68, v69
  v_max3_f32 v28, v28, v70, v71
  v_mov_b32 v29, v28
  s_xor_b32 s66, s66, 0x2000
  v_xor_b32 v5, 0x2000, v5
  v_permlane32_swap_b32 v28, v29
  v_max_f32 v28, v28, v29
  v_mov_b32 v29, v28
  s_nop 1
  v_permlane16_swap_b32 v28, v29
  v_max_f32 v28, v28, v29
  v_mul_f32 v28, s58, v28
  v_pk_fma_f32 v[64:65], v[64:65], s[58:59], v[28:29] op_sel_hi:[1,0,0] neg_lo:[0,0,1] neg_hi:[0,0,1]
  v_pk_fma_f32 v[66:67], v[66:67], s[58:59], v[28:29] op_sel_hi:[1,0,0] neg_lo:[0,0,1] neg_hi:[0,0,1]
  v_pk_fma_f32 v[68:69], v[68:69], s[58:59], v[28:29] op_sel_hi:[1,0,0] neg_lo:[0,0,1] neg_hi:[0,0,1]
  v_pk_fma_f32 v[70:71], v[70:71], s[58:59], v[28:29] op_sel_hi:[1,0,0] neg_lo:[0,0,1] neg_hi:[0,0,1]
  v_pk_fma_f32 v[74:75], v[74:75], s[58:59], v[28:29] op_sel_hi:[1,0,0] neg_lo:[0,0,1] neg_hi:[0,0,1]
  v_exp_f32 v64, v64
  v_exp_f32 v65, v65
  v_exp_f32 v66, v66
  v_exp_f32 v67, v67
  v_exp_f32 v68, v68
  v_exp_f32 v69, v69
  v_exp_f32 v70, v70
  v_exp_f32 v71, v71
  v_exp_f32 v74, v74
  v_exp_f32 v75, v75
  v_cvt_pk_bf16_f32 v76, v64, v65
  v_cvt_pk_bf16_f32 v77, v66, v67
  v_cvt_pk_bf16_f32 v78, v68, v69
  v_cvt_pk_bf16_f32 v79, v70, v71
  v_cvt_pk_bf16_f32 v16, v74, v75
  v_cvt_pk_bf16_f32 v19, v74, v75
  v_pk_add_f32 v[64:65], v[64:65], v[66:67]
  v_pk_add_f32 v[68:69], v[68:69], v[70:71]
  v_pk_add_f32 v[64:65], v[64:65], v[74:75]
  v_pk_add_f32 v[28:29], v[64:65], v[68:69]
  v_mfma_f32_16x16x32_bf16 v[120:123], v[20:23], v[76:79], 0
  v_add_f32 v28, v28, v29
  v_mov_b32 v29, v28
  v_mfma_f32_16x16x32_bf16 v[124:127], v[24:27], v[76:79], 0
  s_nop 0
  v_permlane32_swap_b32 v28, v29
  v_mfma_f32_16x16x16_bf16 v[120:123], v[14:15], v[16:17], v[120:123]
  v_add_f32 v28, v28, v29
  v_mov_b32 v29, v28
  v_mfma_f32_16x16x16_bf16 v[124:127], v[14:15], v[18:19], v[124:127]
  s_nop 0
  v_permlane16_swap_b32 v28, v29
  v_add_f32 v28, v28, v29
  v_rcp_f32 v28, v28
  s_nop 0
  v_pk_mul_f32 v[120:121], v[120:121], v[28:29] op_sel_hi:[1,0]
  v_pk_mul_f32 v[122:123], v[122:123], v[28:29] op_sel_hi:[1,0]
  s_nop 0
  v_pk_mul_f32 v[124:125], v[124:125], v[28:29] op_sel_hi:[1,0]
  v_pk_mul_f32 v[126:127], v[126:127], v[28:29] op_sel_hi:[1,0]
  v_cvt_pk_bf16_f32 v120, v120, v121
  v_cvt_pk_bf16_f32 v121, v122, v123
  v_cvt_pk_bf16_f32 v122, v124, v125
  v_cvt_pk_bf16_f32 v123, v126, v127
  ds_write_b128 v6, v[120:123]
  s_waitcnt lgkmcnt(0)
  s_barrier
  ds_read_b128 v[80:83], v0 offset:12544
  ds_read_b128 v[84:87], v0 offset:13568
  s_waitcnt lgkmcnt(1)
  v_smfmac_f32_16x16x64_bf16 v[32:35], v[80:83], v[176:183], v10
  s_nop 0
  s_waitcnt lgkmcnt(0)
  v_smfmac_f32_16x16x64_bf16 v[32:35], v[84:87], v[184:191], v10
  ds_read_b128 v[88:91], v7 offset:16384
  s_nop 0
  v_smfmac_f32_16x16x64_bf16 v[36:39], v[80:83], v[192:199], v10
  ds_read_b128 v[92:95], v7 offset:17408
  s_nop 0
  v_smfmac_f32_16x16x64_bf16 v[36:39], v[84:87], v[200:207], v10
  ds_read_b128 v[96:99], v7 offset:18432
  s_nop 0
  v_smfmac_f32_16x16x64_bf16 v[40:43], v[80:83], v[208:215], v10
  ds_read_b128 v[100:103], v7 offset:19456
  v_add_f32 v32, v32, v33
  v_smfmac_f32_16x16x64_bf16 v[40:43], v[84:87], v[216:223], v10
  ds_read_b128 v[64:67], v7 offset:32768
  v_add_f32 v34, v34, v35
  v_cvt_pk_bf16_f32 v120, v32, v34
  v_smfmac_f32_16x16x64_bf16 v[44:47], v[80:83], v[224:231], v10
  ds_read_b128 v[68:71], v7 offset:33792
  v_add_f32 v36, v36, v37
  v_and_or_b32 v120, v120, -2, s54
  v_smfmac_f32_16x16x64_bf16 v[44:47], v[84:87], v[232:239], v10
  ds_read_b128 v[72:75], v7 offset:34816
  v_add_f32 v38, v38, v39
  v_cvt_pk_bf16_f32 v121, v36, v38
  v_smfmac_f32_16x16x64_bf16 v[48:51], v[80:83], v[240:247], v10
  ds_read_b128 v[76:79], v7 offset:35840
  v_add_f32 v40, v40, v41
  v_smfmac_f32_16x16x64_bf16 v[48:51], v[84:87], v[248:255], v10
  v_add_f32 v42, v42, v43
  v_cvt_pk_bf16_f32 v122, v40, v42
  v_smfmac_f32_16x16x64_bf16 v[52:55], v[80:83], v[104:111], v10
  v_add_f32 v44, v44, v45
  v_and_or_b32 v122, v122, -2, s54
  v_smfmac_f32_16x16x64_bf16 v[52:55], v[84:87], v[112:119], v10
  s_waitcnt lgkmcnt(6)
  v_add_f32 v46, v46, v47
  v_cvt_pk_bf16_f32 v123, v44, v46
  v_smfmac_f32_16x16x64_bf16 v[56:59], v[80:83], v[88:95], v10
  buffer_store_dwordx4 v[120:123], v1, s[4:7], s62 offen offset:0
  s_waitcnt lgkmcnt(4)
  v_add_f32 v48, v48, v49
  v_smfmac_f32_16x16x64_bf16 v[56:59], v[84:87], v[96:103], v10
  s_waitcnt lgkmcnt(2)
  v_add_f32 v50, v50, v51
  v_cvt_pk_bf16_f32 v124, v48, v50
  v_smfmac_f32_16x16x64_bf16 v[60:63], v[80:83], v[64:71], v10
  s_waitcnt lgkmcnt(0)
  v_add_f32 v52, v52, v53
  v_and_or_b32 v124, v124, -2, s54
  v_smfmac_f32_16x16x64_bf16 v[60:63], v[84:87], v[72:79], v10
  v_add_f32 v54, v54, v55
  v_cvt_pk_bf16_f32 v125, v52, v54
  v_add_f32 v56, v56, v57
  v_add_f32 v58, v58, v59
  v_cvt_pk_bf16_f32 v126, v56, v58
  v_and_or_b32 v126, v126, -2, s54
  s_nop 1
  v_add_f32 v60, v60, v61
  v_add_f32 v62, v62, v63
  v_cvt_pk_bf16_f32 v127, v60, v62
  buffer_store_dwordx4 v[124:127], v1, s[4:7], s62 offen offset:2048
  s_bitcmp1_b32 s46, 0
  s_cbranch_scc1 L_x1_f
  s_and_b32 s68, s50, 3
  s_lshl_b32 s68, s68, 13
  s_add_u32 s51, s68, s56
  s_add_u32 s60, s51, 4096
  s_and_b32 s68, s68, 0x2000
  s_add_u32 s3, s61, s68
  s_lshl_b32 s53, s68, 1
  s_sub_u32 s96, s57, s66
  s_add_u32 s96, s96, -8192
  s_add_u32 s57, s57, 24576
  s_add_u32 s97, s57, 8192
  s_xor_b32 s68, s66, 0x2000
  s_add_u32 m0, s68, s55
  s_cmp_gt_u32 s50, s38
  s_cselect_b32 s68, 4096, 0
  s_add_u32 s59, s59, s68
  s_add_u32 s17, s50, 1
  s_max_u32 s52, s50, 1
  s_sub_u32 s52, s52, 1
  s_and_b32 s100, s17, 1
  v_cndmask_b32 v52, 0, v11, s[70:71]
  v_cndmask_b32 v53, 0, v11, s[72:73]
  v_cndmask_b32 v54, 0, v11, s[74:75]
  v_cndmask_b32 v55, 0, v11, s[76:77]
  s_nop 15
  s_nop 15
  s_nop 0
  buffer_load_dwordx4 v[40:43], v0, s[4:7], s63 offen sc1
  buffer_load_dwordx4 v[44:47], v0, s[4:7], s63 offen offset:1024 sc1
  ds_read_b128 v[88:91], v8 offset:2048
  ds_read_b128 v[92:95], v8 offset:3072
  ds_read_b128 v[96:99], v8 offset:16384
  ds_read_b128 v[100:103], v8 offset:17408
  ds_read_b128 v[104:107], v8 offset:18432
  ds_read_b128 v[108:111], v8 offset:19456
  ds_read_b128 v[112:115], v8 offset:32768
  ds_read_b128 v[116:119], v8 offset:33792
  ds_read_b128 v[120:123], v8 offset:34816
  ds_read_b128 v[124:127], v8 offset:35840
  s_nop 14
  buffer_load_dwordx4 v[56:59], v0, s[4:7], s63 offen sc1
  buffer_load_dwordx4 v[60:63], v0, s[4:7], s63 offen offset:1024 sc1
  s_mov_b32 s67, 0
L_redQ0_f:
  s_waitcnt vmcnt(3)
L_redP0_f:
  v_mfma_f32_16x16x32_bf16 v[48:51], v[40:43], v[52:55], 0
  s_waitcnt vmcnt(2)
  v_mfma_f32_16x16x32_bf16 v[48:51], v[44:47], v[52:55], v[48:51]
  v_xor_b32 v16, s54, v40
  v_bitop3_b32 v16, v16, v42, s54 bitop3:0xf6
  v_bitop3_b32 v16, v16, v44, s54 bitop3:0xf6
  v_bitop3_b32 v16, v16, v46, s54 bitop3:0xf6
  v_and_b32 v16, 1, v16
  v_cmp_ne_u32 vcc, 0, v16
  v_cmp_ne_u32 s[98:99], 0, v31
  s_nop 0
  v_permlane32_swap_b32 v48, v50
  v_permlane32_swap_b32 v49, v51
  v_add_f32 v48, v48, v50
  v_add_f32 v49, v49, v51
  s_cbranch_vccnz L_reP0_f
  s_nop 0
  v_permlane16_swap_b32 v48, v49
  v_add_f32 v48, v48, v49
  s_nop 1
  v_mov_b32_dpp v49, v48 quad_perm:[2,3,0,1] row_mask:0xf bank_mask:0xf
  v_cvt_pk_bf16_f32 v48, v48, v49
  v_min_u32 v48, -2, v48
  v_cndmask_b32 v24, v48, -1, s[18:19]
  buffer_store_dword v24, v2, s[4:7], s3 offen
L_pub0_f:
  s_waitcnt vmcnt(1)
  ds_read_b128 v[40:43], v7 offset:49152
  v_xor_b32 v2, s53, v2
  ds_read_b128 v[44:47], v7 offset:50176
  v_xor_b32 v29, 1024, v9
  ds_read_b128 v[48:51], v7 offset:51200
  v_xor_b32 v30, 2048, v9
  ds_read_b128 v[52:55], v7 offset:52224
  v_xor_b32 v31, 3072, v9
  ds_read_b128 v[56:59], v8 offset:0
  ds_read_b128 v[60:63], v8 offset:1024
  s_nop 15
  s_nop 15
  s_nop 9
L_ep0_f:
  buffer_load_dwordx4 v[32:35], v9, s[4:7], s51 offen sc1
  v_mov_b64 v[64:65], 0
  v_mov_b64 v[66:67], 0
  v_mov_b64 v[68:69], 0
  v_mov_b64 v[70:71], 0
  v_mov_b64 v[72:73], 0
  v_mov_b64 v[74:75], 0
  v_mov_b64 v[76:77], 0
  v_mov_b64 v[78:79], 0
  v_mov_b64 v[80:81], 0
  v_mov_b64 v[82:83], 0
  v_mov_b64 v[84:85], 0
  v_mov_b64 v[86:87], 0
  v_lshlrev_b32 v19, 1, v0
  v_mov_b32 v28, s52
  s_nop 0
  buffer_load_dwordx4 v[32:35], v9, s[4:7], s51 offen sc1
  s_nop 14
  buffer_load_dwordx4 v[36:39], v9, s[4:7], s60 offen sc1
  s_cmp_eq_u32 s50, 63
  s_cbranch_scc1 L_last_f
  s_bitcmp1_b64 s[98:99], s17
  s_waitcnt lgkmcnt(0)
  s_cbranch_scc1 L_step_f
  s_branch L_flag_f
L_reP0_f:
  buffer_load_dwordx4 v[40:43], v0, s[4:7], s63 offen sc1
  buffer_load_dwordx4 v[44:47], v0, s[4:7], s63 offen offset:1024 sc1
  s_waitcnt vmcnt(3)
  v_mfma_f32_16x16x32_bf16 v[48:51], v[56:59], v[52:55], 0
  s_waitcnt vmcnt(2)
  v_mfma_f32_16x16x32_bf16 v[48:51], v[60:63], v[52:55], v[48:51]
  v_xor_b32 v16, s54, v56
  v_bitop3_b32 v16, v16, v58, s54 bitop3:0xf6
  v_bitop3_b32 v16, v16, v60, s54 bitop3:0xf6
  v_bitop3_b32 v16, v16, v62, s54 bitop3:0xf6
  v_and_b32 v16, 1, v16
  v_cmp_ne_u32 vcc, 0, v16
  v_cmp_ne_u32 s[98:99], 0, v31
  s_nop 0
  v_permlane32_swap_b32 v48, v50
  v_permlane32_swap_b32 v49, v51
  v_add_f32 v48, v48, v50
  v_add_f32 v49, v49, v51
  s_cbranch_vccnz L_reQ0_f
  s_nop 0
  v_permlane16_swap_b32 v48, v49
  v_add_f32 v48, v48, v49
  s_nop 1
  v_mov_b32_dpp v49, v48 quad_perm:[2,3,0,1] row_mask:0xf bank_mask:0xf
  v_cvt_pk_bf16_f32 v48, v48, v49
  v_min_u32 v48, -2, v48
  v_cndmask_b32 v24, v48, -1, s[18:19]
  buffer_store_dword v24, v2, s[4:7], s3 offen
  s_waitcnt vmcnt(1)
  ds_read_b128 v[40:43], v7 offset:49152
  v_xor_b32 v2, s53, v2
  ds_read_b128 v[44:47], v7 offset:50176
  v_xor_b32 v29, 1024, v9
  ds_read_b128 v[48:51], v7 offset:51200
  v_xor_b32 v30, 2048, v9
  ds_read_b128 v[52:55], v7 offset:52224
  v_xor_b32 v31, 3072, v9
  ds_read_b128 v[56:59], v8 offset:0
  ds_read_b128 v[60:63], v8 offset:1024
  s_branch L_ep0_f
L_reQ0_f:
  buffer_load_dwordx4 v[56:59], v0, s[4:7], s63 offen sc1
  buffer_load_dwordx4 v[60:63], v0, s[4:7], s63 offen offset:1024 sc1
  s_sub_u32 s49, s49, 1
  s_cbranch_scc0 L_redQ0_f
  s_branch L_end
.p2align 6

L_x1_f:
  s_and_b32 s68, s50, 3
  s_lshl_b32 s68, s68, 13
  s_add_u32 s51, s68, s56
  s_add_u32 s60, s51, 4096
  s_and_b32 s68, s68, 0x2000
  s_add_u32 s3, s61, s68
  s_lshl_b32 s53, s68, 1
  s_sub_u32 s96, s57, s66
  s_add_u32 s96, s96, -8192
  s_add_u32 s57, s57, 24576
  s_add_u32 s97, s57, 8192
  s_xor_b32 s68, s66, 0x2000
  s_add_u32 m0, s68, s55
  s_cmp_gt_u32 s50, s38
  s_cselect_b32 s68, 4096, 0
  s_add_u32 s59, s59, s68
  s_add_u32 s17, s50, 1
  s_max_u32 s52, s50, 1
  s_sub_u32 s52, s52, 1
  s_and_b32 s100, s17, 1
  v_cndmask_b32 v52, 0, v11, s[70:71]
  v_cndmask_b32 v53, 0, v11, s[72:73]
  v_cndmask_b32 v54, 0, v11, s[74:75]
  v_cndmask_b32 v55, 0, v11, s[76:77]
  s_nop 15
  s_nop 15
  s_nop 15
  s_nop 10
  buffer_load_dwordx4 v[40:43], v0, s[4:7], s63 offen sc1
  buffer_load_dwordx4 v[44:47], v0, s[4:7], s63 offen offset:1024 sc1
  ds_read_b128 v[88:91], v8 offset:2048
  ds_read_b128 v[92:95], v8 offset:3072
  ds_read_b128 v[96:99], v8 offset:16384
  ds_read_b128 v[100:103], v8 offset:17408
  ds_read_b128 v[104:107], v8 offset:18432
  ds_read_b128 v[108:111], v8 offset:19456
  ds_read_b128 v[112:115], v8 offset:32768
  ds_read_b128 v[116:119], v8 offset:33792
  ds_read_b128 v[120:123], v8 offset:34816
  ds_read_b128 v[124:127], v8 offset:35840
  s_nop 9
  buffer_load_dwordx4 v[56:59], v0, s[4:7], s63 offen sc1
  buffer_load_dwordx4 v[60:63], v0, s[4:7], s63 offen offset:1024 sc1
  s_mov_b32 s67, 0
L_redQ1_f:
  s_waitcnt vmcnt(3)
L_redP1_f:
  v_mfma_f32_16x16x32_bf16 v[48:51], v[40:43], v[52:55], 0
  s_waitcnt vmcnt(2)
  v_mfma_f32_16x16x32_bf16 v[48:51], v[44:47], v[52:55], v[48:51]
  v_xor_b32 v16, s54, v40
  v_bitop3_b32 v16, v16, v42, s54 bitop3:0xf6
  v_bitop3_b32 v16, v16, v44, s54 bitop3:0xf6
  v_bitop3_b32 v16, v16, v46, s54 bitop3:0xf6
  v_and_b32 v16, 1, v16
  v_cmp_ne_u32 vcc, 0, v16
  v_cmp_ne_u32 s[98:99], 0, v31
  s_nop 0
  v_permlane32_swap_b32 v48, v50
  v_permlane32_swap_b32 v49, v51
  v_add_f32 v48, v48, v50
  v_add_f32 v49, v49, v51
  s_cbranch_vccnz L_reP1_f
  s_nop 0
  v_permlane16_swap_b32 v48, v49
  v_add_f32 v48, v48, v49
  s_nop 1
  v_mov_b32_dpp v49, v48 quad_perm:[2,3,0,1] row_mask:0xf bank_mask:0xf
  v_cvt_pk_bf16_f32 v48, v48, v49
  v_min_u32 v48, -2, v48
  v_cndmask_b32 v24, v48, -1, s[18:19]
  buffer_store_dword v24, v2, s[4:7], s3 offen
L_pub1_f:
  s_waitcnt vmcnt(1)
  ds_read_b128 v[40:43], v7 offset:49152
  v_xor_b32 v2, s53, v2
  ds_read_b128 v[44:47], v7 offset:50176
  v_xor_b32 v29, 1024, v9
  ds_read_b128 v[48:51], v7 offset:51200
  v_xor_b32 v30, 2048, v9
  ds_read_b128 v[52:55], v7 offset:52224
  v_xor_b32 v31, 3072, v9
  ds_read_b128 v[56:59], v8 offset:0
  ds_read_b128 v[60:63], v8 offset:1024
  s_nop 11
L_ep1_f:
  buffer_load_dwordx4 v[32:35], v9, s[4:7], s51 offen sc1
  v_mov_b64 v[64:65], 0
  v_mov_b64 v[66:67], 0
  v_mov_b64 v[68:69], 0
  v_mov_b64 v[70:71], 0
  v_mov_b64 v[72:73], 0
  v_mov_b64 v[74:75], 0
  v_mov_b64 v[76:77], 0
  v_mov_b64 v[78:79], 0
  v_mov_b64 v[80:81], 0
  v_mov_b64 v[82:83], 0
  v_mov_b64 v[84:85], 0
  v_mov_b64 v[86:87], 0
  v_lshlrev_b32 v19, 1, v0
  v_mov_b32 v28, s52
  buffer_load_dwordx4 v[32:35], v9, s[4:7], s51 offen sc1
  s_nop 14
  buffer_load_dwordx4 v[36:39], v9, s[4:7], s60 offen sc1
  s_cmp_eq_u32 s50, 63
  s_cbranch_scc1 L_last_f
  s_bitcmp1_b64 s[98:99], s17
  s_waitcnt lgkmcnt(0)
  s_cbranch_scc1 L_step_f
  s_branch L_flag_f
L_reP1_f:
  buffer_load_dwordx4 v[40:43], v0, s[4:7], s63 offen sc1
  buffer_load_dwordx4 v[44:47], v0, s[4:7], s63 offen offset:1024 sc1
  s_waitcnt vmcnt(3)
  v_mfma_f32_16x16x32_bf16 v[48:51], v[56:59], v[52:55], 0
  s_waitcnt vmcnt(2)
  v_mfma_f32_16x16x32_bf16 v[48:51], v[60:63], v[52:55], v[48:51]
  v_xor_b32 v16, s54, v56
  v_bitop3_b32 v16, v16, v58, s54 bitop3:0xf6
  v_bitop3_b32 v16, v16, v60, s54 bitop3:0xf6
  v_bitop3_b32 v16, v16, v62, s54 bitop3:0xf6
  v_and_b32 v16, 1, v16
  v_cmp_ne_u32 vcc, 0, v16
  v_cmp_ne_u32 s[98:99], 0, v31
  s_nop 0
  v_permlane32_swap_b32 v48, v50
  v_permlane32_swap_b32 v49, v51
  v_add_f32 v48, v48, v50
  v_add_f32 v49, v49, v51
  s_cbranch_vccnz L_reQ1_f
  s_nop 0
  v_permlane16_swap_b32 v48, v49
  v_add_f32 v48, v48, v49
  s_nop 1
  v_mov_b32_dpp v49, v48 quad_perm:[2,3,0,1] row_mask:0xf bank_mask:0xf
  v_cvt_pk_bf16_f32 v48, v48, v49
  v_min_u32 v48, -2, v48
  v_cndmask_b32 v24, v48, -1, s[18:19]
  buffer_store_dword v24, v2, s[4:7], s3 offen
  s_waitcnt vmcnt(1)
  ds_read_b128 v[40:43], v7 offset:49152
  v_xor_b32 v2, s53, v2
  ds_read_b128 v[44:47], v7 offset:50176
  v_xor_b32 v29, 1024, v9
  ds_read_b128 v[48:51], v7 offset:51200
  v_xor_b32 v30, 2048, v9
  ds_read_b128 v[52:55], v7 offset:52224
  v_xor_b32 v31, 3072, v9
  ds_read_b128 v[56:59], v8 offset:0
  ds_read_b128 v[60:63], v8 offset:1024
  s_branch L_ep1_f
L_reQ1_f:
  buffer_load_dwordx4 v[56:59], v0, s[4:7], s63 offen sc1
  buffer_load_dwordx4 v[60:63], v0, s[4:7], s63 offen offset:1024 sc1
  s_sub_u32 s49, s49, 1
  s_cbranch_scc0 L_redQ1_f
  s_branch L_end
L_flag_f:
  v_lshrrev_b32 v16, 2, v0
  buffer_load_dword v16, v16, s[4:7], s64 offen sc1
  s_sub_u32 s49, s49, 1
  s_cbranch_scc1 L_end
  s_waitcnt vmcnt(0)
  v_cmp_ne_u32 s[98:99], 0, v16
  s_nop 0
  s_bitcmp1_b64 s[98:99], s17
  s_cbranch_scc1 L_step_f
  s_branch L_flag_f
L_retE_f:
  buffer_load_dwordx4 v[32:35], v9, s[4:7], s51 offen sc1
  buffer_load_dwordx4 v[36:39], v9, s[4:7], s60 offen sc1
  s_sub_u32 s49, s49, 1
  s_waitcnt vmcnt(3)
  s_cbranch_scc0 L_chkE_f
  s_branch L_end
L_retL_f:
  buffer_load_dwordx4 v[36:39], v9, s[4:7], s60 offen sc1
  s_sub_u32 s49, s49, 1
  s_cbranch_scc1 L_end
  s_bitcmp1_b32 s67, 0
  s_bitset1_b32 s67, 0
  s_waitcnt vmcnt(1)
  s_cbranch_scc0 L_retL1_f
  s_waitcnt vmcnt(1)
L_retL1_f:
  v_max3_u32 v16, v36, v37, v38
  v_max_u32 v16, v16, v39
  v_cmp_eq_u32 vcc, -1, v16
  ds_write_b128 v9, v[36:39] offset:4096
  s_cbranch_vccz L_okL_f
  s_branch L_retL_f
L_lret_f:
  buffer_load_dwordx4 v[32:35], v9, s[4:7], s51 offen sc1
  buffer_load_dwordx4 v[36:39], v9, s[4:7], s60 offen sc1
  s_sub_u32 s49, s49, 1
  s_cbranch_scc1 L_end
L_last_f:
  s_waitcnt vmcnt(0) lgkmcnt(0)
  v_max3_u32 v16, v32, v33, v34
  v_max3_u32 v16, v16, v35, v36
  v_max3_u32 v16, v16, v37, v38
  v_max_u32 v16, v16, v39
  v_cmp_eq_u32 vcc, -1, v16
  ds_write_b128 v9, v[32:35]
  ds_write_b128 v9, v[36:39] offset:4096
  s_cbranch_vccnz L_lret_f
  v_smfmac_f32_16x16x64_bf16 v[72:75], v[32:35], v[56:63], v10
  buffer_store_dwordx4 v[12:15], v0, s[4:7], s59 offen sc1
  v_smfmac_f32_16x16x64_bf16 v[76:79], v[32:35], v[88:95], v10
  v_smfmac_f32_16x16x64_bf16 v[80:83], v[32:35], a[176:183], v10
  v_smfmac_f32_16x16x64_bf16 v[84:87], v[32:35], a[240:247], v10
  s_mov_b64 exec, 1
  buffer_store_dword v28, off, s[4:7], s65 sc1
  s_mov_b64 exec, -1
  s_waitcnt lgkmcnt(0)
  s_barrier
  ds_read_b128 v[40:43], v29 offset:0
  ds_read_b128 v[44:47], v29 offset:4096
  v_smfmac_f32_16x16x64_bf16 v[72:75], v[36:39], v[112:119], v10
  ds_read_b128 v[48:51], v30 offset:0
  v_smfmac_f32_16x16x64_bf16 v[76:79], v[36:39], v[120:127], v10
  ds_read_b128 v[52:55], v30 offset:4096
  v_smfmac_f32_16x16x64_bf16 v[80:83], v[36:39], a[184:191], v10
  ds_read_b128 v[56:59], v31 offset:0
  v_smfmac_f32_16x16x64_bf16 v[84:87], v[36:39], a[248:255], v10
  ds_read_b128 v[60:63], v31 offset:4096
  s_waitcnt lgkmcnt(5)
  v_smfmac_f32_16x16x64_bf16 v[72:75], v[40:43], a[80:87], v10
  v_smfmac_f32_16x16x64_bf16 v[76:79], v[40:43], a[128:135], v10
  v_smfmac_f32_16x16x64_bf16 v[80:83], v[40:43], a[192:199], v10
  v_smfmac_f32_16x16x64_bf16 v[84:87], v[40:43], v[128:135], v10
  s_waitcnt lgkmcnt(4)
  v_smfmac_f32_16x16x64_bf16 v[72:75], v[44:47], a[88:95], v10
  v_smfmac_f32_16x16x64_bf16 v[76:79], v[44:47], a[136:143], v10
  v_smfmac_f32_16x16x64_bf16 v[80:83], v[44:47], a[200:207], v10
  v_smfmac_f32_16x16x64_bf16 v[84:87], v[44:47], v[136:143], v10
  s_waitcnt lgkmcnt(3)
  v_smfmac_f32_16x16x64_bf16 v[72:75], v[48:51], a[96:103], v10
  v_smfmac_f32_16x16x64_bf16 v[76:79], v[48:51], a[144:151], v10
  v_smfmac_f32_16x16x64_bf16 v[80:83], v[48:51], a[208:215], v10
  v_smfmac_f32_16x16x64_bf16 v[84:87], v[48:51], v[144:151], v10
  s_waitcnt lgkmcnt(2)
  v_smfmac_f32_16x16x64_bf16 v[72:75], v[52:55], a[104:111], v10
  v_smfmac_f32_16x16x64_bf16 v[76:79], v[52:55], a[152:159], v10
  v_smfmac_f32_16x16x64_bf16 v[80:83], v[52:55], a[216:223], v10
  v_smfmac_f32_16x16x64_bf16 v[84:87], v[52:55], v[152:159], v10
  s_waitcnt lgkmcnt(1)
  v_smfmac_f32_16x16x64_bf16 v[72:75], v[56:59], a[112:119], v10
  s_waitcnt lgkmcnt(0)
  v_smfmac_f32_16x16x64_bf16 v[72:75], v[60:63], a[120:127], v10
  v_smfmac_f32_16x16x64_bf16 v[76:79], v[56:59], a[160:167], v10
  v_smfmac_f32_16x16x64_bf16 v[76:79], v[60:63], a[168:175], v10
  v_smfmac_f32_16x16x64_bf16 v[80:83], v[56:59], a[224:231], v10
  v_smfmac_f32_16x16x64_bf16 v[80:83], v[60:63], a[232:239], v10
  v_smfmac_f32_16x16x64_bf16 v[84:87], v[56:59], v[160:167], v10
  v_smfmac_f32_16x16x64_bf16 v[84:87], v[60:63], v[168:175], v10
  s_nop 1
  v_add_f32 v72, v72, v73
  v_add_f32 v74, v74, v75
  v_cvt_pk_bf16_f32 v12, v72, v74
  v_add_f32 v76, v76, v77
  v_add_f32 v78, v78, v79
  v_cvt_pk_bf16_f32 v13, v76, v78
  v_add_f32 v80, v80, v81
  v_add_f32 v82, v82, v83
  v_cvt_pk_bf16_f32 v14, v80, v82
  v_add_f32 v84, v84, v85
  v_add_f32 v86, v86, v87
  v_cvt_pk_bf16_f32 v15, v84, v86
  s_branch L_final
.p2align 8
  s_nop 0
  s_nop 0
  s_nop 0
  s_nop 0
  s_nop 0
  s_nop 0
  s_nop 0
  s_nop 0

L_step_s:
  s_waitcnt vmcnt(2)
L_chkE_s:
  v_max3_u32 v16, v32, v33, v34
  v_max_u32 v16, v16, v35
  v_cmp_eq_u32 vcc, -1, v16
  ds_write_b128 v9, v[32:35]
  s_cbranch_vccnz L_retE_s
L_okE_s:
  v_smfmac_f32_16x16x64_bf16 v[64:67], v[32:35], v[40:47], v10
  buffer_load_dwordx4 v[36:39], v9, s[4:7], s60 offen sc1
L_okE2_s:
  v_smfmac_f32_16x16x64_bf16 v[68:71], v[32:35], v[48:55], v10
  v_smfmac_f32_16x16x64_bf16 v[72:75], v[32:35], v[56:63], v10
  s_waitcnt lgkmcnt(0)
  s_barrier
  ds_read_b128 v[40:43], v29 offset:0
  ds_read_b128 v[48:51], v30 offset:0
  v_smfmac_f32_16x16x64_bf16 v[76:79], v[32:35], v[88:95], v10
  ds_read_b128 v[56:59], v31 offset:0
  s_waitcnt vmcnt(1)
  v_max3_u32 v16, v36, v37, v38
  v_smfmac_f32_16x16x64_bf16 v[80:83], v[32:35], a[176:183], v10
  v_max_u32 v16, v16, v39
  v_smfmac_f32_16x16x64_bf16 v[84:87], v[32:35], a[240:247], v10
  v_cmp_eq_u32 vcc, -1, v16
  ds_write_b128 v9, v[36:39] offset:4096
  s_cbranch_vccnz L_retL_s
L_okL_s:
  v_smfmac_f32_16x16x64_bf16 v[64:67], v[36:39], v[96:103], v10
  v_smfmac_f32_16x16x64_bf16 v[68:71], v[36:39], v[104:111], v10
  buffer_load_dwordx4 v[20:23], v5, s[4:7], s96 offen sc1
  v_smfmac_f32_16x16x64_bf16 v[72:75], v[36:39], v[112:119], v10
  ds_read_b128 v[88:91], v8 offset:49152
  v_smfmac_f32_16x16x64_bf16 v[76:79], v[36:39], v[120:127], v10
  ds_read_b128 v[92:95], v8 offset:50176
  s_waitcnt lgkmcnt(3)
  v_smfmac_f32_16x16x64_bf16 v[64:67], v[40:43], a[0:7], v10
  buffer_load_dwordx4 v[24:27], v5, s[4:7], s96 offen offset:256 sc1
  ds_read_b128 v[96:99], v8 offset:51200
  v_smfmac_f32_16x16x64_bf16 v[68:71], v[40:43], a[32:39], v10
  s_waitcnt lgkmcnt(3)
  v_smfmac_f32_16x16x64_bf16 v[72:75], v[40:43], a[80:87], v10
  s_barrier
  v_smfmac_f32_16x16x64_bf16 v[76:79], v[40:43], a[128:135], v10
  buffer_load_dwordx4 v0, s[4:7], s57 offen sc1 lds
  ds_read_b128 v[44:47], v29 offset:4096
  v_smfmac_f32_16x16x64_bf16 v[64:67], v[48:51], a[16:23], v10
  ds_read_b128 v[52:55], v30 offset:4096
  v_smfmac_f32_16x16x64_bf16 v[68:71], v[48:51], a[48:55], v10
  ds_read_b128 v[60:63], v31 offset:4096
  v_lshrrev_b32 v31, 2, v0
  v_smfmac_f32_16x16x64_bf16 v[72:75], v[48:51], a[96:103], v10
  v_smfmac_f32_16x16x64_bf16 v[76:79], v[48:51], a[144:151], v10
  buffer_load_dwordx4 v0, s[4:7], s57 offen offset:1024 sc1 lds
  s_movk_i32 m0, 14592
  ds_read_b128 v[100:103], v8 offset:52224
  v_smfmac_f32_16x16x64_bf16 v[64:67], v[56:59], a[24:31], v10
  ds_read_b128 v[104:107], v5 offset:0
  v_smfmac_f32_16x16x64_bf16 v[68:71], v[56:59], a[64:71], v10
  ds_read_b128 v[108:111], v5 offset:2048
  v_smfmac_f32_16x16x64_bf16 v[72:75], v[56:59], a[112:119], v10
  buffer_load_dword v19, s[4:7], s97 offen sc1 lds
  v_smfmac_f32_16x16x64_bf16 v[76:79], v[56:59], a[160:167], v10
  ds_read_b128 v[112:115], v5 offset:4096
  s_waitcnt lgkmcnt(3)
  v_smfmac_f32_16x16x64_bf16 v[64:67], v[44:47], a[8:15], v10
  ds_read_b128 v[116:119], v5 offset:6144
  v_smfmac_f32_16x16x64_bf16 v[64:67], v[52:55], v[88:95], v10
  buffer_store_dwordx4 v[12:15], v0, s[4:7], s59 offen sc1
  ds_read_b128 v[120:123], v5 offset:256
  v_smfmac_f32_16x16x64_bf16 v[64:67], v[60:63], v[96:103], v10
  ds_read_b128 v[124:127], v5 offset:2304
  v_smfmac_f32_16x16x64_bf16 v[68:71], v[44:47], a[40:47], v10
  s_waitcnt vmcnt(4)
  s_nop 0
  v_smfmac_f32_16x16x64_bf16 v[68:71], v[52:55], a[56:63], v10
  buffer_load_dword v31, v31, s[4:7], s64 offen sc1
  v_smfmac_f32_16x16x64_bf16 v[68:71], v[60:63], a[72:79], v10
  s_nop 0
  v_add_f32 v64, v64, v65
  v_smfmac_f32_16x16x64_bf16 v[72:75], v[44:47], a[88:95], v10
  s_nop 0
  v_add_f32 v66, v66, v67
  v_smfmac_f32_16x16x64_bf16 v[72:75], v[52:55], a[104:111], v10
  s_mov_b64 exec, 1
  buffer_store_dword v28, off, s[4:7], s65 sc1
  s_mov_b64 exec, -1
  v_cvt_pk_bf16_f32 v65, v64, v66
  v_smfmac_f32_16x16x64_bf16 v[72:75], v[60:63], a[120:127], v10
  v_add_f32 v68, v68, v69
  v_smfmac_f32_16x16x64_bf16 v[76:79], v[44:47], a[136:143], v10
  s_nop 0
  v_add_f32 v70, v70, v71
  v_smfmac_f32_16x16x64_bf16 v[76:79], v[52:55], a[152:159], v10
  s_nop 0
  v_cvt_pk_bf16_f32 v69, v68, v70
  v_smfmac_f32_16x16x64_bf16 v[76:79], v[60:63], a[168:175], v10
  ds_write2_b32 v3, v65, v69 offset0:0 offset1:32
  v_add_f32 v72, v72, v73
  v_smfmac_f32_16x16x64_bf16 v[80:83], v[36:39], a[184:191], v10
  s_nop 0
  v_add_f32 v74, v74, v75
  v_smfmac_f32_16x16x64_bf16 v[84:87], v[36:39], a[248:255], v10
  s_nop 0
  v_cvt_pk_bf16_f32 v12, v72, v74
  v_add_f32 v76, v76, v77
  v_smfmac_f32_16x16x64_bf16 v[80:83], v[40:43], a[192:199], v10
  v_add_f32 v78, v78, v79
  v_cvt_pk_bf16_f32 v13, v76, v78
  v_smfmac_f32_16x16x64_bf16 v[84:87], v[40:43], v[128:135], v10
  ds_write2_b32 v3, v12, v13 offset0:1 offset1:33
  v_mov_b64 v[32:33], 0
  v_smfmac_f32_16x16x64_bf16 v[80:83], v[44:47], a[200:207], v10
  v_mov_b64 v[34:35], 0
  v_smfmac_f32_16x16x64_bf16 v[84:87], v[44:47], v[136:143], v10
  v_mov_b64 v[36:37], 0
  v_smfmac_f32_16x16x64_bf16 v[80:83], v[48:51], a[208:215], v10
  v_mov_b64 v[38:39], 0
  v_smfmac_f32_16x16x64_bf16 v[84:87], v[48:51], v[144:151], v10
  s_waitcnt lgkmcnt(0)
  v_mov_b64 v[40:41], 0
  v_smfmac_f32_16x16x64_bf16 v[80:83], v[52:55], a[216:223], v10
  s_barrier
  v_smfmac_f32_16x16x64_bf16 v[84:87], v[52:55], v[152:159], v10
  ds_read_b64_tr_b16 v[88:89], v4 offset:0
  ds_read_b64_tr_b16 v[90:91], v4 offset:64
  v_mov_b64 v[42:43], 0
  v_smfmac_f32_16x16x64_bf16 v[80:83], v[56:59], a[224:231], v10
  ds_read_b64_tr_b16 v[92:93], v4 offset:256
  v_mov_b64 v[44:45], 0
  v_smfmac_f32_16x16x64_bf16 v[80:83], v[60:63], a[232:239], v10
  ds_read_b64_tr_b16 v[94:95], v4 offset:320
  v_mov_b64 v[46:47], 0
  v_smfmac_f32_16x16x64_bf16 v[84:87], v[56:59], v[160:167], v10
  ds_read_b64_tr_b16 v[96:97], v4 offset:512
  v_mov_b64 v[48:49], 0
  v_smfmac_f32_16x16x64_bf16 v[84:87], v[60:63], v[168:175], v10
  ds_read_b64_tr_b16 v[98:99], v4 offset:576
  s_waitcnt lgkmcnt(4)
  v_mov_b64 v[50:51], 0
  v_mfma_f32_16x16x32_bf16 v[64:67], v[104:107], v[88:91], 0
  ds_read_b64_tr_b16 v[100:101], v4 offset:768
  v_mov_b64 v[52:53], 0
  v_mfma_f32_16x16x32_bf16 v[68:71], v[120:123], v[88:91], 0
  ds_read_b64_tr_b16 v[102:103], v4 offset:832
  v_mov_b64 v[54:55], 0
  v_mfma_f32_16x16x32_bf16 v[72:75], v[88:91], v[88:91], 0
  s_waitcnt lgkmcnt(4)
  v_add_f32 v80, v80, v81
  v_mfma_f32_16x16x32_bf16 v[64:67], v[108:111], v[92:95], v[64:67]
  ds_read_b128 v[104:107], v5 offset:4352
  v_add_f32 v82, v82, v83
  v_mfma_f32_16x16x32_bf16 v[68:71], v[124:127], v[92:95], v[68:71]
  ds_read_b128 v[108:111], v5 offset:6400
  v_cvt_pk_bf16_f32 v14, v80, v82
  v_mfma_f32_16x16x32_bf16 v[72:75], v[92:95], v[92:95], v[72:75]
  s_waitcnt lgkmcnt(2)
  v_add_f32 v84, v84, v85
  v_mfma_f32_16x16x32_bf16 v[64:67], v[112:115], v[96:99], v[64:67]
  v_add_f32 v86, v86, v87
  v_cvt_pk_bf16_f32 v15, v84, v86
  v_mfma_f32_16x16x32_bf16 v[64:67], v[116:119], v[100:103], v[64:67]
  v_mov_b64 v[56:57], 0
  v_mov_b64 v[58:59], 0
  v_mfma_f32_16x16x32_bf16 v[72:75], v[96:99], v[96:99], v[72:75]
  v_mov_b64 v[60:61], 0
  v_mov_b64 v[62:63], 0
  v_mfma_f32_16x16x32_bf16 v[72:75], v[100:103], v[100:103], v[72:75]
  s_waitcnt lgkmcnt(0)
  s_nop 1
  v_mfma_f32_16x16x32_bf16 v[68:71], v[104:107], v[96:99], v[68:71]
  v_max3_f32 v28, v64, v65, v66
  v_mfma_f32_16x16x32_bf16 v[68:71], v[108:111], v[100:103], v[68:71]
  ds_read_b128 v[104:107], v7 offset:0
  s_add_u32 s50, s50, 1
  ds_read_b128 v[108:111], v7 offset:1024
  s_mov_b32 s54, s100
  ds_read_b128 v[112:115], v7 offset:2048
  ds_read_b128 v[116:119], v7 offset:3072
  v_max3_f32 v28, v28, v67, v74
  v_max_f32 v28, v28, v75
  v_max3_f32 v28, v28, v68, v69
  v_max3_f32 v28, v28, v70, v71
  v_mov_b32 v29, v28
  s_xor_b32 s66, s66, 0x2000
  v_xor_b32 v5, 0x2000, v5
  v_permlane32_swap_b32 v28, v29
  v_max_f32 v28, v28, v29
  v_mov_b32 v29, v28
  s_nop 1
  v_permlane16_swap_b32 v28, v29
  v_max_f32 v28, v28, v29
  v_mul_f32 v28, s58, v28
  v_pk_fma_f32 v[64:65], v[64:65], s[58:59], v[28:29] op_sel_hi:[1,0,0] neg_lo:[0,0,1] neg_hi:[0,0,1]
  v_pk_fma_f32 v[66:67], v[66:67], s[58:59], v[28:29] op_sel_hi:[1,0,0] neg_lo:[0,0,1] neg_hi:[0,0,1]
  v_pk_fma_f32 v[68:69], v[68:69], s[58:59], v[28:29] op_sel_hi:[1,0,0] neg_lo:[0,0,1] neg_hi:[0,0,1]
  v_pk_fma_f32 v[70:71], v[70:71], s[58:59], v[28:29] op_sel_hi:[1,0,0] neg_lo:[0,0,1] neg_hi:[0,0,1]
  v_pk_fma_f32 v[74:75], v[74:75], s[58:59], v[28:29] op_sel_hi:[1,0,0] neg_lo:[0,0,1] neg_hi:[0,0,1]
  v_exp_f32 v64, v64
  v_exp_f32 v65, v65
  v_exp_f32 v66, v66
  v_exp_f32 v67, v67
  v_exp_f32 v68, v68
  v_exp_f32 v69, v69
  v_exp_f32 v70, v70
  v_exp_f32 v71, v71
  v_exp_f32 v74, v74
  v_exp_f32 v75, v75
  v_cvt_pk_bf16_f32 v76, v64, v65
  v_cvt_pk_bf16_f32 v77, v66, v67
  v_cvt_pk_bf16_f32 v78, v68, v69
  v_cvt_pk_bf16_f32 v79, v70, v71
  v_cvt_pk_bf16_f32 v16, v74, v75
  v_cvt_pk_bf16_f32 v19, v74, v75
  v_pk_add_f32 v[64:65], v[64:65], v[66:67]
  v_pk_add_f32 v[68:69], v[68:69], v[70:71]
  v_pk_add_f32 v[64:65], v[64:65], v[74:75]
  v_pk_add_f32 v[28:29], v[64:65], v[68:69]
  v_mfma_f32_16x16x32_bf16 v[120:123], v[20:23], v[76:79], 0
  v_add_f32 v28, v28, v29
  v_mov_b32 v29, v28
  v_mfma_f32_16x16x32_bf16 v[124:127], v[24:27], v[76:79], 0
  s_nop 0
  v_permlane32_swap_b32 v28, v29
  v_mfma_f32_16x16x16_bf16 v[120:123], v[14:15], v[16:17], v[120:123]
  v_add_f32 v28, v28, v29
  v_mov_b32 v29, v28
  v_mfma_f32_16x16x16_bf16 v[124:127], v[14:15], v[18:19], v[124:127]
  s_nop 0
  v_permlane16_swap_b32 v28, v29
  v_add_f32 v28, v28, v29
  v_rcp_f32 v28, v28
  s_nop 0
  v_pk_mul_f32 v[120:121], v[120:121], v[28:29] op_sel_hi:[1,0]
  v_pk_mul_f32 v[122:123], v[122:123], v[28:29] op_sel_hi:[1,0]
  s_nop 0
  v_pk_mul_f32 v[124:125], v[124:125], v[28:29] op_sel_hi:[1,0]
  v_pk_mul_f32 v[126:127], v[126:127], v[28:29] op_sel_hi:[1,0]
  v_cvt_pk_bf16_f32 v120, v120, v121
  v_cvt_pk_bf16_f32 v121, v122, v123
  v_cvt_pk_bf16_f32 v122, v124, v125
  v_cvt_pk_bf16_f32 v123, v126, v127
  ds_write_b128 v6, v[120:123]
  s_waitcnt lgkmcnt(0)
  s_barrier
  ds_read_b128 v[80:83], v0 offset:12544
  ds_read_b128 v[84:87], v0 offset:13568
  s_waitcnt lgkmcnt(1)
  v_smfmac_f32_16x16x64_bf16 v[32:35], v[80:83], v[176:183], v10
  s_nop 0
  s_waitcnt lgkmcnt(0)
  v_smfmac_f32_16x16x64_bf16 v[32:35], v[84:87], v[184:191], v10
  ds_read_b128 v[88:91], v7 offset:16384
  s_nop 0
  v_smfmac_f32_16x16x64_bf16 v[36:39], v[80:83], v[192:199], v10
  ds_read_b128 v[92:95], v7 offset:17408
  s_nop 0
  v_smfmac_f32_16x16x64_bf16 v[36:39], v[84:87], v[200:207], v10
  ds_read_b128 v[96:99], v7 offset:18432
  s_nop 0
  v_smfmac_f32_16x16x64_bf16 v[40:43], v[80:83], v[208:215], v10
  ds_read_b128 v[100:103], v7 offset:19456
  v_add_f32 v32, v32, v33
  v_smfmac_f32_16x16x64_bf16 v[40:43], v[84:87], v[216:223], v10
  ds_read_b128 v[64:67], v7 offset:32768
  v_add_f32 v34, v34, v35
  v_cvt_pk_bf16_f32 v120, v32, v34
  v_smfmac_f32_16x16x64_bf16 v[44:47], v[80:83], v[224:231], v10
  ds_read_b128 v[68:71], v7 offset:33792
  v_add_f32 v36, v36, v37
  v_and_or_b32 v120, v120, -2, s54
  v_smfmac_f32_16x16x64_bf16 v[44:47], v[84:87], v[232:239], v10
  ds_read_b128 v[72:75], v7 offset:34816
  v_add_f32 v38, v38, v39
  v_cvt_pk_bf16_f32 v121, v36, v38
  v_smfmac_f32_16x16x64_bf16 v[48:51], v[80:83], v[240:247], v10
  ds_read_b128 v[76:79], v7 offset:35840
  v_add_f32 v40, v40, v41
  v_smfmac_f32_16x16x64_bf16 v[48:51], v[84:87], v[248:255], v10
  v_add_f32 v42, v42, v43
  v_cvt_pk_bf16_f32 v122, v40, v42
  v_smfmac_f32_16x16x64_bf16 v[52:55], v[80:83], v[104:111], v10
  v_add_f32 v44, v44, v45
  v_and_or_b32 v122, v122, -2, s54
  v_smfmac_f32_16x16x64_bf16 v[52:55], v[84:87], v[112:119], v10
  s_waitcnt lgkmcnt(6)
  v_add_f32 v46, v46, v47
  v_cvt_pk_bf16_f32 v123, v44, v46
  v_smfmac_f32_16x16x64_bf16 v[56:59], v[80:83], v[88:95], v10
  buffer_store_dwordx4 v[120:123], v1, s[4:7], s62 offen offset:0 sc1
  s_waitcnt lgkmcnt(4)
  v_add_f32 v48, v48, v49
  v_smfmac_f32_16x16x64_bf16 v[56:59], v[84:87], v[96:103], v10
  s_waitcnt lgkmcnt(2)
  v_add_f32 v50, v50, v51
  v_cvt_pk_bf16_f32 v124, v48, v50
  v_smfmac_f32_16x16x64_bf16 v[60:63], v[80:83], v[64:71], v10
  s_waitcnt lgkmcnt(0)
  v_add_f32 v52, v52, v53
  v_and_or_b32 v124, v124, -2, s54
  v_smfmac_f32_16x16x64_bf16 v[60:63], v[84:87], v[72:79], v10
  v_add_f32 v54, v54, v55
  v_cvt_pk_bf16_f32 v125, v52, v54
  v_add_f32 v56, v56, v57
  v_add_f32 v58, v58, v59
  v_cvt_pk_bf16_f32 v126, v56, v58
  v_and_or_b32 v126, v126, -2, s54
  s_nop 1
  v_add_f32 v60, v60, v61
  v_add_f32 v62, v62, v63
  v_cvt_pk_bf16_f32 v127, v60, v62
  buffer_store_dwordx4 v[124:127], v1, s[4:7], s62 offen offset:2048 sc1
  s_bitcmp1_b32 s46, 0
  s_cbranch_scc1 L_x1_s
  s_and_b32 s68, s50, 3
  s_lshl_b32 s68, s68, 13
  s_add_u32 s51, s68, s56
  s_add_u32 s60, s51, 4096
  s_and_b32 s68, s68, 0x2000
  s_add_u32 s3, s61, s68
  s_lshl_b32 s53, s68, 1
  s_sub_u32 s96, s57, s66
  s_add_u32 s96, s96, -8192
  s_add_u32 s57, s57, 24576
  s_add_u32 s97, s57, 8192
  s_xor_b32 s68, s66, 0x2000
  s_add_u32 m0, s68, s55
  s_cmp_gt_u32 s50, s38
  s_cselect_b32 s68, 4096, 0
  s_add_u32 s59, s59, s68
  s_add_u32 s17, s50, 1
  s_max_u32 s52, s50, 1
  s_sub_u32 s52, s52, 1
  s_and_b32 s100, s17, 1
  v_cndmask_b32 v52, 0, v11, s[70:71]
  v_cndmask_b32 v53, 0, v11, s[72:73]
  v_cndmask_b32 v54, 0, v11, s[74:75]
  v_cndmask_b32 v55, 0, v11, s[76:77]
  s_sleep 12
  s_nop 5
  buffer_load_dwordx4 v[40:43], v0, s[4:7], s63 offen sc1
  buffer_load_dwordx4 v[44:47], v0, s[4:7], s63 offen offset:1024 sc1
  ds_read_b128 v[88:91], v8 offset:2048
  ds_read_b128 v[92:95], v8 offset:3072
  ds_read_b128 v[96:99], v8 offset:16384
  ds_read_b128 v[100:103], v8 offset:17408
  ds_read_b128 v[104:107], v8 offset:18432
  ds_read_b128 v[108:111], v8 offset:19456
  ds_read_b128 v[112:115], v8 offset:32768
  ds_read_b128 v[116:119], v8 offset:33792
  ds_read_b128 v[120:123], v8 offset:34816
  ds_read_b128 v[124:127], v8 offset:35840
  s_nop 14
  buffer_load_dwordx4 v[56:59], v0, s[4:7], s63 offen sc1
  buffer_load_dwordx4 v[60:63], v0, s[4:7], s63 offen offset:1024 sc1
  s_mov_b32 s67, 0
L_redQ0_s:
  s_waitcnt vmcnt(3)
L_redP0_s:
  v_mfma_f32_16x16x32_bf16 v[48:51], v[40:43], v[52:55], 0
  s_waitcnt vmcnt(2)
  v_mfma_f32_16x16x32_bf16 v[48:51], v[44:47], v[52:55], v[48:51]
  v_xor_b32 v16, s54, v40
  v_bitop3_b32 v16, v16, v42, s54 bitop3:0xf6
  v_bitop3_b32 v16, v16, v44, s54 bitop3:0xf6
  v_bitop3_b32 v16, v16, v46, s54 bitop3:0xf6
  v_and_b32 v16, 1, v16
  v_cmp_ne_u32 vcc, 0, v16
  v_cmp_ne_u32 s[98:99], 0, v31
  s_nop 0
  v_permlane32_swap_b32 v48, v50
  v_permlane32_swap_b32 v49, v51
  v_add_f32 v48, v48, v50
  v_add_f32 v49, v49, v51
  s_cbranch_vccnz L_reP0_s
  s_nop 0
  v_permlane16_swap_b32 v48, v49
  v_add_f32 v48, v48, v49
  s_nop 1
  v_mov_b32_dpp v49, v48 quad_perm:[2,3,0,1] row_mask:0xf bank_mask:0xf
  v_cvt_pk_bf16_f32 v48, v48, v49
  v_min_u32 v48, -2, v48
  v_cndmask_b32 v24, v48, -1, s[18:19]
  buffer_store_dword v24, v2, s[4:7], s3 offen sc1
L_pub0_s:
  s_waitcnt vmcnt(1)
  ds_read_b128 v[40:43], v7 offset:49152
  v_xor_b32 v2, s53, v2
  ds_read_b128 v[44:47], v7 offset:50176
  v_xor_b32 v29, 1024, v9
  ds_read_b128 v[48:51], v7 offset:51200
  v_xor_b32 v30, 2048, v9
  ds_read_b128 v[52:55], v7 offset:52224
  v_xor_b32 v31, 3072, v9
  ds_read_b128 v[56:59], v8 offset:0
  ds_read_b128 v[60:63], v8 offset:1024
  s_nop 15
  s_nop 15
  s_nop 9
L_ep0_s:
  s_sleep 9
  s_nop 12
  buffer_load_dwordx4 v[32:35], v9, s[4:7], s51 offen sc1
  v_mov_b64 v[64:65], 0
  v_mov_b64 v[66:67], 0
  v_mov_b64 v[68:69], 0
  v_mov_b64 v[70:71], 0
  v_mov_b64 v[72:73], 0
  v_mov_b64 v[74:75], 0
  v_mov_b64 v[76:77], 0
  v_mov_b64 v[78:79], 0
  v_mov_b64 v[80:81], 0
  v_mov_b64 v[82:83], 0
  v_mov_b64 v[84:85], 0
  v_mov_b64 v[86:87], 0
  v_lshlrev_b32 v19, 1, v0
  v_mov_b32 v28, s52
  s_nop 15
  s_nop 15
  s_nop 13
  buffer_load_dwordx4 v[32:35], v9, s[4:7], s51 offen sc1
  s_nop 14
  buffer_load_dwordx4 v[36:39], v9, s[4:7], s60 offen sc1
  s_cmp_eq_u32 s50, 63
  s_cbranch_scc1 L_last_s
  s_bitcmp1_b64 s[98:99], s17
  s_waitcnt lgkmcnt(0)
  s_cbranch_scc1 L_step_s
  s_branch L_flag_s
L_reP0_s:
  buffer_load_dwordx4 v[40:43], v0, s[4:7], s63 offen sc1
  buffer_load_dwordx4 v[44:47], v0, s[4:7], s63 offen offset:1024 sc1
  s_waitcnt vmcnt(3)
  v_mfma_f32_16x16x32_bf16 v[48:51], v[56:59], v[52:55], 0
  s_waitcnt vmcnt(2)
  v_mfma_f32_16x16x32_bf16 v[48:51], v[60:63], v[52:55], v[48:51]
  v_xor_b32 v16, s54, v56
  v_bitop3_b32 v16, v16, v58, s54 bitop3:0xf6
  v_bitop3_b32 v16, v16, v60, s54 bitop3:0xf6
  v_bitop3_b32 v16, v16, v62, s54 bitop3:0xf6
  v_and_b32 v16, 1, v16
  v_cmp_ne_u32 vcc, 0, v16
  v_cmp_ne_u32 s[98:99], 0, v31
  s_nop 0
  v_permlane32_swap_b32 v48, v50
  v_permlane32_swap_b32 v49, v51
  v_add_f32 v48, v48, v50
  v_add_f32 v49, v49, v51
  s_cbranch_vccnz L_reQ0_s
  s_nop 0
  v_permlane16_swap_b32 v48, v49
  v_add_f32 v48, v48, v49
  s_nop 1
  v_mov_b32_dpp v49, v48 quad_perm:[2,3,0,1] row_mask:0xf bank_mask:0xf
  v_cvt_pk_bf16_f32 v48, v48, v49
  v_min_u32 v48, -2, v48
  v_cndmask_b32 v24, v48, -1, s[18:19]
  buffer_store_dword v24, v2, s[4:7], s3 offen sc1
  s_waitcnt vmcnt(1)
  ds_read_b128 v[40:43], v7 offset:49152
  v_xor_b32 v2, s53, v2
  ds_read_b128 v[44:47], v7 offset:50176
  v_xor_b32 v29, 1024, v9
  ds_read_b128 v[48:51], v7 offset:51200
  v_xor_b32 v30, 2048, v9
  ds_read_b128 v[52:55], v7 offset:52224
  v_xor_b32 v31, 3072, v9
  ds_read_b128 v[56:59], v8 offset:0
  ds_read_b128 v[60:63], v8 offset:1024
  s_branch L_ep0_s
L_reQ0_s:
  buffer_load_dwordx4 v[56:59], v0, s[4:7], s63 offen sc1
  buffer_load_dwordx4 v[60:63], v0, s[4:7], s63 offen offset:1024 sc1
  s_sub_u32 s49, s49, 1
  s_cbranch_scc0 L_redQ0_s
  s_branch L_end
.p2align 6

L_x1_s:
  s_and_b32 s68, s50, 3
  s_lshl_b32 s68, s68, 13
  s_add_u32 s51, s68, s56
  s_add_u32 s60, s51, 4096
  s_and_b32 s68, s68, 0x2000
  s_add_u32 s3, s61, s68
  s_lshl_b32 s53, s68, 1
  s_sub_u32 s96, s57, s66
  s_add_u32 s96, s96, -8192
  s_add_u32 s57, s57, 24576
  s_add_u32 s97, s57, 8192
  s_xor_b32 s68, s66, 0x2000
  s_add_u32 m0, s68, s55
  s_cmp_gt_u32 s50, s38
  s_cselect_b32 s68, 4096, 0
  s_add_u32 s59, s59, s68
  s_add_u32 s17, s50, 1
  s_max_u32 s52, s50, 1
  s_sub_u32 s52, s52, 1
  s_and_b32 s100, s17, 1
  v_cndmask_b32 v52, 0, v11, s[70:71]
  v_cndmask_b32 v53, 0, v11, s[72:73]
  v_cndmask_b32 v54, 0, v11, s[74:75]
  v_cndmask_b32 v55, 0, v11, s[76:77]
  s_sleep 14
  s_nop 14
  buffer_load_dwordx4 v[40:43], v0, s[4:7], s63 offen sc1
  buffer_load_dwordx4 v[44:47], v0, s[4:7], s63 offen offset:1024 sc1
  ds_read_b128 v[88:91], v8 offset:2048
  ds_read_b128 v[92:95], v8 offset:3072
  ds_read_b128 v[96:99], v8 offset:16384
  ds_read_b128 v[100:103], v8 offset:17408
  ds_read_b128 v[104:107], v8 offset:18432
  ds_read_b128 v[108:111], v8 offset:19456
  ds_read_b128 v[112:115], v8 offset:32768
  ds_read_b128 v[116:119], v8 offset:33792
  ds_read_b128 v[120:123], v8 offset:34816
  ds_read_b128 v[124:127], v8 offset:35840
  s_nop 9
  buffer_load_dwordx4 v[56:59], v0, s[4:7], s63 offen sc1
  buffer_load_dwordx4 v[60:63], v0, s[4:7], s63 offen offset:1024 sc1
  s_mov_b32 s67, 0
L_redQ1_s:
  s_waitcnt vmcnt(3)
L_redP1_s:
  v_mfma_f32_16x16x32_bf16 v[48:51], v[40:43], v[52:55], 0
  s_waitcnt vmcnt(2)
  v_mfma_f32_16x16x32_bf16 v[48:51], v[44:47], v[52:55], v[48:51]
  v_xor_b32 v16, s54, v40
  v_bitop3_b32 v16, v16, v42, s54 bitop3:0xf6
  v_bitop3_b32 v16, v16, v44, s54 bitop3:0xf6
  v_bitop3_b32 v16, v16, v46, s54 bitop3:0xf6
  v_and_b32 v16, 1, v16
  v_cmp_ne_u32 vcc, 0, v16
  v_cmp_ne_u32 s[98:99], 0, v31
  s_nop 0
  v_permlane32_swap_b32 v48, v50
  v_permlane32_swap_b32 v49, v51
  v_add_f32 v48, v48, v50
  v_add_f32 v49, v49, v51
  s_cbranch_vccnz L_reP1_s
  s_nop 0
  v_permlane16_swap_b32 v48, v49
  v_add_f32 v48, v48, v49
  s_nop 1
  v_mov_b32_dpp v49, v48 quad_perm:[2,3,0,1] row_mask:0xf bank_mask:0xf
  v_cvt_pk_bf16_f32 v48, v48, v49
  v_min_u32 v48, -2, v48
  v_cndmask_b32 v24, v48, -1, s[18:19]
  buffer_store_dword v24, v2, s[4:7], s3 offen sc1
L_pub1_s:
  s_waitcnt vmcnt(1)
  ds_read_b128 v[40:43], v7 offset:49152
  v_xor_b32 v2, s53, v2
  ds_read_b128 v[44:47], v7 offset:50176
  v_xor_b32 v29, 1024, v9
  ds_read_b128 v[48:51], v7 offset:51200
  v_xor_b32 v30, 2048, v9
  ds_read_b128 v[52:55], v7 offset:52224
  v_xor_b32 v31, 3072, v9
  ds_read_b128 v[56:59], v8 offset:0
  ds_read_b128 v[60:63], v8 offset:1024
  s_nop 11
L_ep1_s:
  s_sleep 8
  s_nop 8
  buffer_load_dwordx4 v[32:35], v9, s[4:7], s51 offen sc1
  v_mov_b64 v[64:65], 0
  v_mov_b64 v[66:67], 0
  v_mov_b64 v[68:69], 0
  v_mov_b64 v[70:71], 0
  v_mov_b64 v[72:73], 0
  v_mov_b64 v[74:75], 0
  v_mov_b64 v[76:77], 0
  v_mov_b64 v[78:79], 0
  v_mov_b64 v[80:81], 0
  v_mov_b64 v[82:83], 0
  v_mov_b64 v[84:85], 0
  v_mov_b64 v[86:87], 0
  v_lshlrev_b32 v19, 1, v0
  v_mov_b32 v28, s52
  s_nop 15
  s_nop 15
  s_nop 13
  buffer_load_dwordx4 v[32:35], v9, s[4:7], s51 offen sc1
  s_nop 14
  buffer_load_dwordx4 v[36:39], v9, s[4:7], s60 offen sc1
  s_cmp_eq_u32 s50, 63
  s_cbranch_scc1 L_last_s
  s_bitcmp1_b64 s[98:99], s17
  s_waitcnt lgkmcnt(0)
  s_cbranch_scc1 L_step_s
  s_branch L_flag_s
L_reP1_s:
  buffer_load_dwordx4 v[40:43], v0, s[4:7], s63 offen sc1
  buffer_load_dwordx4 v[44:47], v0, s[4:7], s63 offen offset:1024 sc1
  s_waitcnt vmcnt(3)
  v_mfma_f32_16x16x32_bf16 v[48:51], v[56:59], v[52:55], 0
  s_waitcnt vmcnt(2)
  v_mfma_f32_16x16x32_bf16 v[48:51], v[60:63], v[52:55], v[48:51]
  v_xor_b32 v16, s54, v56
  v_bitop3_b32 v16, v16, v58, s54 bitop3:0xf6
  v_bitop3_b32 v16, v16, v60, s54 bitop3:0xf6
  v_bitop3_b32 v16, v16, v62, s54 bitop3:0xf6
  v_and_b32 v16, 1, v16
  v_cmp_ne_u32 vcc, 0, v16
  v_cmp_ne_u32 s[98:99], 0, v31
  s_nop 0
  v_permlane32_swap_b32 v48, v50
  v_permlane32_swap_b32 v49, v51
  v_add_f32 v48, v48, v50
  v_add_f32 v49, v49, v51
  s_cbranch_vccnz L_reQ1_s
  s_nop 0
  v_permlane16_swap_b32 v48, v49
  v_add_f32 v48, v48, v49
  s_nop 1
  v_mov_b32_dpp v49, v48 quad_perm:[2,3,0,1] row_mask:0xf bank_mask:0xf
  v_cvt_pk_bf16_f32 v48, v48, v49
  v_min_u32 v48, -2, v48
  v_cndmask_b32 v24, v48, -1, s[18:19]
  buffer_store_dword v24, v2, s[4:7], s3 offen sc1
  s_waitcnt vmcnt(1)
  ds_read_b128 v[40:43], v7 offset:49152
  v_xor_b32 v2, s53, v2
  ds_read_b128 v[44:47], v7 offset:50176
  v_xor_b32 v29, 1024, v9
  ds_read_b128 v[48:51], v7 offset:51200
  v_xor_b32 v30, 2048, v9
  ds_read_b128 v[52:55], v7 offset:52224
  v_xor_b32 v31, 3072, v9
  ds_read_b128 v[56:59], v8 offset:0
  ds_read_b128 v[60:63], v8 offset:1024
  s_branch L_ep1_s
L_reQ1_s:
  buffer_load_dwordx4 v[56:59], v0, s[4:7], s63 offen sc1
  buffer_load_dwordx4 v[60:63], v0, s[4:7], s63 offen offset:1024 sc1
  s_sub_u32 s49, s49, 1
  s_cbranch_scc0 L_redQ1_s
  s_branch L_end
L_flag_s:
  v_lshrrev_b32 v16, 2, v0
  buffer_load_dword v16, v16, s[4:7], s64 offen sc1
  s_sub_u32 s49, s49, 1
  s_cbranch_scc1 L_end
  s_waitcnt vmcnt(0)
  v_cmp_ne_u32 s[98:99], 0, v16
  s_nop 0
  s_bitcmp1_b64 s[98:99], s17
  s_cbranch_scc1 L_step_s
  s_branch L_flag_s
L_retE_s:
  buffer_load_dwordx4 v[32:35], v9, s[4:7], s51 offen sc1
  buffer_load_dwordx4 v[36:39], v9, s[4:7], s60 offen sc1
  s_sub_u32 s49, s49, 1
  s_waitcnt vmcnt(3)
  s_cbranch_scc0 L_chkE_s
  s_branch L_end
L_retL_s:
  buffer_load_dwordx4 v[36:39], v9, s[4:7], s60 offen sc1
  s_sub_u32 s49, s49, 1
  s_cbranch_scc1 L_end
  s_bitcmp1_b32 s67, 0
  s_bitset1_b32 s67, 0
  s_waitcnt vmcnt(1)
  s_cbranch_scc0 L_retL1_s
  s_waitcnt vmcnt(1)
L_retL1_s:
  v_max3_u32 v16, v36, v37, v38
  v_max_u32 v16, v16, v39
  v_cmp_eq_u32 vcc, -1, v16
  ds_write_b128 v9, v[36:39] offset:4096
  s_cbranch_vccz L_okL_s
  s_branch L_retL_s
L_lret_s:
  buffer_load_dwordx4 v[32:35], v9, s[4:7], s51 offen sc1
  buffer_load_dwordx4 v[36:39], v9, s[4:7], s60 offen sc1
  s_sub_u32 s49, s49, 1
  s_cbranch_scc1 L_end
L_last_s:
  s_waitcnt vmcnt(0) lgkmcnt(0)
  v_max3_u32 v16, v32, v33, v34
  v_max3_u32 v16, v16, v35, v36
  v_max3_u32 v16, v16, v37, v38
  v_max_u32 v16, v16, v39
  v_cmp_eq_u32 vcc, -1, v16
  ds_write_b128 v9, v[32:35]
  ds_write_b128 v9, v[36:39] offset:4096
  s_cbranch_vccnz L_lret_s
  v_smfmac_f32_16x16x64_bf16 v[72:75], v[32:35], v[56:63], v10
  buffer_store_dwordx4 v[12:15], v0, s[4:7], s59 offen sc1
  v_smfmac_f32_16x16x64_bf16 v[76:79], v[32:35], v[88:95], v10
  v_smfmac_f32_16x16x64_bf16 v[80:83], v[32:35], a[176:183], v10
  v_smfmac_f32_16x16x64_bf16 v[84:87], v[32:35], a[240:247], v10
  s_mov_b64 exec, 1
  buffer_store_dword v28, off, s[4:7], s65 sc1
  s_mov_b64 exec, -1
  s_waitcnt lgkmcnt(0)
  s_barrier
  ds_read_b128 v[40:43], v29 offset:0
  ds_read_b128 v[44:47], v29 offset:4096
  v_smfmac_f32_16x16x64_bf16 v[72:75], v[36:39], v[112:119], v10
  ds_read_b128 v[48:51], v30 offset:0
  v_smfmac_f32_16x16x64_bf16 v[76:79], v[36:39], v[120:127], v10
  ds_read_b128 v[52:55], v30 offset:4096
  v_smfmac_f32_16x16x64_bf16 v[80:83], v[36:39], a[184:191], v10
  ds_read_b128 v[56:59], v31 offset:0
  v_smfmac_f32_16x16x64_bf16 v[84:87], v[36:39], a[248:255], v10
  ds_read_b128 v[60:63], v31 offset:4096
  s_waitcnt lgkmcnt(5)
  v_smfmac_f32_16x16x64_bf16 v[72:75], v[40:43], a[80:87], v10
  v_smfmac_f32_16x16x64_bf16 v[76:79], v[40:43], a[128:135], v10
  v_smfmac_f32_16x16x64_bf16 v[80:83], v[40:43], a[192:199], v10
  v_smfmac_f32_16x16x64_bf16 v[84:87], v[40:43], v[128:135], v10
  s_waitcnt lgkmcnt(4)
  v_smfmac_f32_16x16x64_bf16 v[72:75], v[44:47], a[88:95], v10
  v_smfmac_f32_16x16x64_bf16 v[76:79], v[44:47], a[136:143], v10
  v_smfmac_f32_16x16x64_bf16 v[80:83], v[44:47], a[200:207], v10
  v_smfmac_f32_16x16x64_bf16 v[84:87], v[44:47], v[136:143], v10
  s_waitcnt lgkmcnt(3)
  v_smfmac_f32_16x16x64_bf16 v[72:75], v[48:51], a[96:103], v10
  v_smfmac_f32_16x16x64_bf16 v[76:79], v[48:51], a[144:151], v10
  v_smfmac_f32_16x16x64_bf16 v[80:83], v[48:51], a[208:215], v10
  v_smfmac_f32_16x16x64_bf16 v[84:87], v[48:51], v[144:151], v10
  s_waitcnt lgkmcnt(2)
  v_smfmac_f32_16x16x64_bf16 v[72:75], v[52:55], a[104:111], v10
  v_smfmac_f32_16x16x64_bf16 v[76:79], v[52:55], a[152:159], v10
  v_smfmac_f32_16x16x64_bf16 v[80:83], v[52:55], a[216:223], v10
  v_smfmac_f32_16x16x64_bf16 v[84:87], v[52:55], v[152:159], v10
  s_waitcnt lgkmcnt(1)
  v_smfmac_f32_16x16x64_bf16 v[72:75], v[56:59], a[112:119], v10
  s_waitcnt lgkmcnt(0)
  v_smfmac_f32_16x16x64_bf16 v[72:75], v[60:63], a[120:127], v10
  v_smfmac_f32_16x16x64_bf16 v[76:79], v[56:59], a[160:167], v10
  v_smfmac_f32_16x16x64_bf16 v[76:79], v[60:63], a[168:175], v10
  v_smfmac_f32_16x16x64_bf16 v[80:83], v[56:59], a[224:231], v10
  v_smfmac_f32_16x16x64_bf16 v[80:83], v[60:63], a[232:239], v10
  v_smfmac_f32_16x16x64_bf16 v[84:87], v[56:59], v[160:167], v10
  v_smfmac_f32_16x16x64_bf16 v[84:87], v[60:63], v[168:175], v10
  s_nop 1
  v_add_f32 v72, v72, v73
  v_add_f32 v74, v74, v75
  v_cvt_pk_bf16_f32 v12, v72, v74
  v_add_f32 v76, v76, v77
  v_add_f32 v78, v78, v79
  v_cvt_pk_bf16_f32 v13, v76, v78
  v_add_f32 v80, v80, v81
  v_add_f32 v82, v82, v83
  v_cvt_pk_bf16_f32 v14, v80, v82
  v_add_f32 v84, v84, v85
  v_add_f32 v86, v86, v87
  v_cvt_pk_bf16_f32 v15, v84, v86
  s_branch L_final
L_final:
  s_add_u32 s59, s59, 4096
  buffer_store_dwordx4 v[12:15], v0, s[4:7], s59 offen sc1
  s_waitcnt lgkmcnt(0)
  s_waitcnt vmcnt(0)
  s_branch L_end
L_worker:
  s_sub_u32 s50, s47, 32
  s_sub_u32 s63, s50, 32
  s_cmp_lt_u32 s63, 180
  s_cbranch_scc1 L_proj
  s_waitcnt vmcnt(0)
  s_cmp_lg_u32 s46, 0
  s_cbranch_scc1 L_cf_sp
  s_waitcnt vmcnt(0)
  v_readfirstlane_b32 s1, v127
  s_cmp_lg_u32 s101, 0
  s_cselect_b32 s1, 0, s1
  s_bitcmp1_b32 s1, s47
  s_cbranch_scc1 L_reclaim
  v_mov_b32 v127, s47
  v_mov_b32 v126, 33408
  ds_write_b32 v126, v127
  v_mov_b32 v127, 1
  s_mov_b64 exec, 1
  buffer_atomic_add v127, off, s[8:11], 0 offset:128
  s_mov_b64 exec, -1
  s_waitcnt lgkmcnt(0)
L_cf_sp:
  s_barrier
  v_mov_b32 v126, 33408
  ds_read_b32 v126, v126
  s_waitcnt lgkmcnt(0)
  v_readfirstlane_b32 s0, v126
  s_nop 0
  s_cmp_lg_u32 s0, s47
  s_cbranch_scc1 L_restart
  s_cmp_lt_u32 s50, 32
  s_cbranch_scc1 L_end
L_wi_sp:
  s_sleep 127
  buffer_load_dword v3, off, s[8:11], 0 offset:128 sc1
  s_sub_u32 s49, s49, 1
  s_cbranch_scc1 L_end
  s_waitcnt vmcnt(0)
  v_readfirstlane_b32 s51, v3
  s_nop 0
  s_and_b32 s51, s51, 0xffff
  s_cmp_eq_u32 s51, 256
  s_cbranch_scc0 L_wi_sp
  s_branch L_phase2
L_proj:
  s_mul_i32 s53, s63, 205
  s_lshr_b32 s53, s53, 10
  s_mul_i32 s51, s53, 5
  s_sub_u32 s54, s63, s51
  s_cmp_lt_u32 s53, 32
  s_cselect_b32 s64, s30, s22
  s_cselect_b32 s65, s31, s23
  s_mov_b32 s66, 1572864
  s_cselect_b32 s66, 4194304, s66
  s_mov_b32 s67, 0x20000
  s_cselect_b32 s68, s32, s22
  s_cselect_b32 s69, s33, s23
  s_mov_b32 s70, 1572864
  s_cselect_b32 s70, 4194304, s70
  s_mov_b32 s71, 0x20000
  s_cselect_b32 s72, s34, s22
  s_cselect_b32 s73, s35, s23
  s_mov_b32 s74, 1572864
  s_cselect_b32 s74, 4194304, s74
  s_mov_b32 s75, 0x20000
  s_cselect_b32 s76, s26, s20
  s_cselect_b32 s77, s27, s21
  s_mov_b32 s78, 2097152
  s_cselect_b32 s78, 2097152, s78
  s_mov_b32 s79, 0x20000
  s_mov_b32 s55, 3072
  s_cselect_b32 s55, 8192, s55
  s_cselect_b32 s61, 0, 1024
  s_and_b32 s56, s53, 31
  s_lshl_b32 s56, s56, 8
  v_and_b32 v1, 63, v0
  v_lshlrev_b32 v3, 4, v1
  v_and_b32 v4, 39, v1
  v_bfe_u32 v2, v1, 3, 1
  v_lshl_or_b32 v4, v2, 4, v4
  v_bfe_u32 v2, v1, 4, 1
  v_lshl_or_b32 v4, v2, 3, v4
  v_lshlrev_b32 v4, 4, v4
  v_lshrrev_b32 v2, 4, v1
  v_mul_lo_u32 v5, v2, s55
  v_lshlrev_b32 v2, 2, v2
  v_xor_b32 v2, v2, v1
  v_and_b32 v2, 15, v2
  v_lshl_add_u32 v5, v2, 4, v5
  v_lshrrev_b32 v2, 5, v1
  v_lshlrev_b32 v6, 11, v2
  v_bfe_u32 v2, v1, 2, 2
  v_lshl_add_u32 v6, v2, 8, v6
  v_bfe_u32 v2, v1, 4, 1
  v_lshl_add_u32 v6, v2, 5, v6
  v_and_b32 v2, 3, v1
  v_lshl_add_u32 v6, v2, 3, v6
  v_bfe_u32 v2, v1, 2, 2
  v_xor_b32 v2, s46, v2
  v_lshl_add_u32 v6, v2, 6, v6
  v_and_b32 v2, 31, v1
  v_mul_u32_u24 v7, 1040, v2
  v_lshrrev_b32 v2, 5, v1
  v_lshl_add_u32 v7, v2, 4, v7
  s_lshl_b32 s51, s53, 6
  s_add_u32 s51, s51, s54
  s_mul_i32 s57, s51, 24576
  s_lshl_b32 s52, s46, 11
  s_add_u32 s57, s57, s52
  s_lshl_b32 s58, s51, 2
  s_add_u32 s58, s58, 84475904
  s_mov_b32 s59, 0
  s_lshl_b32 s51, s54, 15
  s_lshl_b32 s52, s46, 13
  s_add_u32 s51, s51, s52
  s_mul_i32 s52, s46, 8320
  s_add_u32 s52, s52, s59
  s_add_u32 m0, s52, 0
  s_add_u32 s3, s51, 0
  buffer_load_dwordx4 v3, s[76:79], s3 offen lds
  s_add_u32 m0, s52, 1040
  s_add_u32 s3, s51, 1024
  buffer_load_dwordx4 v3, s[76:79], s3 offen lds
  s_add_u32 m0, s52, 2080
  s_add_u32 s3, s51, 2048
  buffer_load_dwordx4 v3, s[76:79], s3 offen lds
  s_add_u32 m0, s52, 3120
  s_add_u32 s3, s51, 3072
  buffer_load_dwordx4 v3, s[76:79], s3 offen lds
  s_add_u32 m0, s52, 4160
  s_add_u32 s3, s51, 4096
  buffer_load_dwordx4 v3, s[76:79], s3 offen lds
  s_add_u32 m0, s52, 5200
  s_add_u32 s3, s51, 5120
  buffer_load_dwordx4 v3, s[76:79], s3 offen lds
  s_add_u32 m0, s52, 6240
  s_add_u32 s3, s51, 6144
  buffer_load_dwordx4 v3, s[76:79], s3 offen lds
  s_add_u32 m0, s52, 7280
  s_add_u32 s3, s51, 7168
  buffer_load_dwordx4 v3, s[76:79], s3 offen lds
  s_lshl_b32 s51, s46, 4
  s_mul_i32 s60, s51, s55
  s_add_u32 s60, s60, s56
  s_lshl_b32 s62, s55, 2
  s_lshl_b32 s63, s46, 12
  s_mul_i32 s51, s55, 0
  s_add_u32 s51, s51, s60
  s_mul_i32 s52, s61, 0
  s_add_u32 s51, s51, s52
  s_add_u32 m0, s63, 33792
  s_nop 0
  buffer_load_dwordx4 v5, s[64:67], s51 offen lds
  s_add_u32 s51, s51, s62
  s_add_u32 m0, s63, 34816
  s_nop 0
  buffer_load_dwordx4 v5, s[64:67], s51 offen lds
  s_add_u32 s51, s51, s62
  s_add_u32 m0, s63, 35840
  s_nop 0
  buffer_load_dwordx4 v5, s[64:67], s51 offen lds
  s_add_u32 s51, s51, s62
  s_add_u32 m0, s63, 36864
  s_nop 0
  buffer_load_dwordx4 v5, s[64:67], s51 offen lds
  s_mul_i32 s51, s55, 64
  s_add_u32 s51, s51, s60
  s_mul_i32 s52, s61, 0
  s_add_u32 s51, s51, s52
  s_add_u32 m0, s63, 50176
  s_nop 0
  buffer_load_dwordx4 v5, s[64:67], s51 offen lds
  s_add_u32 s51, s51, s62
  s_add_u32 m0, s63, 51200
  s_nop 0
  buffer_load_dwordx4 v5, s[64:67], s51 offen lds
  s_add_u32 s51, s51, s62
  s_add_u32 m0, s63, 52224
  s_nop 0
  buffer_load_dwordx4 v5, s[64:67], s51 offen lds
  s_add_u32 s51, s51, s62
  s_add_u32 m0, s63, 53248
  s_nop 0
  buffer_load_dwordx4 v5, s[64:67], s51 offen lds
  s_mul_i32 s51, s55, 128
  s_add_u32 s51, s51, s60
  s_mul_i32 s52, s61, 0
  s_add_u32 s51, s51, s52
  s_add_u32 m0, s63, 66560
  s_nop 0
  buffer_load_dwordx4 v5, s[64:67], s51 offen lds
  s_add_u32 s51, s51, s62
  s_add_u32 m0, s63, 67584
  s_nop 0
  buffer_load_dwordx4 v5, s[64:67], s51 offen lds
  s_add_u32 s51, s51, s62
  s_add_u32 m0, s63, 68608
  s_nop 0
  buffer_load_dwordx4 v5, s[64:67], s51 offen lds
  s_add_u32 s51, s51, s62
  s_add_u32 m0, s63, 69632
  s_nop 0
  buffer_load_dwordx4 v5, s[64:67], s51 offen lds
  s_mul_i32 s51, s55, 192
  s_add_u32 s51, s51, s60
  s_mul_i32 s52, s61, 0
  s_add_u32 s51, s51, s52
  s_add_u32 m0, s63, 82944
  s_nop 0
  buffer_load_dwordx4 v5, s[64:67], s51 offen lds
  s_add_u32 s51, s51, s62
  s_add_u32 m0, s63, 83968
  s_nop 0
  buffer_load_dwordx4 v5, s[64:67], s51 offen lds
  s_add_u32 s51, s51, s62
  s_add_u32 m0, s63, 84992
  s_nop 0
  buffer_load_dwordx4 v5, s[64:67], s51 offen lds
  s_add_u32 s51, s51, s62
  s_add_u32 m0, s63, 86016
  s_nop 0
  buffer_load_dwordx4 v5, s[64:67], s51 offen lds
  s_mul_i32 s51, s55, 256
  s_add_u32 s51, s51, s60
  s_mul_i32 s52, s61, 0
  s_add_u32 s51, s51, s52
  s_add_u32 m0, s63, 99328
  s_nop 0
  buffer_load_dwordx4 v5, s[64:67], s51 offen lds
  s_add_u32 s51, s51, s62
  s_add_u32 m0, s63, 100352
  s_nop 0
  buffer_load_dwordx4 v5, s[64:67], s51 offen lds
  s_add_u32 s51, s51, s62
  s_add_u32 m0, s63, 101376
  s_nop 0
  buffer_load_dwordx4 v5, s[64:67], s51 offen lds
  s_add_u32 s51, s51, s62
  s_add_u32 m0, s63, 102400
  s_nop 0
  buffer_load_dwordx4 v5, s[64:67], s51 offen lds
  s_mul_i32 s51, s55, 320
  s_add_u32 s51, s51, s60
  s_mul_i32 s52, s61, 0
  s_add_u32 s51, s51, s52
  s_add_u32 m0, s63, 115712
  s_nop 0
  buffer_load_dwordx4 v5, s[64:67], s51 offen lds
  s_add_u32 s51, s51, s62
  s_add_u32 m0, s63, 116736
  s_nop 0
  buffer_load_dwordx4 v5, s[64:67], s51 offen lds
  s_add_u32 s51, s51, s62
  s_add_u32 m0, s63, 117760
  s_nop 0
  buffer_load_dwordx4 v5, s[64:67], s51 offen lds
  s_add_u32 s51, s51, s62
  s_add_u32 m0, s63, 118784
  s_nop 0
  buffer_load_dwordx4 v5, s[64:67], s51 offen lds
  s_cmp_lg_u32 s46, 0
  s_cbranch_scc1 L_cf_pj
  s_waitcnt vmcnt(32)
  v_readfirstlane_b32 s1, v127
  s_cmp_lg_u32 s101, 0
  s_cselect_b32 s1, 0, s1
  s_bitcmp1_b32 s1, s47
  s_cbranch_scc1 L_reclaim
  v_mov_b32 v127, s47
  v_mov_b32 v126, 33408
  ds_write_b32 v126, v127
  v_mov_b32 v127, 1
  s_mov_b64 exec, 1
  buffer_atomic_add v127, off, s[8:11], 0 offset:128
  s_mov_b64 exec, -1
  s_waitcnt lgkmcnt(0)
L_cf_pj:
  s_barrier
  v_mov_b32 v126, 33408
  ds_read_b32 v126, v126
  s_waitcnt lgkmcnt(0)
  v_readfirstlane_b32 s0, v126
  s_nop 0
  s_cmp_lg_u32 s0, s47
  s_cbranch_scc1 L_restart
  s_waitcnt vmcnt(20)
  s_barrier
  s_mul_i32 s51, s55, 384
  s_add_u32 s51, s51, s60
  s_mul_i32 s52, s61, 0
  s_add_u32 s51, s51, s52
  s_add_u32 m0, s63, 132096
  s_nop 0
  buffer_load_dwordx4 v5, s[64:67], s51 offen lds
  s_add_u32 s51, s51, s62
  s_add_u32 m0, s63, 133120
  s_nop 0
  buffer_load_dwordx4 v5, s[64:67], s51 offen lds
  s_add_u32 s51, s51, s62
  s_add_u32 m0, s63, 134144
  s_nop 0
  buffer_load_dwordx4 v5, s[64:67], s51 offen lds
  s_add_u32 s51, s51, s62
  s_add_u32 m0, s63, 135168
  s_nop 0
  buffer_load_dwordx4 v5, s[64:67], s51 offen lds
  v_add_u32 v10, 33792, v6
  ds_read_b64_tr_b16 a[0:1], v10 offset:0
  ds_read_b64_tr_b16 a[2:3], v10 offset:1024
  ds_read_b64_tr_b16 a[4:5], v10 offset:4096
  ds_read_b64_tr_b16 a[6:7], v10 offset:5120
  ds_read_b64_tr_b16 a[8:9], v10 offset:8192
  ds_read_b64_tr_b16 a[10:11], v10 offset:9216
  ds_read_b64_tr_b16 a[12:13], v10 offset:12288
  ds_read_b64_tr_b16 a[14:15], v10 offset:13312
  s_waitcnt vmcnt(20) lgkmcnt(0)
  s_barrier
  s_mul_i32 s51, s55, 448
  s_add_u32 s51, s51, s60
  s_mul_i32 s52, s61, 0
  s_add_u32 s51, s51, s52
  s_add_u32 m0, s63, 33792
  s_nop 0
  buffer_load_dwordx4 v5, s[64:67], s51 offen lds
  s_add_u32 s51, s51, s62
  s_add_u32 m0, s63, 34816
  s_nop 0
  buffer_load_dwordx4 v5, s[64:67], s51 offen lds
  s_add_u32 s51, s51, s62
  s_add_u32 m0, s63, 35840
  s_nop 0
  buffer_load_dwordx4 v5, s[64:67], s51 offen lds
  s_add_u32 s51, s51, s62
  s_add_u32 m0, s63, 36864
  s_nop 0
  buffer_load_dwordx4 v5, s[64:67], s51 offen lds
  v_add_u32 v10, 50176, v6
  ds_read_b64_tr_b16 a[16:17], v10 offset:0
  ds_read_b64_tr_b16 a[18:19], v10 offset:1024
  ds_read_b64_tr_b16 a[20:21], v10 offset:4096
  ds_read_b64_tr_b16 a[22:23], v10 offset:5120
  ds_read_b64_tr_b16 a[24:25], v10 offset:8192
  ds_read_b64_tr_b16 a[26:27], v10 offset:9216
  ds_read_b64_tr_b16 a[28:29], v10 offset:12288
  ds_read_b64_tr_b16 a[30:31], v10 offset:13312
  s_waitcnt vmcnt(20) lgkmcnt(0)
  s_barrier
  s_mul_i32 s51, s55, 0
  s_add_u32 s51, s51, s60
  s_mul_i32 s52, s61, 1
  s_add_u32 s51, s51, s52
  s_add_u32 m0, s63, 50176
  s_nop 0
  buffer_load_dwordx4 v5, s[68:71], s51 offen lds
  s_add_u32 s51, s51, s62
  s_add_u32 m0, s63, 51200
  s_nop 0
  buffer_load_dwordx4 v5, s[68:71], s51 offen lds
  s_add_u32 s51, s51, s62
  s_add_u32 m0, s63, 52224
  s_nop 0
  buffer_load_dwordx4 v5, s[68:71], s51 offen lds
  s_add_u32 s51, s51, s62
  s_add_u32 m0, s63, 53248
  s_nop 0
  buffer_load_dwordx4 v5, s[68:71], s51 offen lds
  v_add_u32 v10, 66560, v6
  ds_read_b64_tr_b16 a[32:33], v10 offset:0
  ds_read_b64_tr_b16 a[34:35], v10 offset:1024
  ds_read_b64_tr_b16 a[36:37], v10 offset:4096
  ds_read_b64_tr_b16 a[38:39], v10 offset:5120
  ds_read_b64_tr_b16 a[40:41], v10 offset:8192
  ds_read_b64_tr_b16 a[42:43], v10 offset:9216
  ds_read_b64_tr_b16 a[44:45], v10 offset:12288
  ds_read_b64_tr_b16 a[46:47], v10 offset:13312
  s_waitcnt vmcnt(20) lgkmcnt(0)
  s_barrier
  s_mul_i32 s51, s55, 64
  s_add_u32 s51, s51, s60
  s_mul_i32 s52, s61, 1
  s_add_u32 s51, s51, s52
  s_add_u32 m0, s63, 66560
  s_nop 0
  buffer_load_dwordx4 v5, s[68:71], s51 offen lds
  s_add_u32 s51, s51, s62
  s_add_u32 m0, s63, 67584
  s_nop 0
  buffer_load_dwordx4 v5, s[68:71], s51 offen lds
  s_add_u32 s51, s51, s62
  s_add_u32 m0, s63, 68608
  s_nop 0
  buffer_load_dwordx4 v5, s[68:71], s51 offen lds
  s_add_u32 s51, s51, s62
  s_add_u32 m0, s63, 69632
  s_nop 0
  buffer_load_dwordx4 v5, s[68:71], s51 offen lds
  v_add_u32 v10, 82944, v6
  ds_read_b64_tr_b16 a[48:49], v10 offset:0
  ds_read_b64_tr_b16 a[50:51], v10 offset:1024
  ds_read_b64_tr_b16 a[52:53], v10 offset:4096
  ds_read_b64_tr_b16 a[54:55], v10 offset:5120
  ds_read_b64_tr_b16 a[56:57], v10 offset:8192
  ds_read_b64_tr_b16 a[58:59], v10 offset:9216
  ds_read_b64_tr_b16 a[60:61], v10 offset:12288
  ds_read_b64_tr_b16 a[62:63], v10 offset:13312
  s_waitcnt vmcnt(20) lgkmcnt(0)
  s_barrier
  s_mul_i32 s51, s55, 128
  s_add_u32 s51, s51, s60
  s_mul_i32 s52, s61, 1
  s_add_u32 s51, s51, s52
  s_add_u32 m0, s63, 82944
  s_nop 0
  buffer_load_dwordx4 v5, s[68:71], s51 offen lds
  s_add_u32 s51, s51, s62
  s_add_u32 m0, s63, 83968
  s_nop 0
  buffer_load_dwordx4 v5, s[68:71], s51 offen lds
  s_add_u32 s51, s51, s62
  s_add_u32 m0, s63, 84992
  s_nop 0
  buffer_load_dwordx4 v5, s[68:71], s51 offen lds
  s_add_u32 s51, s51, s62
  s_add_u32 m0, s63, 86016
  s_nop 0
  buffer_load_dwordx4 v5, s[68:71], s51 offen lds
  v_add_u32 v10, 99328, v6
  ds_read_b64_tr_b16 a[64:65], v10 offset:0
  ds_read_b64_tr_b16 a[66:67], v10 offset:1024
  ds_read_b64_tr_b16 a[68:69], v10 offset:4096
  ds_read_b64_tr_b16 a[70:71], v10 offset:5120
  ds_read_b64_tr_b16 a[72:73], v10 offset:8192
  ds_read_b64_tr_b16 a[74:75], v10 offset:9216
  ds_read_b64_tr_b16 a[76:77], v10 offset:12288
  ds_read_b64_tr_b16 a[78:79], v10 offset:13312
  s_waitcnt vmcnt(20) lgkmcnt(0)
  s_barrier
  s_mul_i32 s51, s55, 192
  s_add_u32 s51, s51, s60
  s_mul_i32 s52, s61, 1
  s_add_u32 s51, s51, s52
  s_add_u32 m0, s63, 99328
  s_nop 0
  buffer_load_dwordx4 v5, s[68:71], s51 offen lds
  s_add_u32 s51, s51, s62
  s_add_u32 m0, s63, 100352
  s_nop 0
  buffer_load_dwordx4 v5, s[68:71], s51 offen lds
  s_add_u32 s51, s51, s62
  s_add_u32 m0, s63, 101376
  s_nop 0
  buffer_load_dwordx4 v5, s[68:71], s51 offen lds
  s_add_u32 s51, s51, s62
  s_add_u32 m0, s63, 102400
  s_nop 0
  buffer_load_dwordx4 v5, s[68:71], s51 offen lds
  v_add_u32 v10, 115712, v6
  ds_read_b64_tr_b16 a[80:81], v10 offset:0
  ds_read_b64_tr_b16 a[82:83], v10 offset:1024
  ds_read_b64_tr_b16 a[84:85], v10 offset:4096
  ds_read_b64_tr_b16 a[86:87], v10 offset:5120
  ds_read_b64_tr_b16 a[88:89], v10 offset:8192
  ds_read_b64_tr_b16 a[90:91], v10 offset:9216
  ds_read_b64_tr_b16 a[92:93], v10 offset:12288
  ds_read_b64_tr_b16 a[94:95], v10 offset:13312
  s_waitcnt vmcnt(20) lgkmcnt(0)
  s_barrier
  s_mul_i32 s51, s55, 256
  s_add_u32 s51, s51, s60
  s_mul_i32 s52, s61, 1
  s_add_u32 s51, s51, s52
  s_add_u32 m0, s63, 115712
  s_nop 0
  buffer_load_dwordx4 v5, s[68:71], s51 offen lds
  s_add_u32 s51, s51, s62
  s_add_u32 m0, s63, 116736
  s_nop 0
  buffer_load_dwordx4 v5, s[68:71], s51 offen lds
  s_add_u32 s51, s51, s62
  s_add_u32 m0, s63, 117760
  s_nop 0
  buffer_load_dwordx4 v5, s[68:71], s51 offen lds
  s_add_u32 s51, s51, s62
  s_add_u32 m0, s63, 118784
  s_nop 0
  buffer_load_dwordx4 v5, s[68:71], s51 offen lds
  v_add_u32 v10, 132096, v6
  ds_read_b64_tr_b16 a[96:97], v10 offset:0
  ds_read_b64_tr_b16 a[98:99], v10 offset:1024
  ds_read_b64_tr_b16 a[100:101], v10 offset:4096
  ds_read_b64_tr_b16 a[102:103], v10 offset:5120
  ds_read_b64_tr_b16 a[104:105], v10 offset:8192
  ds_read_b64_tr_b16 a[106:107], v10 offset:9216
  ds_read_b64_tr_b16 a[108:109], v10 offset:12288
  ds_read_b64_tr_b16 a[110:111], v10 offset:13312
  s_waitcnt vmcnt(20) lgkmcnt(0)
  s_barrier
  s_mul_i32 s51, s55, 320
  s_add_u32 s51, s51, s60
  s_mul_i32 s52, s61, 1
  s_add_u32 s51, s51, s52
  s_add_u32 m0, s63, 132096
  s_nop 0
  buffer_load_dwordx4 v5, s[68:71], s51 offen lds
  s_add_u32 s51, s51, s62
  s_add_u32 m0, s63, 133120
  s_nop 0
  buffer_load_dwordx4 v5, s[68:71], s51 offen lds
  s_add_u32 s51, s51, s62
  s_add_u32 m0, s63, 134144
  s_nop 0
  buffer_load_dwordx4 v5, s[68:71], s51 offen lds
  s_add_u32 s51, s51, s62
  s_add_u32 m0, s63, 135168
  s_nop 0
  buffer_load_dwordx4 v5, s[68:71], s51 offen lds
  v_add_u32 v10, 33792, v6
  ds_read_b64_tr_b16 a[112:113], v10 offset:0
  ds_read_b64_tr_b16 a[114:115], v10 offset:1024
  ds_read_b64_tr_b16 a[116:117], v10 offset:4096
  ds_read_b64_tr_b16 a[118:119], v10 offset:5120
  ds_read_b64_tr_b16 a[120:121], v10 offset:8192
  ds_read_b64_tr_b16 a[122:123], v10 offset:9216
  ds_read_b64_tr_b16 a[124:125], v10 offset:12288
  ds_read_b64_tr_b16 a[126:127], v10 offset:13312
  s_waitcnt vmcnt(20) lgkmcnt(0)
  s_barrier
  s_mul_i32 s51, s55, 384
  s_add_u32 s51, s51, s60
  s_mul_i32 s52, s61, 1
  s_add_u32 s51, s51, s52
  s_add_u32 m0, s63, 33792
  s_nop 0
  buffer_load_dwordx4 v5, s[68:71], s51 offen lds
  s_add_u32 s51, s51, s62
  s_add_u32 m0, s63, 34816
  s_nop 0
  buffer_load_dwordx4 v5, s[68:71], s51 offen lds
  s_add_u32 s51, s51, s62
  s_add_u32 m0, s63, 35840
  s_nop 0
  buffer_load_dwordx4 v5, s[68:71], s51 offen lds
  s_add_u32 s51, s51, s62
  s_add_u32 m0, s63, 36864
  s_nop 0
  buffer_load_dwordx4 v5, s[68:71], s51 offen lds
  v_add_u32 v10, 50176, v6
  ds_read_b64_tr_b16 a[128:129], v10 offset:0
  ds_read_b64_tr_b16 a[130:131], v10 offset:1024
  ds_read_b64_tr_b16 a[132:133], v10 offset:4096
  ds_read_b64_tr_b16 a[134:135], v10 offset:5120
  ds_read_b64_tr_b16 a[136:137], v10 offset:8192
  ds_read_b64_tr_b16 a[138:139], v10 offset:9216
  ds_read_b64_tr_b16 a[140:141], v10 offset:12288
  ds_read_b64_tr_b16 a[142:143], v10 offset:13312
  s_waitcnt vmcnt(20) lgkmcnt(0)
  s_barrier
  s_mul_i32 s51, s55, 448
  s_add_u32 s51, s51, s60
  s_mul_i32 s52, s61, 1
  s_add_u32 s51, s51, s52
  s_add_u32 m0, s63, 50176
  s_nop 0
  buffer_load_dwordx4 v5, s[68:71], s51 offen lds
  s_add_u32 s51, s51, s62
  s_add_u32 m0, s63, 51200
  s_nop 0
  buffer_load_dwordx4 v5, s[68:71], s51 offen lds
  s_add_u32 s51, s51, s62
  s_add_u32 m0, s63, 52224
  s_nop 0
  buffer_load_dwordx4 v5, s[68:71], s51 offen lds
  s_add_u32 s51, s51, s62
  s_add_u32 m0, s63, 53248
  s_nop 0
  buffer_load_dwordx4 v5, s[68:71], s51 offen lds
  v_add_u32 v10, 66560, v6
  ds_read_b64_tr_b16 a[144:145], v10 offset:0
  ds_read_b64_tr_b16 a[146:147], v10 offset:1024
  ds_read_b64_tr_b16 a[148:149], v10 offset:4096
  ds_read_b64_tr_b16 a[150:151], v10 offset:5120
  ds_read_b64_tr_b16 a[152:153], v10 offset:8192
  ds_read_b64_tr_b16 a[154:155], v10 offset:9216
  ds_read_b64_tr_b16 a[156:157], v10 offset:12288
  ds_read_b64_tr_b16 a[158:159], v10 offset:13312
  s_waitcnt vmcnt(20) lgkmcnt(0)
  s_barrier
  s_mul_i32 s51, s55, 0
  s_add_u32 s51, s51, s60
  s_mul_i32 s52, s61, 2
  s_add_u32 s51, s51, s52
  s_add_u32 m0, s63, 66560
  s_nop 0
  buffer_load_dwordx4 v5, s[72:75], s51 offen lds
  s_add_u32 s51, s51, s62
  s_add_u32 m0, s63, 67584
  s_nop 0
  buffer_load_dwordx4 v5, s[72:75], s51 offen lds
  s_add_u32 s51, s51, s62
  s_add_u32 m0, s63, 68608
  s_nop 0
  buffer_load_dwordx4 v5, s[72:75], s51 offen lds
  s_add_u32 s51, s51, s62
  s_add_u32 m0, s63, 69632
  s_nop 0
  buffer_load_dwordx4 v5, s[72:75], s51 offen lds
  v_add_u32 v10, 82944, v6
  ds_read_b64_tr_b16 a[160:161], v10 offset:0
  ds_read_b64_tr_b16 a[162:163], v10 offset:1024
  ds_read_b64_tr_b16 a[164:165], v10 offset:4096
  ds_read_b64_tr_b16 a[166:167], v10 offset:5120
  ds_read_b64_tr_b16 a[168:169], v10 offset:8192
  ds_read_b64_tr_b16 a[170:171], v10 offset:9216
  ds_read_b64_tr_b16 a[172:173], v10 offset:12288
  ds_read_b64_tr_b16 a[174:175], v10 offset:13312
  s_waitcnt vmcnt(20) lgkmcnt(0)
  s_barrier
  s_mul_i32 s51, s55, 64
  s_add_u32 s51, s51, s60
  s_mul_i32 s52, s61, 2
  s_add_u32 s51, s51, s52
  s_add_u32 m0, s63, 82944
  s_nop 0
  buffer_load_dwordx4 v5, s[72:75], s51 offen lds
  s_add_u32 s51, s51, s62
  s_add_u32 m0, s63, 83968
  s_nop 0
  buffer_load_dwordx4 v5, s[72:75], s51 offen lds
  s_add_u32 s51, s51, s62
  s_add_u32 m0, s63, 84992
  s_nop 0
  buffer_load_dwordx4 v5, s[72:75], s51 offen lds
  s_add_u32 s51, s51, s62
  s_add_u32 m0, s63, 86016
  s_nop 0
  buffer_load_dwordx4 v5, s[72:75], s51 offen lds
  v_add_u32 v10, 99328, v6
  ds_read_b64_tr_b16 a[176:177], v10 offset:0
  ds_read_b64_tr_b16 a[178:179], v10 offset:1024
  ds_read_b64_tr_b16 a[180:181], v10 offset:4096
  ds_read_b64_tr_b16 a[182:183], v10 offset:5120
  ds_read_b64_tr_b16 a[184:185], v10 offset:8192
  ds_read_b64_tr_b16 a[186:187], v10 offset:9216
  ds_read_b64_tr_b16 a[188:189], v10 offset:12288
  ds_read_b64_tr_b16 a[190:191], v10 offset:13312
  s_waitcnt vmcnt(20) lgkmcnt(0)
  s_barrier
  s_mul_i32 s51, s55, 128
  s_add_u32 s51, s51, s60
  s_mul_i32 s52, s61, 2
  s_add_u32 s51, s51, s52
  s_add_u32 m0, s63, 99328
  s_nop 0
  buffer_load_dwordx4 v5, s[72:75], s51 offen lds
  s_add_u32 s51, s51, s62
  s_add_u32 m0, s63, 100352
  s_nop 0
  buffer_load_dwordx4 v5, s[72:75], s51 offen lds
  s_add_u32 s51, s51, s62
  s_add_u32 m0, s63, 101376
  s_nop 0
  buffer_load_dwordx4 v5, s[72:75], s51 offen lds
  s_add_u32 s51, s51, s62
  s_add_u32 m0, s63, 102400
  s_nop 0
  buffer_load_dwordx4 v5, s[72:75], s51 offen lds
  v_add_u32 v10, 115712, v6
  ds_read_b64_tr_b16 a[192:193], v10 offset:0
  ds_read_b64_tr_b16 a[194:195], v10 offset:1024
  ds_read_b64_tr_b16 a[196:197], v10 offset:4096
  ds_read_b64_tr_b16 a[198:199], v10 offset:5120
  ds_read_b64_tr_b16 a[200:201], v10 offset:8192
  ds_read_b64_tr_b16 a[202:203], v10 offset:9216
  ds_read_b64_tr_b16 a[204:205], v10 offset:12288
  ds_read_b64_tr_b16 a[206:207], v10 offset:13312
  s_waitcnt vmcnt(20) lgkmcnt(0)
  s_barrier
  s_mul_i32 s51, s55, 192
  s_add_u32 s51, s51, s60
  s_mul_i32 s52, s61, 2
  s_add_u32 s51, s51, s52
  s_add_u32 m0, s63, 115712
  s_nop 0
  buffer_load_dwordx4 v5, s[72:75], s51 offen lds
  s_add_u32 s51, s51, s62
  s_add_u32 m0, s63, 116736
  s_nop 0
  buffer_load_dwordx4 v5, s[72:75], s51 offen lds
  s_add_u32 s51, s51, s62
  s_add_u32 m0, s63, 117760
  s_nop 0
  buffer_load_dwordx4 v5, s[72:75], s51 offen lds
  s_add_u32 s51, s51, s62
  s_add_u32 m0, s63, 118784
  s_nop 0
  buffer_load_dwordx4 v5, s[72:75], s51 offen lds
  v_add_u32 v10, 132096, v6
  ds_read_b64_tr_b16 a[208:209], v10 offset:0
  ds_read_b64_tr_b16 a[210:211], v10 offset:1024
  ds_read_b64_tr_b16 a[212:213], v10 offset:4096
  ds_read_b64_tr_b16 a[214:215], v10 offset:5120
  ds_read_b64_tr_b16 a[216:217], v10 offset:8192
  ds_read_b64_tr_b16 a[218:219], v10 offset:9216
  ds_read_b64_tr_b16 a[220:221], v10 offset:12288
  ds_read_b64_tr_b16 a[222:223], v10 offset:13312
  s_waitcnt vmcnt(20) lgkmcnt(0)
  s_barrier
  s_mul_i32 s51, s55, 256
  s_add_u32 s51, s51, s60
  s_mul_i32 s52, s61, 2
  s_add_u32 s51, s51, s52
  s_add_u32 m0, s63, 132096
  s_nop 0
  buffer_load_dwordx4 v5, s[72:75], s51 offen lds
  s_add_u32 s51, s51, s62
  s_add_u32 m0, s63, 133120
  s_nop 0
  buffer_load_dwordx4 v5, s[72:75], s51 offen lds
  s_add_u32 s51, s51, s62
  s_add_u32 m0, s63, 134144
  s_nop 0
  buffer_load_dwordx4 v5, s[72:75], s51 offen lds
  s_add_u32 s51, s51, s62
  s_add_u32 m0, s63, 135168
  s_nop 0
  buffer_load_dwordx4 v5, s[72:75], s51 offen lds
  v_add_u32 v10, 33792, v6
  ds_read_b64_tr_b16 a[224:225], v10 offset:0
  ds_read_b64_tr_b16 a[226:227], v10 offset:1024
  ds_read_b64_tr_b16 a[228:229], v10 offset:4096
  ds_read_b64_tr_b16 a[230:231], v10 offset:5120
  ds_read_b64_tr_b16 a[232:233], v10 offset:8192
  ds_read_b64_tr_b16 a[234:235], v10 offset:9216
  ds_read_b64_tr_b16 a[236:237], v10 offset:12288
  ds_read_b64_tr_b16 a[238:239], v10 offset:13312
  s_waitcnt vmcnt(20) lgkmcnt(0)
  s_barrier
  s_mul_i32 s51, s55, 320
  s_add_u32 s51, s51, s60
  s_mul_i32 s52, s61, 2
  s_add_u32 s51, s51, s52
  s_add_u32 m0, s63, 33792
  s_nop 0
  buffer_load_dwordx4 v5, s[72:75], s51 offen lds
  s_add_u32 s51, s51, s62
  s_add_u32 m0, s63, 34816
  s_nop 0
  buffer_load_dwordx4 v5, s[72:75], s51 offen lds
  s_add_u32 s51, s51, s62
  s_add_u32 m0, s63, 35840
  s_nop 0
  buffer_load_dwordx4 v5, s[72:75], s51 offen lds
  s_add_u32 s51, s51, s62
  s_add_u32 m0, s63, 36864
  s_nop 0
  buffer_load_dwordx4 v5, s[72:75], s51 offen lds
  v_add_u32 v10, 50176, v6
  ds_read_b64_tr_b16 a[240:241], v10 offset:0
  ds_read_b64_tr_b16 a[242:243], v10 offset:1024
  ds_read_b64_tr_b16 a[244:245], v10 offset:4096
  ds_read_b64_tr_b16 a[246:247], v10 offset:5120
  ds_read_b64_tr_b16 a[248:249], v10 offset:8192
  ds_read_b64_tr_b16 a[250:251], v10 offset:9216
  ds_read_b64_tr_b16 a[252:253], v10 offset:12288
  ds_read_b64_tr_b16 a[254:255], v10 offset:13312
  s_waitcnt vmcnt(20) lgkmcnt(0)
  s_barrier
  s_mul_i32 s51, s55, 384
  s_add_u32 s51, s51, s60
  s_mul_i32 s52, s61, 2
  s_add_u32 s51, s51, s52
  s_add_u32 m0, s63, 50176
  s_nop 0
  buffer_load_dwordx4 v5, s[72:75], s51 offen lds
  s_add_u32 s51, s51, s62
  s_add_u32 m0, s63, 51200
  s_nop 0
  buffer_load_dwordx4 v5, s[72:75], s51 offen lds
  s_add_u32 s51, s51, s62
  s_add_u32 m0, s63, 52224
  s_nop 0
  buffer_load_dwordx4 v5, s[72:75], s51 offen lds
  s_add_u32 s51, s51, s62
  s_add_u32 m0, s63, 53248
  s_nop 0
  buffer_load_dwordx4 v5, s[72:75], s51 offen lds
  v_add_u32 v10, 66560, v6
  ds_read_b64_tr_b16 v[128:129], v10 offset:0
  ds_read_b64_tr_b16 v[130:131], v10 offset:1024
  ds_read_b64_tr_b16 v[132:133], v10 offset:4096
  ds_read_b64_tr_b16 v[134:135], v10 offset:5120
  ds_read_b64_tr_b16 v[136:137], v10 offset:8192
  ds_read_b64_tr_b16 v[138:139], v10 offset:9216
  ds_read_b64_tr_b16 v[140:141], v10 offset:12288
  ds_read_b64_tr_b16 v[142:143], v10 offset:13312
  s_waitcnt vmcnt(20) lgkmcnt(0)
  s_barrier
  s_mul_i32 s51, s55, 448
  s_add_u32 s51, s51, s60
  s_mul_i32 s52, s61, 2
  s_add_u32 s51, s51, s52
  s_add_u32 m0, s63, 66560
  s_nop 0
  buffer_load_dwordx4 v5, s[72:75], s51 offen lds
  s_add_u32 s51, s51, s62
  s_add_u32 m0, s63, 67584
  s_nop 0
  buffer_load_dwordx4 v5, s[72:75], s51 offen lds
  s_add_u32 s51, s51, s62
  s_add_u32 m0, s63, 68608
  s_nop 0
  buffer_load_dwordx4 v5, s[72:75], s51 offen lds
  s_add_u32 s51, s51, s62
  s_add_u32 m0, s63, 69632
  s_nop 0
  buffer_load_dwordx4 v5, s[72:75], s51 offen lds
  v_add_u32 v10, 82944, v6
  ds_read_b64_tr_b16 v[144:145], v10 offset:0
  ds_read_b64_tr_b16 v[146:147], v10 offset:1024
  ds_read_b64_tr_b16 v[148:149], v10 offset:4096
  ds_read_b64_tr_b16 v[150:151], v10 offset:5120
  ds_read_b64_tr_b16 v[152:153], v10 offset:8192
  ds_read_b64_tr_b16 v[154:155], v10 offset:9216
  ds_read_b64_tr_b16 v[156:157], v10 offset:12288
  ds_read_b64_tr_b16 v[158:159], v10 offset:13312
  s_waitcnt vmcnt(20) lgkmcnt(0)
  s_barrier
  buffer_load_dword v9, off, s[8:11], 0 offset:128 sc1
  v_add_u32 v10, 99328, v6
  ds_read_b64_tr_b16 v[160:161], v10 offset:0
  ds_read_b64_tr_b16 v[162:163], v10 offset:1024
  ds_read_b64_tr_b16 v[164:165], v10 offset:4096
  ds_read_b64_tr_b16 v[166:167], v10 offset:5120
  ds_read_b64_tr_b16 v[168:169], v10 offset:8192
  ds_read_b64_tr_b16 v[170:171], v10 offset:9216
  ds_read_b64_tr_b16 v[172:173], v10 offset:12288
  ds_read_b64_tr_b16 v[174:175], v10 offset:13312
  s_waitcnt vmcnt(17) lgkmcnt(0)
  s_barrier
  v_add_u32 v10, 115712, v6
  ds_read_b64_tr_b16 v[176:177], v10 offset:0
  ds_read_b64_tr_b16 v[178:179], v10 offset:1024
  ds_read_b64_tr_b16 v[180:181], v10 offset:4096
  ds_read_b64_tr_b16 v[182:183], v10 offset:5120
  ds_read_b64_tr_b16 v[184:185], v10 offset:8192
  ds_read_b64_tr_b16 v[186:187], v10 offset:9216
  ds_read_b64_tr_b16 v[188:189], v10 offset:12288
  ds_read_b64_tr_b16 v[190:191], v10 offset:13312
  s_waitcnt vmcnt(13) lgkmcnt(0)
  s_barrier
  v_add_u32 v10, 132096, v6
  ds_read_b64_tr_b16 v[192:193], v10 offset:0
  ds_read_b64_tr_b16 v[194:195], v10 offset:1024
  ds_read_b64_tr_b16 v[196:197], v10 offset:4096
  ds_read_b64_tr_b16 v[198:199], v10 offset:5120
  ds_read_b64_tr_b16 v[200:201], v10 offset:8192
  ds_read_b64_tr_b16 v[202:203], v10 offset:9216
  ds_read_b64_tr_b16 v[204:205], v10 offset:12288
  ds_read_b64_tr_b16 v[206:207], v10 offset:13312
  s_waitcnt vmcnt(9) lgkmcnt(0)
  s_barrier
  v_add_u32 v10, 33792, v6
  ds_read_b64_tr_b16 v[208:209], v10 offset:0
  ds_read_b64_tr_b16 v[210:211], v10 offset:1024
  ds_read_b64_tr_b16 v[212:213], v10 offset:4096
  ds_read_b64_tr_b16 v[214:215], v10 offset:5120
  ds_read_b64_tr_b16 v[216:217], v10 offset:8192
  ds_read_b64_tr_b16 v[218:219], v10 offset:9216
  ds_read_b64_tr_b16 v[220:221], v10 offset:12288
  ds_read_b64_tr_b16 v[222:223], v10 offset:13312
  s_waitcnt vmcnt(5) lgkmcnt(0)
  s_barrier
  v_add_u32 v10, 50176, v6
  ds_read_b64_tr_b16 v[224:225], v10 offset:0
  ds_read_b64_tr_b16 v[226:227], v10 offset:1024
  ds_read_b64_tr_b16 v[228:229], v10 offset:4096
  ds_read_b64_tr_b16 v[230:231], v10 offset:5120
  ds_read_b64_tr_b16 v[232:233], v10 offset:8192
  ds_read_b64_tr_b16 v[234:235], v10 offset:9216
  ds_read_b64_tr_b16 v[236:237], v10 offset:12288
  ds_read_b64_tr_b16 v[238:239], v10 offset:13312
  s_waitcnt vmcnt(1) lgkmcnt(0)
  s_barrier
  v_add_u32 v10, 66560, v6
  ds_read_b64_tr_b16 v[240:241], v10 offset:0
  ds_read_b64_tr_b16 v[242:243], v10 offset:1024
  ds_read_b64_tr_b16 v[244:245], v10 offset:4096
  ds_read_b64_tr_b16 v[246:247], v10 offset:5120
  ds_read_b64_tr_b16 v[248:249], v10 offset:8192
  ds_read_b64_tr_b16 v[250:251], v10 offset:9216
  ds_read_b64_tr_b16 v[252:253], v10 offset:12288
  ds_read_b64_tr_b16 v[254:255], v10 offset:13312
  s_waitcnt vmcnt(0) lgkmcnt(0)
  v_readfirstlane_b32 s51, v9
  s_nop 0
  s_and_b32 s51, s51, 0xffff
  s_cmp_eq_u32 s51, 256
  s_cbranch_scc1 L_go_pj
L_wi_pj:
  s_sleep 16
  buffer_load_dword v8, off, s[8:11], 0 offset:128 sc1
  s_sub_u32 s49, s49, 1
  s_cbranch_scc1 L_end
  s_waitcnt vmcnt(0)
  v_readfirstlane_b32 s51, v8
  s_nop 0
  s_and_b32 s51, s51, 0xffff
  s_cmp_eq_u32 s51, 256
  s_cbranch_scc0 L_wi_pj
L_go_pj:
  s_mov_b32 s60, 0
  v_mov_b32 v9, 2
L_pj_loop:
  s_waitcnt vmcnt(6)
  s_barrier
  v_add_u32 v8, s59, v7
  s_add_u32 s62, s54, 5
  s_min_u32 s62, s62, 63
  s_sub_u32 s63, 33280, s59
  s_lshl_b32 s51, s62, 15
  s_lshl_b32 s52, s46, 13
  s_add_u32 s51, s51, s52
  s_mul_i32 s52, s46, 8320
  s_add_u32 s52, s52, s63
  ds_read_b128 v[16:19], v8 offset:0
  ds_read_b128 v[20:23], v8 offset:32
  ds_read_b128 v[24:27], v8 offset:64
  s_waitcnt lgkmcnt(2)
  v_mfma_f32_32x32x16_bf16 v[32:47], a[0:3], v[16:19], 0
  ds_read_b128 v[28:31], v8 offset:96
  v_mfma_f32_32x32x16_bf16 v[48:63], a[128:131], v[16:19], 0
  s_add_u32 m0, s52, 0
  s_add_u32 s3, s51, 0
  buffer_load_dwordx4 v3, s[76:79], s3 offen lds
  v_mfma_f32_32x32x16_bf16 v[64:79], v[16:19], v[128:131], 0
  s_waitcnt lgkmcnt(2)
  v_mfma_f32_32x32x16_bf16 v[32:47], a[4:7], v[20:23], v[32:47]
  ds_read_b128 v[16:19], v8 offset:128
  v_mfma_f32_32x32x16_bf16 v[48:63], a[132:135], v[20:23], v[48:63]
  s_add_u32 m0, s52, 1040
  s_add_u32 s3, s51, 1024
  buffer_load_dwordx4 v3, s[76:79], s3 offen lds
  v_mfma_f32_32x32x16_bf16 v[64:79], v[20:23], v[132:135], v[64:79]
  s_waitcnt lgkmcnt(2)
  v_mfma_f32_32x32x16_bf16 v[32:47], a[8:11], v[24:27], v[32:47]
  ds_read_b128 v[20:23], v8 offset:160
  v_mfma_f32_32x32x16_bf16 v[48:63], a[136:139], v[24:27], v[48:63]
  s_add_u32 m0, s52, 2080
  s_add_u32 s3, s51, 2048
  buffer_load_dwordx4 v3, s[76:79], s3 offen lds
  v_mfma_f32_32x32x16_bf16 v[64:79], v[24:27], v[136:139], v[64:79]
  s_waitcnt lgkmcnt(2)
  v_mfma_f32_32x32x16_bf16 v[32:47], a[12:15], v[28:31], v[32:47]
  ds_read_b128 v[24:27], v8 offset:192
  v_mfma_f32_32x32x16_bf16 v[48:63], a[140:143], v[28:31], v[48:63]
  s_add_u32 m0, s52, 3120
  s_add_u32 s3, s51, 3072
  buffer_load_dwordx4 v3, s[76:79], s3 offen lds
  v_mfma_f32_32x32x16_bf16 v[64:79], v[28:31], v[140:143], v[64:79]
  s_waitcnt lgkmcnt(2)
  v_mfma_f32_32x32x16_bf16 v[32:47], a[16:19], v[16:19], v[32:47]
  ds_read_b128 v[28:31], v8 offset:224
  v_mfma_f32_32x32x16_bf16 v[48:63], a[144:147], v[16:19], v[48:63]
  s_add_u32 m0, s52, 4160
  s_add_u32 s3, s51, 4096
  buffer_load_dwordx4 v3, s[76:79], s3 offen lds
  v_mfma_f32_32x32x16_bf16 v[64:79], v[16:19], v[144:147], v[64:79]
  s_waitcnt lgkmcnt(2)
  v_mfma_f32_32x32x16_bf16 v[32:47], a[20:23], v[20:23], v[32:47]
  ds_read_b128 v[16:19], v8 offset:256
  v_mfma_f32_32x32x16_bf16 v[48:63], a[148:151], v[20:23], v[48:63]
  s_add_u32 m0, s52, 5200
  s_add_u32 s3, s51, 5120
  buffer_load_dwordx4 v3, s[76:79], s3 offen lds
  v_mfma_f32_32x32x16_bf16 v[64:79], v[20:23], v[148:151], v[64:79]
  s_waitcnt lgkmcnt(2)
  v_mfma_f32_32x32x16_bf16 v[32:47], a[24:27], v[24:27], v[32:47]
  ds_read_b128 v[20:23], v8 offset:288
  v_mfma_f32_32x32x16_bf16 v[48:63], a[152:155], v[24:27], v[48:63]
  s_add_u32 m0, s52, 6240
  s_add_u32 s3, s51, 6144
  buffer_load_dwordx4 v3, s[76:79], s3 offen lds
  v_mfma_f32_32x32x16_bf16 v[64:79], v[24:27], v[152:155], v[64:79]
  s_waitcnt lgkmcnt(2)
  v_mfma_f32_32x32x16_bf16 v[32:47], a[28:31], v[28:31], v[32:47]
  ds_read_b128 v[24:27], v8 offset:320
  v_mfma_f32_32x32x16_bf16 v[48:63], a[156:159], v[28:31], v[48:63]
  s_add_u32 m0, s52, 7280
  s_add_u32 s3, s51, 7168
  buffer_load_dwordx4 v3, s[76:79], s3 offen lds
  v_mfma_f32_32x32x16_bf16 v[64:79], v[28:31], v[156:159], v[64:79]
  s_waitcnt lgkmcnt(2)
  v_mfma_f32_32x32x16_bf16 v[32:47], a[32:35], v[16:19], v[32:47]
  ds_read_b128 v[28:31], v8 offset:352
  v_mfma_f32_32x32x16_bf16 v[48:63], a[160:163], v[16:19], v[48:63]
  v_mfma_f32_32x32x16_bf16 v[64:79], v[16:19], v[160:163], v[64:79]
  s_waitcnt lgkmcnt(2)
  v_mfma_f32_32x32x16_bf16 v[32:47], a[36:39], v[20:23], v[32:47]
  ds_read_b128 v[16:19], v8 offset:384
  v_mfma_f32_32x32x16_bf16 v[48:63], a[164:167], v[20:23], v[48:63]
  v_mfma_f32_32x32x16_bf16 v[64:79], v[20:23], v[164:167], v[64:79]
  s_waitcnt lgkmcnt(2)
  v_mfma_f32_32x32x16_bf16 v[32:47], a[40:43], v[24:27], v[32:47]
  ds_read_b128 v[20:23], v8 offset:416
  v_mfma_f32_32x32x16_bf16 v[48:63], a[168:171], v[24:27], v[48:63]
  v_mfma_f32_32x32x16_bf16 v[64:79], v[24:27], v[168:171], v[64:79]
  s_waitcnt lgkmcnt(2)
  v_mfma_f32_32x32x16_bf16 v[32:47], a[44:47], v[28:31], v[32:47]
  ds_read_b128 v[24:27], v8 offset:448
  v_mfma_f32_32x32x16_bf16 v[48:63], a[172:175], v[28:31], v[48:63]
  v_mfma_f32_32x32x16_bf16 v[64:79], v[28:31], v[172:175], v[64:79]
  s_waitcnt lgkmcnt(2)
  v_mfma_f32_32x32x16_bf16 v[32:47], a[48:51], v[16:19], v[32:47]
  ds_read_b128 v[28:31], v8 offset:480
  v_mfma_f32_32x32x16_bf16 v[48:63], a[176:179], v[16:19], v[48:63]
  v_mfma_f32_32x32x16_bf16 v[64:79], v[16:19], v[176:179], v[64:79]
  s_waitcnt lgkmcnt(2)
  v_mfma_f32_32x32x16_bf16 v[32:47], a[52:55], v[20:23], v[32:47]
  ds_read_b128 v[16:19], v8 offset:512
  v_mfma_f32_32x32x16_bf16 v[48:63], a[180:183], v[20:23], v[48:63]
  v_mfma_f32_32x32x16_bf16 v[64:79], v[20:23], v[180:183], v[64:79]
  s_waitcnt lgkmcnt(2)
  v_mfma_f32_32x32x16_bf16 v[32:47], a[56:59], v[24:27], v[32:47]
  ds_read_b128 v[20:23], v8 offset:544
  v_mfma_f32_32x32x16_bf16 v[48:63], a[184:187], v[24:27], v[48:63]
  v_mfma_f32_32x32x16_bf16 v[64:79], v[24:27], v[184:187], v[64:79]
  s_waitcnt lgkmcnt(2)
  v_mfma_f32_32x32x16_bf16 v[32:47], a[60:63], v[28:31], v[32:47]
  ds_read_b128 v[24:27], v8 offset:576
  v_mfma_f32_32x32x16_bf16 v[48:63], a[188:191], v[28:31], v[48:63]
  v_mfma_f32_32x32x16_bf16 v[64:79], v[28:31], v[188:191], v[64:79]
  s_waitcnt lgkmcnt(2)
  v_mfma_f32_32x32x16_bf16 v[32:47], a[64:67], v[16:19], v[32:47]
  ds_read_b128 v[28:31], v8 offset:608
  v_mfma_f32_32x32x16_bf16 v[48:63], a[192:195], v[16:19], v[48:63]
  v_mfma_f32_32x32x16_bf16 v[64:79], v[16:19], v[192:195], v[64:79]
  s_waitcnt lgkmcnt(2)
  v_mfma_f32_32x32x16_bf16 v[32:47], a[68:71], v[20:23], v[32:47]
  ds_read_b128 v[16:19], v8 offset:640
  v_mfma_f32_32x32x16_bf16 v[48:63], a[196:199], v[20:23], v[48:63]
  v_mfma_f32_32x32x16_bf16 v[64:79], v[20:23], v[196:199], v[64:79]
  s_waitcnt lgkmcnt(2)
  v_mfma_f32_32x32x16_bf16 v[32:47], a[72:75], v[24:27], v[32:47]
  ds_read_b128 v[20:23], v8 offset:672
  v_mfma_f32_32x32x16_bf16 v[48:63], a[200:203], v[24:27], v[48:63]
  v_mfma_f32_32x32x16_bf16 v[64:79], v[24:27], v[200:203], v[64:79]
  s_waitcnt lgkmcnt(2)
  v_mfma_f32_32x32x16_bf16 v[32:47], a[76:79], v[28:31], v[32:47]
  ds_read_b128 v[24:27], v8 offset:704
  v_mfma_f32_32x32x16_bf16 v[48:63], a[204:207], v[28:31], v[48:63]
  v_mfma_f32_32x32x16_bf16 v[64:79], v[28:31], v[204:207], v[64:79]
  s_waitcnt lgkmcnt(2)
  v_mfma_f32_32x32x16_bf16 v[32:47], a[80:83], v[16:19], v[32:47]
  ds_read_b128 v[28:31], v8 offset:736
  v_mfma_f32_32x32x16_bf16 v[48:63], a[208:211], v[16:19], v[48:63]
  s_waitcnt vmcnt(8)
  s_barrier
  s_cmp_eq_u32 s60, 0
  s_cbranch_scc1 L_pj_nf
  s_mov_b64 exec, 1
  buffer_store_dword v9, off, s[4:7], s60 sc1
  s_mov_b64 exec, -1
L_pj_nf:
  v_mfma_f32_32x32x16_bf16 v[64:79], v[16:19], v[208:211], v[64:79]
  s_waitcnt lgkmcnt(2)
  v_mfma_f32_32x32x16_bf16 v[32:47], a[84:87], v[20:23], v[32:47]
  ds_read_b128 v[16:19], v8 offset:768
  v_mfma_f32_32x32x16_bf16 v[48:63], a[212:215], v[20:23], v[48:63]
  v_mfma_f32_32x32x16_bf16 v[64:79], v[20:23], v[212:215], v[64:79]
  s_waitcnt lgkmcnt(2)
  v_mfma_f32_32x32x16_bf16 v[32:47], a[88:91], v[24:27], v[32:47]
  ds_read_b128 v[20:23], v8 offset:800
  v_mfma_f32_32x32x16_bf16 v[48:63], a[216:219], v[24:27], v[48:63]
  v_mfma_f32_32x32x16_bf16 v[64:79], v[24:27], v[216:219], v[64:79]
  s_waitcnt lgkmcnt(2)
  v_mfma_f32_32x32x16_bf16 v[32:47], a[92:95], v[28:31], v[32:47]
  ds_read_b128 v[24:27], v8 offset:832
  v_mfma_f32_32x32x16_bf16 v[48:63], a[220:223], v[28:31], v[48:63]
  v_mfma_f32_32x32x16_bf16 v[64:79], v[28:31], v[220:223], v[64:79]
  s_waitcnt lgkmcnt(2)
  v_mfma_f32_32x32x16_bf16 v[32:47], a[96:99], v[16:19], v[32:47]
  ds_read_b128 v[28:31], v8 offset:864
  v_mfma_f32_32x32x16_bf16 v[48:63], a[224:227], v[16:19], v[48:63]
  v_mfma_f32_32x32x16_bf16 v[64:79], v[16:19], v[224:227], v[64:79]
  s_waitcnt lgkmcnt(2)
  v_mfma_f32_32x32x16_bf16 v[32:47], a[100:103], v[20:23], v[32:47]
  ds_read_b128 v[16:19], v8 offset:896
  v_mfma_f32_32x32x16_bf16 v[48:63], a[228:231], v[20:23], v[48:63]
  v_mfma_f32_32x32x16_bf16 v[64:79], v[20:23], v[228:231], v[64:79]
  s_waitcnt lgkmcnt(2)
  v_mfma_f32_32x32x16_bf16 v[32:47], a[104:107], v[24:27], v[32:47]
  ds_read_b128 v[20:23], v8 offset:928
  v_mfma_f32_32x32x16_bf16 v[48:63], a[232:235], v[24:27], v[48:63]
  v_mfma_f32_32x32x16_bf16 v[64:79], v[24:27], v[232:235], v[64:79]
  s_waitcnt lgkmcnt(2)
  v_mfma_f32_32x32x16_bf16 v[32:47], a[108:111], v[28:31], v[32:47]
  ds_read_b128 v[24:27], v8 offset:960
  v_mfma_f32_32x32x16_bf16 v[48:63], a[236:239], v[28:31], v[48:63]
  v_mfma_f32_32x32x16_bf16 v[64:79], v[28:31], v[236:239], v[64:79]
  s_waitcnt lgkmcnt(2)
  v_mfma_f32_32x32x16_bf16 v[32:47], a[112:115], v[16:19], v[32:47]
  ds_read_b128 v[28:31], v8 offset:992
  v_mfma_f32_32x32x16_bf16 v[48:63], a[240:243], v[16:19], v[48:63]
  v_mfma_f32_32x32x16_bf16 v[64:79], v[16:19], v[240:243], v[64:79]
  s_waitcnt lgkmcnt(2)
  v_mfma_f32_32x32x16_bf16 v[32:47], a[116:119], v[20:23], v[32:47]
  v_mfma_f32_32x32x16_bf16 v[48:63], a[244:247], v[20:23], v[48:63]
  v_mfma_f32_32x32x16_bf16 v[64:79], v[20:23], v[244:247], v[64:79]
  s_waitcnt lgkmcnt(1)
  v_mfma_f32_32x32x16_bf16 v[32:47], a[120:123], v[24:27], v[32:47]
  v_mfma_f32_32x32x16_bf16 v[48:63], a[248:251], v[24:27], v[48:63]
  v_mfma_f32_32x32x16_bf16 v[64:79], v[24:27], v[248:251], v[64:79]
  s_waitcnt lgkmcnt(0)
  v_mfma_f32_32x32x16_bf16 v[32:47], a[124:127], v[28:31], v[32:47]
  v_mfma_f32_32x32x16_bf16 v[48:63], a[252:255], v[28:31], v[48:63]
  v_mfma_f32_32x32x16_bf16 v[64:79], v[28:31], v[252:255], v[64:79]
  s_nop 9
  v_cvt_pk_bf16_f32 v80, v32, v33
  v_cvt_pk_bf16_f32 v81, v34, v35
  v_cvt_pk_bf16_f32 v82, v36, v37
  v_cvt_pk_bf16_f32 v83, v38, v39
  v_cvt_pk_bf16_f32 v84, v40, v41
  v_cvt_pk_bf16_f32 v85, v42, v43
  v_cvt_pk_bf16_f32 v86, v44, v45
  v_cvt_pk_bf16_f32 v87, v46, v47
  s_add_u32 s51, s57, 0
  buffer_store_dwordx4 v[80:83], v3, s[4:7], s51 offen sc1
  buffer_store_dwordx4 v[84:87], v3, s[4:7], s51 offen offset:1024 sc1
  v_cvt_pk_bf16_f32 v88, v48, v49
  v_cvt_pk_bf16_f32 v89, v50, v51
  v_cvt_pk_bf16_f32 v90, v52, v53
  v_cvt_pk_bf16_f32 v91, v54, v55
  v_cvt_pk_bf16_f32 v92, v56, v57
  v_cvt_pk_bf16_f32 v93, v58, v59
  v_cvt_pk_bf16_f32 v94, v60, v61
  v_cvt_pk_bf16_f32 v95, v62, v63
  s_add_u32 s51, s57, 8192
  buffer_store_dwordx4 v[88:91], v4, s[4:7], s51 offen sc1
  buffer_store_dwordx4 v[92:95], v4, s[4:7], s51 offen offset:1024 sc1
  v_cvt_pk_bf16_f32 v96, v64, v65
  v_cvt_pk_bf16_f32 v97, v66, v67
  v_cvt_pk_bf16_f32 v98, v68, v69
  v_cvt_pk_bf16_f32 v99, v70, v71
  v_cvt_pk_bf16_f32 v100, v72, v73
  v_cvt_pk_bf16_f32 v101, v74, v75
  v_cvt_pk_bf16_f32 v102, v76, v77
  v_cvt_pk_bf16_f32 v103, v78, v79
  s_add_u32 s51, s57, 16384
  buffer_store_dwordx4 v[96:99], v3, s[4:7], s51 offen sc1
  buffer_store_dwordx4 v[100:103], v3, s[4:7], s51 offen offset:1024 sc1
  s_cmp_eq_u32 s46, 0
  s_cselect_b32 s60, s58, 0
  s_cmp_ge_u32 s54, 5
  s_cbranch_scc1 L_pj_later
  s_waitcnt vmcnt(0)
  s_barrier
  s_cmp_eq_u32 s60, 0
  s_cbranch_scc1 L_pj_later
  s_mov_b64 exec, 1
  buffer_store_dword v9, off, s[4:7], s60 sc1
  s_mov_b64 exec, -1
L_pj_later:
  s_add_u32 s58, s58, 20
  s_add_u32 s57, s57, 122880
  s_sub_u32 s59, 33280, s59
  s_add_u32 s54, s54, 5
  s_cmp_lt_u32 s54, 64
  s_cbranch_scc1 L_pj_loop
  s_waitcnt vmcnt(0)
  s_barrier
  s_cmp_eq_u32 s60, 0
  s_cbranch_scc1 L_phase2
  s_mov_b64 exec, 1
  buffer_store_dword v9, off, s[4:7], s60 sc1
  s_mov_b64 exec, -1
L_phase2:
  s_sub_u32 s50, s50, 32
  s_cbranch_scc1 L_end
  s_cmp_lt_u32 s50, 32
  s_cbranch_scc1 L_attn_b
  s_cmp_lt_u32 s50, 64
  s_cbranch_scc1 L_part_a
  s_mov_b32 s64, s36
  s_and_b32 s65, s37, 0xffff
  s_mov_b32 s66, 4194304
  s_mov_b32 s67, 0x20000
  s_mov_b32 s68, s40
  s_and_b32 s69, s41, 0xffff
  s_mov_b32 s70, 4194304
  s_mov_b32 s71, 0x20000
  s_sub_u32 s53, s50, 64
  s_and_b32 s54, s53, 15
  s_lshr_b32 s53, s53, 4
  s_cmp_ge_u32 s53, 8
  s_cbranch_scc1 L_end
  v_and_b32 v1, 63, v0
  v_lshlrev_b32 v3, 4, v1
  v_and_b32 v9, 7, v1
  v_lshlrev_b32 v9, 2, v9
  v_lshrrev_b32 v2, 2, v1
  v_lshlrev_b32 v4, 10, v2
  v_and_b32 v2, 3, v1
  v_lshl_add_u32 v4, v2, 4, v4
  s_lshl_b32 s55, s46, 20
  s_lshl_b32 s51, s54, 6
  s_add_u32 s55, s55, s51
  s_lshl_b32 s56, s46, 15
  v_lshlrev_b32 v5, 3, v2
  v_lshrrev_b32 v2, 5, v1
  v_lshl_add_u32 v5, v2, 10, v5
  v_bfe_u32 v2, v1, 2, 3
  v_lshl_add_u32 v5, v2, 6, v5
  v_add_u32 v5, s56, v5
  v_lshrrev_b32 v2, 4, v1
  v_lshlrev_b32 v6, 9, v2
  v_lshlrev_b32 v7, 3, v2
  v_and_b32 v2, 7, v1
  v_lshl_add_u32 v6, v2, 4, v6
  v_lshl_add_u32 v7, v2, 11, v7
  v_and_b32 v2, 8, v1
  v_cmp_ne_u32 s[72:73], 0, v2
  v_lshl_add_u32 v6, v2, 8, v6
  v_lshl_add_u32 v7, v2, 27, v7
  s_lshl_b32 s51, s46, 11
  s_add_u32 s51, s51, 131072
  v_add_u32 v10, s51, v3
  s_lshl_b32 s51, s46, 10
  s_add_u32 s51, s51, 131072
  v_add_u32 v11, s51, v3
  s_waitcnt vmcnt(0)
  s_barrier
  s_add_u32 m0, s56, 0
  s_add_u32 s51, s55, 0
  buffer_load_dwordx4 v4, s[64:67], s51 offen lds
  s_add_u32 m0, s56, 1024
  s_add_u32 s51, s55, 16384
  buffer_load_dwordx4 v4, s[64:67], s51 offen lds
  s_add_u32 m0, s56, 2048
  s_add_u32 s51, s55, 32768
  buffer_load_dwordx4 v4, s[64:67], s51 offen lds
  s_add_u32 m0, s56, 3072
  s_add_u32 s51, s55, 49152
  buffer_load_dwordx4 v4, s[64:67], s51 offen lds
  s_add_u32 m0, s56, 4096
  s_add_u32 s51, s55, 65536
  buffer_load_dwordx4 v4, s[64:67], s51 offen lds
  s_add_u32 m0, s56, 5120
  s_add_u32 s51, s55, 81920
  buffer_load_dwordx4 v4, s[64:67], s51 offen lds
  s_add_u32 m0, s56, 6144
  s_add_u32 s51, s55, 98304
  buffer_load_dwordx4 v4, s[64:67], s51 offen lds
  s_add_u32 m0, s56, 7168
  s_add_u32 s51, s55, 114688
  buffer_load_dwordx4 v4, s[64:67], s51 offen lds
  s_add_u32 m0, s56, 8192
  s_add_u32 s51, s55, 131072
  buffer_load_dwordx4 v4, s[64:67], s51 offen lds
  s_add_u32 m0, s56, 9216
  s_add_u32 s51, s55, 147456
  buffer_load_dwordx4 v4, s[64:67], s51 offen lds
  s_add_u32 m0, s56, 10240
  s_add_u32 s51, s55, 163840
  buffer_load_dwordx4 v4, s[64:67], s51 offen lds
  s_add_u32 m0, s56, 11264
  s_add_u32 s51, s55, 180224
  buffer_load_dwordx4 v4, s[64:67], s51 offen lds
  s_add_u32 m0, s56, 12288
  s_add_u32 s51, s55, 196608
  buffer_load_dwordx4 v4, s[64:67], s51 offen lds
  s_add_u32 m0, s56, 13312
  s_add_u32 s51, s55, 212992
  buffer_load_dwordx4 v4, s[64:67], s51 offen lds
  s_add_u32 m0, s56, 14336
  s_add_u32 s51, s55, 229376
  buffer_load_dwordx4 v4, s[64:67], s51 offen lds
  s_add_u32 m0, s56, 15360
  s_add_u32 s51, s55, 245760
  buffer_load_dwordx4 v4, s[64:67], s51 offen lds
  s_add_u32 m0, s56, 16384
  s_add_u32 s51, s55, 262144
  buffer_load_dwordx4 v4, s[64:67], s51 offen lds
  s_add_u32 m0, s56, 17408
  s_add_u32 s51, s55, 278528
  buffer_load_dwordx4 v4, s[64:67], s51 offen lds
  s_add_u32 m0, s56, 18432
  s_add_u32 s51, s55, 294912
  buffer_load_dwordx4 v4, s[64:67], s51 offen lds
  s_add_u32 m0, s56, 19456
  s_add_u32 s51, s55, 311296
  buffer_load_dwordx4 v4, s[64:67], s51 offen lds
  s_add_u32 m0, s56, 20480
  s_add_u32 s51, s55, 327680
  buffer_load_dwordx4 v4, s[64:67], s51 offen lds
  s_add_u32 m0, s56, 21504
  s_add_u32 s51, s55, 344064
  buffer_load_dwordx4 v4, s[64:67], s51 offen lds
  s_add_u32 m0, s56, 22528
  s_add_u32 s51, s55, 360448
  buffer_load_dwordx4 v4, s[64:67], s51 offen lds
  s_add_u32 m0, s56, 23552
  s_add_u32 s51, s55, 376832
  buffer_load_dwordx4 v4, s[64:67], s51 offen lds
  s_add_u32 m0, s56, 24576
  s_add_u32 s51, s55, 393216
  buffer_load_dwordx4 v4, s[64:67], s51 offen lds
  s_add_u32 m0, s56, 25600
  s_add_u32 s51, s55, 409600
  buffer_load_dwordx4 v4, s[64:67], s51 offen lds
  s_add_u32 m0, s56, 26624
  s_add_u32 s51, s55, 425984
  buffer_load_dwordx4 v4, s[64:67], s51 offen lds
  s_add_u32 m0, s56, 27648
  s_add_u32 s51, s55, 442368
  buffer_load_dwordx4 v4, s[64:67], s51 offen lds
  s_add_u32 m0, s56, 28672
  s_add_u32 s51, s55, 458752
  buffer_load_dwordx4 v4, s[64:67], s51 offen lds
  s_add_u32 m0, s56, 29696
  s_add_u32 s51, s55, 475136
  buffer_load_dwordx4 v4, s[64:67], s51 offen lds
  s_waitcnt vmcnt(28)
  s_add_u32 m0, s56, 30720
  s_add_u32 s51, s55, 491520
  buffer_load_dwordx4 v4, s[64:67], s51 offen lds
  s_add_u32 m0, s56, 31744
  s_add_u32 s51, s55, 507904
  buffer_load_dwordx4 v4, s[64:67], s51 offen lds
  ds_read_b64_tr_b16 a[0:1], v5 offset:0
  ds_read_b64_tr_b16 a[2:3], v5 offset:512
  ds_read_b64_tr_b16 a[4:5], v5 offset:32
  ds_read_b64_tr_b16 a[6:7], v5 offset:544
  s_waitcnt vmcnt(28) lgkmcnt(0)
  s_add_u32 m0, s56, 0
  s_add_u32 s51, s55, 524288
  buffer_load_dwordx4 v4, s[64:67], s51 offen lds
  s_add_u32 m0, s56, 1024
  s_add_u32 s51, s55, 540672
  buffer_load_dwordx4 v4, s[64:67], s51 offen lds
  ds_read_b64_tr_b16 a[8:9], v5 offset:2048
  ds_read_b64_tr_b16 a[10:11], v5 offset:2560
  ds_read_b64_tr_b16 a[12:13], v5 offset:2080
  ds_read_b64_tr_b16 a[14:15], v5 offset:2592
  s_waitcnt vmcnt(28) lgkmcnt(0)
  s_add_u32 m0, s56, 2048
  s_add_u32 s51, s55, 557056
  buffer_load_dwordx4 v4, s[64:67], s51 offen lds
  s_add_u32 m0, s56, 3072
  s_add_u32 s51, s55, 573440
  buffer_load_dwordx4 v4, s[64:67], s51 offen lds
  ds_read_b64_tr_b16 a[16:17], v5 offset:4096
  ds_read_b64_tr_b16 a[18:19], v5 offset:4608
  ds_read_b64_tr_b16 a[20:21], v5 offset:4128
  ds_read_b64_tr_b16 a[22:23], v5 offset:4640
  s_waitcnt vmcnt(28) lgkmcnt(0)
  s_add_u32 m0, s56, 4096
  s_add_u32 s51, s55, 589824
  buffer_load_dwordx4 v4, s[64:67], s51 offen lds
  s_add_u32 m0, s56, 5120
  s_add_u32 s51, s55, 606208
  buffer_load_dwordx4 v4, s[64:67], s51 offen lds
  ds_read_b64_tr_b16 a[24:25], v5 offset:6144
  ds_read_b64_tr_b16 a[26:27], v5 offset:6656
  ds_read_b64_tr_b16 a[28:29], v5 offset:6176
  ds_read_b64_tr_b16 a[30:31], v5 offset:6688
  s_waitcnt vmcnt(28) lgkmcnt(0)
  s_add_u32 m0, s56, 6144
  s_add_u32 s51, s55, 622592
  buffer_load_dwordx4 v4, s[64:67], s51 offen lds
  s_add_u32 m0, s56, 7168
  s_add_u32 s51, s55, 638976
  buffer_load_dwordx4 v4, s[64:67], s51 offen lds
  ds_read_b64_tr_b16 a[32:33], v5 offset:8192
  ds_read_b64_tr_b16 a[34:35], v5 offset:8704
  ds_read_b64_tr_b16 a[36:37], v5 offset:8224
  ds_read_b64_tr_b16 a[38:39], v5 offset:8736
  s_waitcnt vmcnt(28) lgkmcnt(0)
  s_add_u32 m0, s56, 8192
  s_add_u32 s51, s55, 655360
  buffer_load_dwordx4 v4, s[64:67], s51 offen lds
  s_add_u32 m0, s56, 9216
  s_add_u32 s51, s55, 671744
  buffer_load_dwordx4 v4, s[64:67], s51 offen lds
  ds_read_b64_tr_b16 a[40:41], v5 offset:10240
  ds_read_b64_tr_b16 a[42:43], v5 offset:10752
  ds_read_b64_tr_b16 a[44:45], v5 offset:10272
  ds_read_b64_tr_b16 a[46:47], v5 offset:10784
  s_waitcnt vmcnt(28) lgkmcnt(0)
  s_add_u32 m0, s56, 10240
  s_add_u32 s51, s55, 688128
  buffer_load_dwordx4 v4, s[64:67], s51 offen lds
  s_add_u32 m0, s56, 11264
  s_add_u32 s51, s55, 704512
  buffer_load_dwordx4 v4, s[64:67], s51 offen lds
  ds_read_b64_tr_b16 a[48:49], v5 offset:12288
  ds_read_b64_tr_b16 a[50:51], v5 offset:12800
  ds_read_b64_tr_b16 a[52:53], v5 offset:12320
  ds_read_b64_tr_b16 a[54:55], v5 offset:12832
  s_waitcnt vmcnt(28) lgkmcnt(0)
  s_add_u32 m0, s56, 12288
  s_add_u32 s51, s55, 720896
  buffer_load_dwordx4 v4, s[64:67], s51 offen lds
  s_add_u32 m0, s56, 13312
  s_add_u32 s51, s55, 737280
  buffer_load_dwordx4 v4, s[64:67], s51 offen lds
  ds_read_b64_tr_b16 a[56:57], v5 offset:14336
  ds_read_b64_tr_b16 a[58:59], v5 offset:14848
  ds_read_b64_tr_b16 a[60:61], v5 offset:14368
  ds_read_b64_tr_b16 a[62:63], v5 offset:14880
  s_waitcnt vmcnt(28) lgkmcnt(0)
  s_add_u32 m0, s56, 14336
  s_add_u32 s51, s55, 753664
  buffer_load_dwordx4 v4, s[64:67], s51 offen lds
  s_add_u32 m0, s56, 15360
  s_add_u32 s51, s55, 770048
  buffer_load_dwordx4 v4, s[64:67], s51 offen lds
  ds_read_b64_tr_b16 a[64:65], v5 offset:16384
  ds_read_b64_tr_b16 a[66:67], v5 offset:16896
  ds_read_b64_tr_b16 a[68:69], v5 offset:16416
  ds_read_b64_tr_b16 a[70:71], v5 offset:16928
  s_waitcnt vmcnt(28) lgkmcnt(0)
  s_add_u32 m0, s56, 16384
  s_add_u32 s51, s55, 786432
  buffer_load_dwordx4 v4, s[64:67], s51 offen lds
  s_add_u32 m0, s56, 17408
  s_add_u32 s51, s55, 802816
  buffer_load_dwordx4 v4, s[64:67], s51 offen lds
  ds_read_b64_tr_b16 a[72:73], v5 offset:18432
  ds_read_b64_tr_b16 a[74:75], v5 offset:18944
  ds_read_b64_tr_b16 a[76:77], v5 offset:18464
  ds_read_b64_tr_b16 a[78:79], v5 offset:18976
  s_waitcnt vmcnt(28) lgkmcnt(0)
  s_add_u32 m0, s56, 18432
  s_add_u32 s51, s55, 819200
  buffer_load_dwordx4 v4, s[64:67], s51 offen lds
  s_add_u32 m0, s56, 19456
  s_add_u32 s51, s55, 835584
  buffer_load_dwordx4 v4, s[64:67], s51 offen lds
  ds_read_b64_tr_b16 a[80:81], v5 offset:20480
  ds_read_b64_tr_b16 a[82:83], v5 offset:20992
  ds_read_b64_tr_b16 a[84:85], v5 offset:20512
  ds_read_b64_tr_b16 a[86:87], v5 offset:21024
  s_waitcnt vmcnt(28) lgkmcnt(0)
  s_add_u32 m0, s56, 20480
  s_add_u32 s51, s55, 851968
  buffer_load_dwordx4 v4, s[64:67], s51 offen lds
  s_add_u32 m0, s56, 21504
  s_add_u32 s51, s55, 868352
  buffer_load_dwordx4 v4, s[64:67], s51 offen lds
  ds_read_b64_tr_b16 a[88:89], v5 offset:22528
  ds_read_b64_tr_b16 a[90:91], v5 offset:23040
  ds_read_b64_tr_b16 a[92:93], v5 offset:22560
  ds_read_b64_tr_b16 a[94:95], v5 offset:23072
  s_waitcnt vmcnt(28) lgkmcnt(0)
  s_add_u32 m0, s56, 22528
  s_add_u32 s51, s55, 884736
  buffer_load_dwordx4 v4, s[64:67], s51 offen lds
  s_add_u32 m0, s56, 23552
  s_add_u32 s51, s55, 901120
  buffer_load_dwordx4 v4, s[64:67], s51 offen lds
  ds_read_b64_tr_b16 a[96:97], v5 offset:24576
  ds_read_b64_tr_b16 a[98:99], v5 offset:25088
  ds_read_b64_tr_b16 a[100:101], v5 offset:24608
  ds_read_b64_tr_b16 a[102:103], v5 offset:25120
  s_waitcnt vmcnt(28) lgkmcnt(0)
  s_add_u32 m0, s56, 24576
  s_add_u32 s51, s55, 917504
  buffer_load_dwordx4 v4, s[64:67], s51 offen lds
  s_add_u32 m0, s56, 25600
  s_add_u32 s51, s55, 933888
  buffer_load_dwordx4 v4, s[64:67], s51 offen lds
  ds_read_b64_tr_b16 a[104:105], v5 offset:26624
  ds_read_b64_tr_b16 a[106:107], v5 offset:27136
  ds_read_b64_tr_b16 a[108:109], v5 offset:26656
  ds_read_b64_tr_b16 a[110:111], v5 offset:27168
  s_waitcnt vmcnt(28) lgkmcnt(0)
  s_add_u32 m0, s56, 26624
  s_add_u32 s51, s55, 950272
  buffer_load_dwordx4 v4, s[64:67], s51 offen lds
  s_add_u32 m0, s56, 27648
  s_add_u32 s51, s55, 966656
  buffer_load_dwordx4 v4, s[64:67], s51 offen lds
  ds_read_b64_tr_b16 a[112:113], v5 offset:28672
  ds_read_b64_tr_b16 a[114:115], v5 offset:29184
  ds_read_b64_tr_b16 a[116:117], v5 offset:28704
  ds_read_b64_tr_b16 a[118:119], v5 offset:29216
  s_waitcnt vmcnt(28) lgkmcnt(0)
  s_add_u32 m0, s56, 28672
  s_add_u32 s51, s55, 983040
  buffer_load_dwordx4 v4, s[64:67], s51 offen lds
  s_add_u32 m0, s56, 29696
  s_add_u32 s51, s55, 999424
  buffer_load_dwordx4 v4, s[64:67], s51 offen lds
  ds_read_b64_tr_b16 a[120:121], v5 offset:30720
  ds_read_b64_tr_b16 a[122:123], v5 offset:31232
  ds_read_b64_tr_b16 a[124:125], v5 offset:30752
  ds_read_b64_tr_b16 a[126:127], v5 offset:31264
  s_waitcnt vmcnt(28) lgkmcnt(0)
  s_add_u32 m0, s56, 30720
  s_add_u32 s51, s55, 1015808
  buffer_load_dwordx4 v4, s[64:67], s51 offen lds
  s_add_u32 m0, s56, 31744
  s_add_u32 s51, s55, 1032192
  buffer_load_dwordx4 v4, s[64:67], s51 offen lds
  ds_read_b64_tr_b16 a[128:129], v5 offset:0
  ds_read_b64_tr_b16 a[130:131], v5 offset:512
  ds_read_b64_tr_b16 a[132:133], v5 offset:32
  ds_read_b64_tr_b16 a[134:135], v5 offset:544
  s_waitcnt vmcnt(28) lgkmcnt(0)
  ds_read_b64_tr_b16 a[136:137], v5 offset:2048
  ds_read_b64_tr_b16 a[138:139], v5 offset:2560
  ds_read_b64_tr_b16 a[140:141], v5 offset:2080
  ds_read_b64_tr_b16 a[142:143], v5 offset:2592
  s_waitcnt vmcnt(26) lgkmcnt(0)
  ds_read_b64_tr_b16 a[144:145], v5 offset:4096
  ds_read_b64_tr_b16 a[146:147], v5 offset:4608
  ds_read_b64_tr_b16 a[148:149], v5 offset:4128
  ds_read_b64_tr_b16 a[150:151], v5 offset:4640
  s_waitcnt vmcnt(24) lgkmcnt(0)
  ds_read_b64_tr_b16 a[152:153], v5 offset:6144
  ds_read_b64_tr_b16 a[154:155], v5 offset:6656
  ds_read_b64_tr_b16 a[156:157], v5 offset:6176
  ds_read_b64_tr_b16 a[158:159], v5 offset:6688
  s_waitcnt vmcnt(22) lgkmcnt(0)
  ds_read_b64_tr_b16 a[160:161], v5 offset:8192
  ds_read_b64_tr_b16 a[162:163], v5 offset:8704
  ds_read_b64_tr_b16 a[164:165], v5 offset:8224
  ds_read_b64_tr_b16 a[166:167], v5 offset:8736
  s_waitcnt vmcnt(20) lgkmcnt(0)
  ds_read_b64_tr_b16 a[168:169], v5 offset:10240
  ds_read_b64_tr_b16 a[170:171], v5 offset:10752
  ds_read_b64_tr_b16 a[172:173], v5 offset:10272
  ds_read_b64_tr_b16 a[174:175], v5 offset:10784
  s_waitcnt vmcnt(18) lgkmcnt(0)
  ds_read_b64_tr_b16 a[176:177], v5 offset:12288
  ds_read_b64_tr_b16 a[178:179], v5 offset:12800
  ds_read_b64_tr_b16 a[180:181], v5 offset:12320
  ds_read_b64_tr_b16 a[182:183], v5 offset:12832
  s_waitcnt vmcnt(16) lgkmcnt(0)
  ds_read_b64_tr_b16 a[184:185], v5 offset:14336
  ds_read_b64_tr_b16 a[186:187], v5 offset:14848
  ds_read_b64_tr_b16 a[188:189], v5 offset:14368
  ds_read_b64_tr_b16 a[190:191], v5 offset:14880
  s_waitcnt vmcnt(14) lgkmcnt(0)
  ds_read_b64_tr_b16 a[192:193], v5 offset:16384
  ds_read_b64_tr_b16 a[194:195], v5 offset:16896
  ds_read_b64_tr_b16 a[196:197], v5 offset:16416
  ds_read_b64_tr_b16 a[198:199], v5 offset:16928
  s_waitcnt vmcnt(12) lgkmcnt(0)
  ds_read_b64_tr_b16 a[200:201], v5 offset:18432
  ds_read_b64_tr_b16 a[202:203], v5 offset:18944
  ds_read_b64_tr_b16 a[204:205], v5 offset:18464
  ds_read_b64_tr_b16 a[206:207], v5 offset:18976
  s_waitcnt vmcnt(10) lgkmcnt(0)
  ds_read_b64_tr_b16 a[208:209], v5 offset:20480
  ds_read_b64_tr_b16 a[210:211], v5 offset:20992
  ds_read_b64_tr_b16 a[212:213], v5 offset:20512
  ds_read_b64_tr_b16 a[214:215], v5 offset:21024
  s_waitcnt vmcnt(8) lgkmcnt(0)
  ds_read_b64_tr_b16 a[216:217], v5 offset:22528
  ds_read_b64_tr_b16 a[218:219], v5 offset:23040
  ds_read_b64_tr_b16 a[220:221], v5 offset:22560
  ds_read_b64_tr_b16 a[222:223], v5 offset:23072
  s_waitcnt vmcnt(6) lgkmcnt(0)
  ds_read_b64_tr_b16 a[224:225], v5 offset:24576
  ds_read_b64_tr_b16 a[226:227], v5 offset:25088
  ds_read_b64_tr_b16 a[228:229], v5 offset:24608
  ds_read_b64_tr_b16 a[230:231], v5 offset:25120
  s_waitcnt vmcnt(4) lgkmcnt(0)
  ds_read_b64_tr_b16 a[232:233], v5 offset:26624
  ds_read_b64_tr_b16 a[234:235], v5 offset:27136
  ds_read_b64_tr_b16 a[236:237], v5 offset:26656
  ds_read_b64_tr_b16 a[238:239], v5 offset:27168
  s_waitcnt vmcnt(2) lgkmcnt(0)
  ds_read_b64_tr_b16 a[240:241], v5 offset:28672
  ds_read_b64_tr_b16 a[242:243], v5 offset:29184
  ds_read_b64_tr_b16 a[244:245], v5 offset:28704
  ds_read_b64_tr_b16 a[246:247], v5 offset:29216
  s_waitcnt vmcnt(0) lgkmcnt(0)
  ds_read_b64_tr_b16 a[248:249], v5 offset:30720
  ds_read_b64_tr_b16 a[250:251], v5 offset:31232
  ds_read_b64_tr_b16 a[252:253], v5 offset:30752
  ds_read_b64_tr_b16 a[254:255], v5 offset:31264
  s_waitcnt lgkmcnt(0)
  s_mov_b32 s59, 0
L_ob_loop:
  s_lshr_b32 s51, s53, 2
  s_lshl_b32 s51, s51, 5
  s_lshl_b32 s52, s46, 3
  s_add_u32 s51, s51, s52
  s_lshl_b32 s58, s51, 4
  s_add_u32 s58, s58, 84508672
  s_lshl_b32 s57, s51, 13
  s_and_b32 s52, s53, 3
  s_lshl_b32 s52, s52, 7
  s_add_u32 s57, s57, s52
  s_add_u32 s57, s57, 58720256
  s_lshr_b32 s62, s53, 2
  s_add_u32 s62, s62, 1
  s_min_u32 s62, s62, 60
  s_and_b32 s63, s50, 31
  s_lshl_b32 s63, s63, 7
  s_add_u32 s63, s63, 84486144
L_nap_ob:
  buffer_load_dword v8, off, s[4:7], s63 sc1
  s_sub_u32 s49, s49, 1
  s_cbranch_scc1 L_end
  s_waitcnt vmcnt(0)
  v_readfirstlane_b32 s52, v8
  s_nop 0
  s_sub_u32 s52, s62, s52
  s_cbranch_scc1 L_napx_ob
  s_cmp_eq_u32 s52, 0
  s_cbranch_scc1 L_napx_ob
  s_min_u32 s52, s52, 8
L_napl_ob:
  s_sleep 24
  s_sub_u32 s52, s52, 1
  s_cmp_lg_u32 s52, 0
  s_cbranch_scc1 L_napl_ob
  s_branch L_nap_ob
L_napx_ob:
L_pg_ob:
  buffer_load_dword v8, v9, s[4:7], s58 offen sc1
  s_sub_u32 s49, s49, 1
  s_cbranch_scc1 L_end
  s_waitcnt vmcnt(0)
  v_cmp_gt_u32 vcc, 1, v8
  s_nop 0
  s_and_b32 vcc_lo, vcc_lo, 255
  s_cbranch_scc0 L_pk_ob
  s_sleep 4
  s_branch L_pg_ob
L_pk_ob:
  s_add_u32 s51, s57, 0
  buffer_load_dwordx4 v[128:131], v6, s[4:7], s51 offen sc1
  s_add_u32 s51, s57, 4096
  buffer_load_dwordx4 v[132:135], v6, s[4:7], s51 offen sc1
  s_add_u32 s51, s57, 8192
  buffer_load_dwordx4 v[136:139], v6, s[4:7], s51 offen sc1
  s_add_u32 s51, s57, 12288
  buffer_load_dwordx4 v[140:143], v6, s[4:7], s51 offen sc1
  s_add_u32 s51, s57, 16384
  buffer_load_dwordx4 v[144:147], v6, s[4:7], s51 offen sc1
  s_add_u32 s51, s57, 20480
  buffer_load_dwordx4 v[148:151], v6, s[4:7], s51 offen sc1
  s_add_u32 s51, s57, 24576
  buffer_load_dwordx4 v[152:155], v6, s[4:7], s51 offen sc1
  s_add_u32 s51, s57, 28672
  buffer_load_dwordx4 v[156:159], v6, s[4:7], s51 offen sc1
  s_add_u32 s51, s57, 32768
  buffer_load_dwordx4 v[160:163], v6, s[4:7], s51 offen sc1
  s_add_u32 s51, s57, 36864
  buffer_load_dwordx4 v[164:167], v6, s[4:7], s51 offen sc1
  s_add_u32 s51, s57, 40960
  buffer_load_dwordx4 v[168:171], v6, s[4:7], s51 offen sc1
  s_add_u32 s51, s57, 45056
  buffer_load_dwordx4 v[172:175], v6, s[4:7], s51 offen sc1
  s_add_u32 s51, s57, 49152
  buffer_load_dwordx4 v[176:179], v6, s[4:7], s51 offen sc1
  s_add_u32 s51, s57, 53248
  buffer_load_dwordx4 v[180:183], v6, s[4:7], s51 offen sc1
  s_add_u32 s51, s57, 57344
  buffer_load_dwordx4 v[184:187], v6, s[4:7], s51 offen sc1
  s_add_u32 s51, s57, 61440
  buffer_load_dwordx4 v[188:191], v6, s[4:7], s51 offen sc1
  s_waitcnt vmcnt(15)
  v_mfma_f32_16x16x32_bf16 v[16:19], a[0:3], v[128:131], 0
  v_mfma_f32_16x16x32_bf16 v[20:23], a[4:7], v[128:131], 0
  v_mfma_f32_16x16x32_bf16 v[24:27], a[8:11], v[128:131], 0
  v_mfma_f32_16x16x32_bf16 v[28:31], a[12:15], v[128:131], 0
  s_waitcnt vmcnt(14)
  v_mfma_f32_16x16x32_bf16 v[16:19], a[16:19], v[132:135], v[16:19]
  v_mfma_f32_16x16x32_bf16 v[20:23], a[20:23], v[132:135], v[20:23]
  v_mfma_f32_16x16x32_bf16 v[24:27], a[24:27], v[132:135], v[24:27]
  v_mfma_f32_16x16x32_bf16 v[28:31], a[28:31], v[132:135], v[28:31]
  s_waitcnt vmcnt(13)
  v_mfma_f32_16x16x32_bf16 v[16:19], a[32:35], v[136:139], v[16:19]
  v_mfma_f32_16x16x32_bf16 v[20:23], a[36:39], v[136:139], v[20:23]
  v_mfma_f32_16x16x32_bf16 v[24:27], a[40:43], v[136:139], v[24:27]
  v_mfma_f32_16x16x32_bf16 v[28:31], a[44:47], v[136:139], v[28:31]
  s_waitcnt vmcnt(12)
  v_mfma_f32_16x16x32_bf16 v[16:19], a[48:51], v[140:143], v[16:19]
  v_mfma_f32_16x16x32_bf16 v[20:23], a[52:55], v[140:143], v[20:23]
  v_mfma_f32_16x16x32_bf16 v[24:27], a[56:59], v[140:143], v[24:27]
  v_mfma_f32_16x16x32_bf16 v[28:31], a[60:63], v[140:143], v[28:31]
  s_waitcnt vmcnt(11)
  v_mfma_f32_16x16x32_bf16 v[16:19], a[64:67], v[144:147], v[16:19]
  v_mfma_f32_16x16x32_bf16 v[20:23], a[68:71], v[144:147], v[20:23]
  v_mfma_f32_16x16x32_bf16 v[24:27], a[72:75], v[144:147], v[24:27]
  v_mfma_f32_16x16x32_bf16 v[28:31], a[76:79], v[144:147], v[28:31]
  s_waitcnt vmcnt(10)
  v_mfma_f32_16x16x32_bf16 v[16:19], a[80:83], v[148:151], v[16:19]
  v_mfma_f32_16x16x32_bf16 v[20:23], a[84:87], v[148:151], v[20:23]
  v_mfma_f32_16x16x32_bf16 v[24:27], a[88:91], v[148:151], v[24:27]
  v_mfma_f32_16x16x32_bf16 v[28:31], a[92:95], v[148:151], v[28:31]
  s_waitcnt vmcnt(9)
  v_mfma_f32_16x16x32_bf16 v[16:19], a[96:99], v[152:155], v[16:19]
  v_mfma_f32_16x16x32_bf16 v[20:23], a[100:103], v[152:155], v[20:23]
  v_mfma_f32_16x16x32_bf16 v[24:27], a[104:107], v[152:155], v[24:27]
  v_mfma_f32_16x16x32_bf16 v[28:31], a[108:111], v[152:155], v[28:31]
  s_waitcnt vmcnt(8)
  v_mfma_f32_16x16x32_bf16 v[16:19], a[112:115], v[156:159], v[16:19]
  v_mfma_f32_16x16x32_bf16 v[20:23], a[116:119], v[156:159], v[20:23]
  v_mfma_f32_16x16x32_bf16 v[24:27], a[120:123], v[156:159], v[24:27]
  v_mfma_f32_16x16x32_bf16 v[28:31], a[124:127], v[156:159], v[28:31]
  s_waitcnt vmcnt(7)
  v_mfma_f32_16x16x32_bf16 v[16:19], a[128:131], v[160:163], v[16:19]
  v_mfma_f32_16x16x32_bf16 v[20:23], a[132:135], v[160:163], v[20:23]
  v_mfma_f32_16x16x32_bf16 v[24:27], a[136:139], v[160:163], v[24:27]
  v_mfma_f32_16x16x32_bf16 v[28:31], a[140:143], v[160:163], v[28:31]
  s_waitcnt vmcnt(6)
  v_mfma_f32_16x16x32_bf16 v[16:19], a[144:147], v[164:167], v[16:19]
  v_mfma_f32_16x16x32_bf16 v[20:23], a[148:151], v[164:167], v[20:23]
  v_mfma_f32_16x16x32_bf16 v[24:27], a[152:155], v[164:167], v[24:27]
  v_mfma_f32_16x16x32_bf16 v[28:31], a[156:159], v[164:167], v[28:31]
  s_waitcnt vmcnt(5)
  v_mfma_f32_16x16x32_bf16 v[16:19], a[160:163], v[168:171], v[16:19]
  v_mfma_f32_16x16x32_bf16 v[20:23], a[164:167], v[168:171], v[20:23]
  v_mfma_f32_16x16x32_bf16 v[24:27], a[168:171], v[168:171], v[24:27]
  v_mfma_f32_16x16x32_bf16 v[28:31], a[172:175], v[168:171], v[28:31]
  s_waitcnt vmcnt(4)
  v_mfma_f32_16x16x32_bf16 v[16:19], a[176:179], v[172:175], v[16:19]
  v_mfma_f32_16x16x32_bf16 v[20:23], a[180:183], v[172:175], v[20:23]
  v_mfma_f32_16x16x32_bf16 v[24:27], a[184:187], v[172:175], v[24:27]
  v_mfma_f32_16x16x32_bf16 v[28:31], a[188:191], v[172:175], v[28:31]
  s_waitcnt vmcnt(3)
  v_mfma_f32_16x16x32_bf16 v[16:19], a[192:195], v[176:179], v[16:19]
  v_mfma_f32_16x16x32_bf16 v[20:23], a[196:199], v[176:179], v[20:23]
  v_mfma_f32_16x16x32_bf16 v[24:27], a[200:203], v[176:179], v[24:27]
  v_mfma_f32_16x16x32_bf16 v[28:31], a[204:207], v[176:179], v[28:31]
  s_waitcnt vmcnt(2)
  v_mfma_f32_16x16x32_bf16 v[16:19], a[208:211], v[180:183], v[16:19]
  v_mfma_f32_16x16x32_bf16 v[20:23], a[212:215], v[180:183], v[20:23]
  v_mfma_f32_16x16x32_bf16 v[24:27], a[216:219], v[180:183], v[24:27]
  v_mfma_f32_16x16x32_bf16 v[28:31], a[220:223], v[180:183], v[28:31]
  s_waitcnt vmcnt(1)
  v_mfma_f32_16x16x32_bf16 v[16:19], a[224:227], v[184:187], v[16:19]
  v_mfma_f32_16x16x32_bf16 v[20:23], a[228:231], v[184:187], v[20:23]
  v_mfma_f32_16x16x32_bf16 v[24:27], a[232:235], v[184:187], v[24:27]
  v_mfma_f32_16x16x32_bf16 v[28:31], a[236:239], v[184:187], v[28:31]
  s_waitcnt vmcnt(0)
  v_mfma_f32_16x16x32_bf16 v[16:19], a[240:243], v[188:191], v[16:19]
  v_mfma_f32_16x16x32_bf16 v[20:23], a[244:247], v[188:191], v[20:23]
  v_mfma_f32_16x16x32_bf16 v[24:27], a[248:251], v[188:191], v[24:27]
  v_mfma_f32_16x16x32_bf16 v[28:31], a[252:255], v[188:191], v[28:31]
  s_nop 6
  v_cndmask_b32 v16, v16, v24, s[72:73]
  v_cndmask_b32 v17, v17, v25, s[72:73]
  v_cndmask_b32 v18, v18, v26, s[72:73]
  v_cndmask_b32 v19, v19, v27, s[72:73]
  v_cndmask_b32 v20, v20, v28, s[72:73]
  v_cndmask_b32 v21, v21, v29, s[72:73]
  v_cndmask_b32 v22, v22, v30, s[72:73]
  v_cndmask_b32 v23, v23, v31, s[72:73]
  v_add_u32 v8, s59, v10
  ds_write_b128 v8, v[16:19]
  ds_write_b128 v8, v[20:23] offset:1024
  s_waitcnt lgkmcnt(0)
  s_barrier
  s_cmp_ge_u32 s46, 2
  s_cbranch_scc1 L_ob_next
  v_add_u32 v8, s59, v11
  ds_read_b128 v[32:35], v8 offset:0
  ds_read_b128 v[36:39], v8 offset:2048
  ds_read_b128 v[40:43], v8 offset:4096
  ds_read_b128 v[44:47], v8 offset:6144
  s_waitcnt lgkmcnt(2)
  v_add_f32 v32, v32, v36
  s_waitcnt lgkmcnt(0)
  v_add_f32 v40, v40, v44
  v_add_f32 v32, v32, v40
  v_add_f32 v33, v33, v37
  v_add_f32 v41, v41, v45
  v_add_f32 v33, v33, v41
  v_add_f32 v34, v34, v38
  v_add_f32 v42, v42, v46
  v_add_f32 v34, v34, v42
  v_add_f32 v35, v35, v39
  v_add_f32 v43, v43, v47
  v_add_f32 v35, v35, v43
  v_add_f32_dpp v32, v32, v32 row_ror:8 row_mask:0xf bank_mask:0xf
  v_add_f32_dpp v33, v33, v33 row_ror:8 row_mask:0xf bank_mask:0xf
  v_add_f32_dpp v34, v34, v34 row_ror:8 row_mask:0xf bank_mask:0xf
  v_add_f32_dpp v35, v35, v35 row_ror:8 row_mask:0xf bank_mask:0xf
  v_cvt_pk_bf16_f32 v32, v32, v33
  v_cvt_pk_bf16_f32 v33, v34, v35
  s_lshl_b32 s51, s53, 14
  s_lshl_b32 s52, s54, 6
  s_add_u32 s51, s51, s52
  s_lshl_b32 s52, s46, 5
  s_add_u32 s51, s51, s52
  buffer_store_dwordx2 v[32:33], v7, s[68:71], s51 offen offset:1024
L_ob_next:
  s_xor_b32 s59, s59, 8192
  s_add_u32 s53, s53, 8
  s_cmp_lt_u32 s53, 256
  s_cbranch_scc1 L_ob_loop
  s_branch L_end
L_attn_b:
  v_and_b32 v1, 63, v0
  v_lshlrev_b32 v3, 4, v1
  v_and_b32 v4, 39, v1
  v_bfe_u32 v2, v1, 3, 1
  v_lshl_or_b32 v4, v2, 4, v4
  v_bfe_u32 v2, v1, 4, 1
  v_lshl_or_b32 v4, v2, 3, v4
  v_lshlrev_b32 v4, 4, v4
  v_and_b32 v2, 31, v1
  v_lshrrev_b32 v7, 5, v1
  v_lshlrev_b32 v7, 2, v7
  v_sub_u32 v2, v2, v7
  v_mov_b32 v7, 4048155338
  v_cmp_gt_i32 vcc, 0, v2
  s_nop 1
  v_cndmask_b32 v16, 0, v7, vcc
  v_cmp_gt_i32 vcc, 1, v2
  s_nop 1
  v_cndmask_b32 v17, 0, v7, vcc
  v_cmp_gt_i32 vcc, 2, v2
  s_nop 1
  v_cndmask_b32 v18, 0, v7, vcc
  v_cmp_gt_i32 vcc, 3, v2
  s_nop 1
  v_cndmask_b32 v19, 0, v7, vcc
  v_cmp_gt_i32 vcc, 8, v2
  s_nop 1
  v_cndmask_b32 v20, 0, v7, vcc
  v_cmp_gt_i32 vcc, 9, v2
  s_nop 1
  v_cndmask_b32 v21, 0, v7, vcc
  v_cmp_gt_i32 vcc, 10, v2
  s_nop 1
  v_cndmask_b32 v22, 0, v7, vcc
  v_cmp_gt_i32 vcc, 11, v2
  s_nop 1
  v_cndmask_b32 v23, 0, v7, vcc
  v_cmp_gt_i32 vcc, 16, v2
  s_nop 1
  v_cndmask_b32 v24, 0, v7, vcc
  v_cmp_gt_i32 vcc, 17, v2
  s_nop 1
  v_cndmask_b32 v25, 0, v7, vcc
  v_cmp_gt_i32 vcc, 18, v2
  s_nop 1
  v_cndmask_b32 v26, 0, v7, vcc
  v_cmp_gt_i32 vcc, 19, v2
  s_nop 1
  v_cndmask_b32 v27, 0, v7, vcc
  v_cmp_gt_i32 vcc, 24, v2
  s_nop 1
  v_cndmask_b32 v28, 0, v7, vcc
  v_cmp_gt_i32 vcc, 25, v2
  s_nop 1
  v_cndmask_b32 v29, 0, v7, vcc
  v_cmp_gt_i32 vcc, 26, v2
  s_nop 1
  v_cndmask_b32 v30, 0, v7, vcc
  v_cmp_gt_i32 vcc, 27, v2
  s_nop 1
  v_cndmask_b32 v31, 0, v7, vcc
  v_lshrrev_b32 v2, 5, v1
  v_lshlrev_b32 v5, 8, v2
  v_and_b32 v2, 15, v1
  v_lshl_add_u32 v5, v2, 4, v5
  v_bfe_u32 v2, v1, 4, 1
  v_lshl_add_u32 v5, v2, 2, v5
  v_add_u32 v5, 8, v5
  s_lshl_b32 s61, s46, 12
  v_and_b32 v2, 3, v1
  v_lshlrev_b32 v6, 8, v2
  v_lshrrev_b32 v2, 5, v1
  v_lshl_add_u32 v6, v2, 6, v6
  v_bfe_u32 v2, v1, 2, 2
  v_lshl_add_u32 v6, v2, 4, v6
  v_add_u32 v6, s61, v6
  v_add_u32 v5, s61, v5
  v_add_u32 v12, s61, v3
  v_and_b32 v11, 3, v1
  v_lshlrev_b32 v11, 2, v11
  v_mov_b32 v10, 1
  v_mov_b64 v[194:195], 0
  v_mov_b64 v[198:199], 0
  v_mov_b64 v[202:203], 0
  v_mov_b64 v[206:207], 0
  v_mov_b64 v[218:219], 0
  s_mov_b32 s53, s46
  s_lshl_b32 s51, s50, 6
  s_add_u32 s51, s51, s53
  s_mul_i32 s54, s51, 24576
  s_lshl_b32 s55, s51, 12
  s_add_u32 s55, s55, 75497472
  s_lshl_b32 s57, s51, 2
  s_add_u32 s57, s57, 84475904
  s_lshl_b32 s58, s50, 7
  s_add_u32 s58, s58, 84486144
  s_lshl_b32 s51, s53, 5
  s_add_u32 s51, s51, s50
  s_lshl_b32 s56, s51, 13
  s_add_u32 s56, s56, 58720256
  s_lshr_b32 s59, s51, 3
  s_lshl_b32 s59, s59, 7
  s_and_b32 s51, s50, 7
  s_lshl_b32 s51, s51, 2
  s_add_u32 s59, s59, s51
  s_add_u32 s59, s59, 84508672
  s_mov_b32 s60, 0x3e0293ee
  s_waitcnt vmcnt(0)
L_ab_loop:
L_pg_abq:
  buffer_load_dword v7, off, s[4:7], s57  sc1
  s_sub_u32 s49, s49, 1
  s_cbranch_scc1 L_end
  s_waitcnt vmcnt(0)
  v_cmp_gt_u32 vcc, 2, v7
  s_nop 0
  s_and_b32 vcc_lo, vcc_lo, 1
  s_cbranch_scc0 L_pk_abq
  s_sleep 4
  s_branch L_pg_abq
L_pk_abq:
  s_add_u32 s51, s54, 4096
  s_add_u32 s51, s54, 8192
  s_add_u32 s52, s54, 12288
  buffer_load_dwordx4 v[64:67], v4, s[4:7], s51 offen offset:0 sc1
  buffer_load_dwordx4 v[68:71], v4, s[4:7], s51 offen offset:1024 sc1
  buffer_load_dwordx4 v[72:75], v4, s[4:7], s51 offen offset:2048 sc1
  buffer_load_dwordx4 v[76:79], v4, s[4:7], s51 offen offset:3072 sc1
  buffer_load_dwordx4 v[80:83], v4, s[4:7], s52 offen offset:0 sc1
  buffer_load_dwordx4 v[84:87], v4, s[4:7], s52 offen offset:1024 sc1
  buffer_load_dwordx4 v[88:91], v4, s[4:7], s52 offen offset:2048 sc1
  buffer_load_dwordx4 v[92:95], v4, s[4:7], s52 offen offset:3072 sc1
  s_add_u32 s51, s54, 0
  s_add_u32 s52, s54, 4096
  buffer_load_dwordx4 v[32:35], v3, s[4:7], s51 offen offset:0 sc1
  buffer_load_dwordx4 v[36:39], v3, s[4:7], s51 offen offset:1024 sc1
  buffer_load_dwordx4 v[40:43], v3, s[4:7], s51 offen offset:2048 sc1
  buffer_load_dwordx4 v[44:47], v3, s[4:7], s51 offen offset:3072 sc1
  buffer_load_dwordx4 v[48:51], v3, s[4:7], s52 offen offset:0 sc1
  buffer_load_dwordx4 v[52:55], v3, s[4:7], s52 offen offset:1024 sc1
  buffer_load_dwordx4 v[56:59], v3, s[4:7], s52 offen offset:2048 sc1
  buffer_load_dwordx4 v[60:63], v3, s[4:7], s52 offen offset:3072 sc1
  s_add_u32 s51, s54, 16384
  s_add_u32 s52, s54, 20480
  buffer_load_dwordx4 v[96:99], v3, s[4:7], s51 offen offset:0 sc1
  buffer_load_dwordx4 v[100:103], v3, s[4:7], s51 offen offset:1024 sc1
  buffer_load_dwordx4 v[104:107], v3, s[4:7], s51 offen offset:2048 sc1
  buffer_load_dwordx4 v[108:111], v3, s[4:7], s51 offen offset:3072 sc1
  buffer_load_dwordx4 v[112:115], v3, s[4:7], s52 offen offset:0 sc1
  buffer_load_dwordx4 v[116:119], v3, s[4:7], s52 offen offset:1024 sc1
  buffer_load_dwordx4 v[120:123], v3, s[4:7], s52 offen offset:2048 sc1
  buffer_load_dwordx4 v[124:127], v3, s[4:7], s52 offen offset:3072 sc1
  s_waitcnt vmcnt(15)
  v_mfma_f32_32x32x16_bf16 v[128:143], v[64:67], v[32:35], v[16:31]
  s_waitcnt vmcnt(14)
  v_mfma_f32_32x32x16_bf16 v[128:143], v[68:71], v[36:39], v[128:143]
  s_waitcnt vmcnt(13)
  v_mfma_f32_32x32x16_bf16 v[128:143], v[72:75], v[40:43], v[128:143]
  s_waitcnt vmcnt(12)
  v_mfma_f32_32x32x16_bf16 v[128:143], v[76:79], v[44:47], v[128:143]
  s_waitcnt vmcnt(11)
  v_mfma_f32_32x32x16_bf16 v[128:143], v[80:83], v[48:51], v[128:143]
  s_waitcnt vmcnt(10)
  v_mfma_f32_32x32x16_bf16 v[128:143], v[84:87], v[52:55], v[128:143]
  s_waitcnt vmcnt(9)
  v_mfma_f32_32x32x16_bf16 v[128:143], v[88:91], v[56:59], v[128:143]
  s_waitcnt vmcnt(8)
  v_mfma_f32_32x32x16_bf16 v[128:143], v[92:95], v[60:63], v[128:143]
  s_add_u32 s51, s53, 1
  s_sub_u32 s62, s53, 1
  s_min_u32 s62, s62, 61
  s_cmp_ge_u32 s53, 60
  s_cselect_b32 s51, s62, s51
  s_sub_u32 s62, s51, 1
  s_waitcnt vmcnt(0)
L_nap_ab:
  buffer_load_dword v7, off, s[4:7], s58 sc1
  s_sub_u32 s49, s49, 1
  s_cbranch_scc1 L_end
  s_waitcnt vmcnt(0)
  v_readfirstlane_b32 s52, v7
  s_nop 0
  s_sub_u32 s52, s62, s52
  s_cbranch_scc1 L_napx_ab
  s_cmp_eq_u32 s52, 0
  s_cbranch_scc1 L_napx_ab
  s_min_u32 s52, s52, 8
L_napl_ab:
  s_sleep 24
  s_sub_u32 s52, s52, 1
  s_cmp_lg_u32 s52, 0
  s_cbranch_scc1 L_napl_ab
  s_branch L_nap_ab
L_napx_ab:
L_pg_abc:
  buffer_load_dword v7, v11, s[4:7], s58 offen sc1
  s_sub_u32 s49, s49, 1
  s_cbranch_scc1 L_end
  s_waitcnt vmcnt(0)
  v_cmp_gt_u32 vcc, s51, v7
  s_nop 0
  s_and_b32 vcc_lo, vcc_lo, 15
  s_cbranch_scc0 L_pk_abc
  s_sleep 4
  s_branch L_pg_abc
L_pk_abc:
  s_mov_b32 s62, 2139193217
  s_branch L_ab_ex1
L_ab_ex:
  s_sleep 0
L_ab_ex1:
  buffer_load_dwordx4 v[144:147], v3, s[4:7], s55 offen offset:0 sc1
  buffer_load_dwordx4 v[148:151], v3, s[4:7], s55 offen offset:1024 sc1
  buffer_load_dwordx4 v[152:155], v3, s[4:7], s55 offen offset:2048 sc1
  buffer_load_dwordx4 v[156:159], v3, s[4:7], s55 offen offset:3072 sc1
  s_sub_u32 s49, s49, 1
  s_cbranch_scc1 L_end
  s_waitcnt vmcnt(3)
  v_xor_b32 v160, s62, v144
  v_xor_b32 v161, s62, v145
  v_xor_b32 v162, s62, v146
  v_xor_b32 v163, s62, v147
  s_waitcnt vmcnt(2)
  v_xor_b32 v164, s62, v148
  v_xor_b32 v165, s62, v149
  v_xor_b32 v166, s62, v150
  v_xor_b32 v167, s62, v151
  s_waitcnt vmcnt(1)
  v_xor_b32 v168, s62, v152
  v_xor_b32 v169, s62, v153
  v_xor_b32 v170, s62, v154
  v_xor_b32 v171, s62, v155
  s_waitcnt vmcnt(0)
  v_xor_b32 v172, s62, v156
  v_xor_b32 v173, s62, v157
  v_xor_b32 v174, s62, v158
  v_xor_b32 v175, s62, v159
  ds_write_b128 v12, v[144:147] offset:0
  ds_write_b128 v12, v[148:151] offset:1024
  ds_write_b128 v12, v[152:155] offset:2048
  ds_write_b128 v12, v[156:159] offset:3072
  v_min3_u32 v7, v160, v161, v162
  v_min3_u32 v7, v7, v163, v164
  v_min3_u32 v7, v7, v165, v166
  v_min3_u32 v7, v7, v167, v168
  v_min3_u32 v7, v7, v169, v170
  v_min3_u32 v7, v7, v171, v172
  v_min3_u32 v7, v7, v173, v174
  v_min_u32 v7, v7, v175
  v_cmp_eq_u32 vcc, 0, v7
  s_waitcnt lgkmcnt(0)
  s_cbranch_vccnz L_ab_ex
  ds_read2st64_b32 v[192:193], v5 offset0:0 offset1:2
  ds_read2st64_b32 v[196:197], v5 offset0:4 offset1:6
  ds_read2st64_b32 v[200:201], v5 offset0:8 offset1:10
  ds_read2st64_b32 v[204:205], v5 offset0:12 offset1:14
  ds_read_b64_tr_b16 v[176:177], v6 offset:0
  ds_read_b64_tr_b16 v[178:179], v6 offset:128
  ds_read_b64_tr_b16 v[180:181], v6 offset:1024
  ds_read_b64_tr_b16 v[182:183], v6 offset:1152
  ds_read_b64_tr_b16 v[184:185], v6 offset:2048
  ds_read_b64_tr_b16 v[186:187], v6 offset:2176
  ds_read_b64_tr_b16 v[188:189], v6 offset:3072
  ds_read_b64_tr_b16 v[190:191], v6 offset:3200
  s_waitcnt lgkmcnt(6)
  v_mfma_f32_32x32x16_bf16 v[144:159], v[176:179], v[32:35], 0
  v_mfma_f32_32x32x16_bf16 v[160:175], v[176:179], v[36:39], 0
  s_waitcnt lgkmcnt(4)
  v_mfma_f32_32x32x16_bf16 v[144:159], v[180:183], v[40:43], v[144:159]
  v_mfma_f32_32x32x16_bf16 v[160:175], v[180:183], v[44:47], v[160:175]
  s_waitcnt lgkmcnt(2)
  v_mfma_f32_32x32x16_bf16 v[144:159], v[184:187], v[48:51], v[144:159]
  v_mfma_f32_32x32x16_bf16 v[160:175], v[184:187], v[52:55], v[160:175]
  s_waitcnt lgkmcnt(0)
  v_mfma_f32_32x32x16_bf16 v[144:159], v[188:191], v[56:59], v[144:159]
  v_mfma_f32_32x32x16_bf16 v[160:175], v[188:191], v[60:63], v[160:175]
  s_nop 11
  v_add_f32 v144, v144, v162
  v_add_f32 v145, v145, v163
  v_add_f32 v148, v148, v166
  v_add_f32 v149, v149, v167
  v_max3_f32 v8, v128, v129, v130
  v_max3_f32 v8, v8, v131, v132
  v_max3_f32 v8, v8, v133, v134
  v_max3_f32 v8, v8, v135, v136
  v_max3_f32 v8, v8, v137, v138
  v_max3_f32 v8, v8, v139, v140
  v_max3_f32 v8, v8, v141, v142
  v_max3_f32 v8, v8, v143, v144
  v_max3_f32 v8, v8, v145, v148
  v_max_f32 v8, v8, v149
  v_mov_b32 v9, v8
  s_nop 1
  v_permlane32_swap_b32 v8, v9
  v_max_f32 v8, v8, v9
  v_mul_f32 v8, s60, v8
  v_fma_f32 v128, v128, s60, -v8
  v_fma_f32 v129, v129, s60, -v8
  v_fma_f32 v130, v130, s60, -v8
  v_fma_f32 v131, v131, s60, -v8
  v_fma_f32 v132, v132, s60, -v8
  v_fma_f32 v133, v133, s60, -v8
  v_fma_f32 v134, v134, s60, -v8
  v_fma_f32 v135, v135, s60, -v8
  v_fma_f32 v136, v136, s60, -v8
  v_fma_f32 v137, v137, s60, -v8
  v_fma_f32 v138, v138, s60, -v8
  v_fma_f32 v139, v139, s60, -v8
  v_fma_f32 v140, v140, s60, -v8
  v_fma_f32 v141, v141, s60, -v8
  v_fma_f32 v142, v142, s60, -v8
  v_fma_f32 v143, v143, s60, -v8
  v_fma_f32 v144, v144, s60, -v8
  v_fma_f32 v145, v145, s60, -v8
  v_fma_f32 v148, v148, s60, -v8
  v_fma_f32 v149, v149, s60, -v8
  v_exp_f32 v128, v128
  v_exp_f32 v129, v129
  v_exp_f32 v130, v130
  v_exp_f32 v131, v131
  v_exp_f32 v132, v132
  v_exp_f32 v133, v133
  v_exp_f32 v134, v134
  v_exp_f32 v135, v135
  v_exp_f32 v136, v136
  v_exp_f32 v137, v137
  v_exp_f32 v138, v138
  v_exp_f32 v139, v139
  v_exp_f32 v140, v140
  v_exp_f32 v141, v141
  v_exp_f32 v142, v142
  v_exp_f32 v143, v143
  v_exp_f32 v144, v144
  v_exp_f32 v145, v145
  v_exp_f32 v148, v148
  v_exp_f32 v149, v149
  v_add_f32 v8, v128, v129
  v_add_f32 v9, v130, v131
  v_add_f32 v8, v8, v132
  v_add_f32 v9, v9, v133
  v_add_f32 v8, v8, v134
  v_add_f32 v9, v9, v135
  v_add_f32 v8, v8, v136
  v_add_f32 v9, v9, v137
  v_add_f32 v8, v8, v138
  v_add_f32 v9, v9, v139
  v_add_f32 v8, v8, v140
  v_add_f32 v9, v9, v141
  v_add_f32 v8, v8, v142
  v_add_f32 v9, v9, v143
  v_add_f32 v8, v8, v144
  v_add_f32 v9, v9, v145
  v_add_f32 v8, v8, v148
  v_add_f32 v9, v9, v149
  v_add_f32 v8, v8, v9
  v_mov_b32 v9, v8
  s_nop 1
  v_permlane32_swap_b32 v8, v9
  v_add_f32 v8, v8, v9
  v_rcp_f32 v8, v8
  v_cvt_pk_bf16_f32 v208, v128, v129
  v_cvt_pk_bf16_f32 v209, v130, v131
  v_cvt_pk_bf16_f32 v210, v132, v133
  v_cvt_pk_bf16_f32 v211, v134, v135
  v_cvt_pk_bf16_f32 v212, v136, v137
  v_cvt_pk_bf16_f32 v213, v138, v139
  v_cvt_pk_bf16_f32 v214, v140, v141
  v_cvt_pk_bf16_f32 v215, v142, v143
  v_cvt_pk_bf16_f32 v216, v144, v145
  v_cvt_pk_bf16_f32 v217, v148, v149
  v_mfma_f32_32x32x16_bf16 v[128:143], v[96:99], v[208:211], 0
  v_mfma_f32_32x32x16_bf16 v[128:143], v[100:103], v[212:215], v[128:143]
  v_mfma_f32_32x32x16_bf16 v[128:143], v[192:195], v[216:219], v[128:143]
  v_mfma_f32_32x32x16_bf16 v[144:159], v[104:107], v[208:211], 0
  v_mfma_f32_32x32x16_bf16 v[144:159], v[108:111], v[212:215], v[144:159]
  v_mfma_f32_32x32x16_bf16 v[144:159], v[196:199], v[216:219], v[144:159]
  v_mfma_f32_32x32x16_bf16 v[160:175], v[112:115], v[208:211], 0
  v_mfma_f32_32x32x16_bf16 v[160:175], v[116:119], v[212:215], v[160:175]
  v_mfma_f32_32x32x16_bf16 v[160:175], v[200:203], v[216:219], v[160:175]
  v_mfma_f32_32x32x16_bf16 v[176:191], v[120:123], v[208:211], 0
  v_mfma_f32_32x32x16_bf16 v[176:191], v[124:127], v[212:215], v[176:191]
  v_mfma_f32_32x32x16_bf16 v[176:191], v[204:207], v[216:219], v[176:191]
  s_add_u32 s52, s56, 4096
  s_nop 1
  v_mul_f32 v128, v128, v8
  v_mul_f32 v129, v129, v8
  v_mul_f32 v130, v130, v8
  v_mul_f32 v131, v131, v8
  v_mul_f32 v132, v132, v8
  v_mul_f32 v133, v133, v8
  v_mul_f32 v134, v134, v8
  v_mul_f32 v135, v135, v8
  v_mul_f32 v136, v136, v8
  v_mul_f32 v137, v137, v8
  v_mul_f32 v138, v138, v8
  v_mul_f32 v139, v139, v8
  v_mul_f32 v140, v140, v8
  v_mul_f32 v141, v141, v8
  v_mul_f32 v142, v142, v8
  v_mul_f32 v143, v143, v8
  v_cvt_pk_bf16_f32 v32, v128, v129
  v_cvt_pk_bf16_f32 v33, v130, v131
  v_cvt_pk_bf16_f32 v34, v132, v133
  v_cvt_pk_bf16_f32 v35, v134, v135
  v_cvt_pk_bf16_f32 v36, v136, v137
  v_cvt_pk_bf16_f32 v37, v138, v139
  v_cvt_pk_bf16_f32 v38, v140, v141
  v_cvt_pk_bf16_f32 v39, v142, v143
  buffer_store_dwordx4 v[32:35], v3, s[4:7], s56 offen offset:0 sc1
  buffer_store_dwordx4 v[36:39], v3, s[4:7], s56 offen offset:1024 sc1
  v_mul_f32 v144, v144, v8
  v_mul_f32 v145, v145, v8
  v_mul_f32 v146, v146, v8
  v_mul_f32 v147, v147, v8
  v_mul_f32 v148, v148, v8
  v_mul_f32 v149, v149, v8
  v_mul_f32 v150, v150, v8
  v_mul_f32 v151, v151, v8
  v_mul_f32 v152, v152, v8
  v_mul_f32 v153, v153, v8
  v_mul_f32 v154, v154, v8
  v_mul_f32 v155, v155, v8
  v_mul_f32 v156, v156, v8
  v_mul_f32 v157, v157, v8
  v_mul_f32 v158, v158, v8
  v_mul_f32 v159, v159, v8
  v_cvt_pk_bf16_f32 v40, v144, v145
  v_cvt_pk_bf16_f32 v41, v146, v147
  v_cvt_pk_bf16_f32 v42, v148, v149
  v_cvt_pk_bf16_f32 v43, v150, v151
  v_cvt_pk_bf16_f32 v44, v152, v153
  v_cvt_pk_bf16_f32 v45, v154, v155
  v_cvt_pk_bf16_f32 v46, v156, v157
  v_cvt_pk_bf16_f32 v47, v158, v159
  buffer_store_dwordx4 v[40:43], v3, s[4:7], s56 offen offset:2048 sc1
  buffer_store_dwordx4 v[44:47], v3, s[4:7], s56 offen offset:3072 sc1
  v_mul_f32 v160, v160, v8
  v_mul_f32 v161, v161, v8
  v_mul_f32 v162, v162, v8
  v_mul_f32 v163, v163, v8
  v_mul_f32 v164, v164, v8
  v_mul_f32 v165, v165, v8
  v_mul_f32 v166, v166, v8
  v_mul_f32 v167, v167, v8
  v_mul_f32 v168, v168, v8
  v_mul_f32 v169, v169, v8
  v_mul_f32 v170, v170, v8
  v_mul_f32 v171, v171, v8
  v_mul_f32 v172, v172, v8
  v_mul_f32 v173, v173, v8
  v_mul_f32 v174, v174, v8
  v_mul_f32 v175, v175, v8
  v_cvt_pk_bf16_f32 v48, v160, v161
  v_cvt_pk_bf16_f32 v49, v162, v163
  v_cvt_pk_bf16_f32 v50, v164, v165
  v_cvt_pk_bf16_f32 v51, v166, v167
  v_cvt_pk_bf16_f32 v52, v168, v169
  v_cvt_pk_bf16_f32 v53, v170, v171
  v_cvt_pk_bf16_f32 v54, v172, v173
  v_cvt_pk_bf16_f32 v55, v174, v175
  buffer_store_dwordx4 v[48:51], v3, s[4:7], s52 offen offset:0 sc1
  buffer_store_dwordx4 v[52:55], v3, s[4:7], s52 offen offset:1024 sc1
  v_mul_f32 v176, v176, v8
  v_mul_f32 v177, v177, v8
  v_mul_f32 v178, v178, v8
  v_mul_f32 v179, v179, v8
  v_mul_f32 v180, v180, v8
  v_mul_f32 v181, v181, v8
  v_mul_f32 v182, v182, v8
  v_mul_f32 v183, v183, v8
  v_mul_f32 v184, v184, v8
  v_mul_f32 v185, v185, v8
  v_mul_f32 v186, v186, v8
  v_mul_f32 v187, v187, v8
  v_mul_f32 v188, v188, v8
  v_mul_f32 v189, v189, v8
  v_mul_f32 v190, v190, v8
  v_mul_f32 v191, v191, v8
  v_cvt_pk_bf16_f32 v56, v176, v177
  v_cvt_pk_bf16_f32 v57, v178, v179
  v_cvt_pk_bf16_f32 v58, v180, v181
  v_cvt_pk_bf16_f32 v59, v182, v183
  v_cvt_pk_bf16_f32 v60, v184, v185
  v_cvt_pk_bf16_f32 v61, v186, v187
  v_cvt_pk_bf16_f32 v62, v188, v189
  v_cvt_pk_bf16_f32 v63, v190, v191
  buffer_store_dwordx4 v[56:59], v3, s[4:7], s52 offen offset:2048 sc1
  buffer_store_dwordx4 v[60:63], v3, s[4:7], s52 offen offset:3072 sc1
  s_waitcnt vmcnt(0)
  s_mov_b64 exec, 1
  buffer_store_dword v10, off, s[4:7], s59 sc1
  s_mov_b64 exec, -1
  s_add_u32 s54, s54, 98304
  s_add_u32 s55, s55, 16384
  s_add_u32 s57, s57, 16
  s_add_u32 s56, s56, 1048576
  s_add_u32 s59, s59, 2048
  s_add_u32 s53, s53, 4
  s_cmp_lt_u32 s53, 64
  s_cbranch_scc1 L_ab_loop
  s_branch L_end
L_part_a:
  s_mov_b32 s64, s24
  s_and_b32 s65, s25, 0xffff
  s_mov_b32 s66, 524288
  s_mov_b32 s67, 0x20000
  s_mov_b32 s68, s40
  s_and_b32 s69, s41, 0xffff
  s_mov_b32 s70, 4194304
  s_mov_b32 s71, 0x20000
  v_and_b32 v1, 63, v0
  v_lshlrev_b32 v3, 4, v1
  v_and_b32 v4, 39, v1
  v_bfe_u32 v2, v1, 3, 1
  v_lshl_or_b32 v4, v2, 4, v4
  v_bfe_u32 v2, v1, 4, 1
  v_lshl_or_b32 v4, v2, 3, v4
  v_lshlrev_b32 v4, 4, v4
  s_sub_u32 s53, s50, 32
  s_and_b32 s54, s53, 1
  s_lshr_b32 s53, s53, 1
  s_mov_b32 s58, 0x3eb8aa3b
  v_and_b32 v2, 31, v1
  v_lshrrev_b32 v7, 5, v1
  v_lshlrev_b32 v7, 2, v7
  v_sub_u32 v2, v2, v7
  v_mov_b32 v12, 4048155338
  v_add_u32 v7, 0, v2
  v_and_b32 v7, 0xfffffff1, v7
  v_cmp_ne_u32 vcc, 0, v7
  s_nop 1
  v_cndmask_b32 v16, 0, v12, vcc
  v_add_u32 v7, -1, v2
  v_and_b32 v7, 0xfffffff1, v7
  v_cmp_ne_u32 vcc, 0, v7
  s_nop 1
  v_cndmask_b32 v17, 0, v12, vcc
  v_add_u32 v7, -2, v2
  v_and_b32 v7, 0xfffffff1, v7
  v_cmp_ne_u32 vcc, 0, v7
  s_nop 1
  v_cndmask_b32 v18, 0, v12, vcc
  v_add_u32 v7, -3, v2
  v_and_b32 v7, 0xfffffff1, v7
  v_cmp_ne_u32 vcc, 0, v7
  s_nop 1
  v_cndmask_b32 v19, 0, v12, vcc
  v_add_u32 v7, -8, v2
  v_and_b32 v7, 0xfffffff1, v7
  v_cmp_ne_u32 vcc, 0, v7
  s_nop 1
  v_cndmask_b32 v20, 0, v12, vcc
  v_add_u32 v7, -9, v2
  v_and_b32 v7, 0xfffffff1, v7
  v_cmp_ne_u32 vcc, 0, v7
  s_nop 1
  v_cndmask_b32 v21, 0, v12, vcc
  v_add_u32 v7, -10, v2
  v_and_b32 v7, 0xfffffff1, v7
  v_cmp_ne_u32 vcc, 0, v7
  s_nop 1
  v_cndmask_b32 v22, 0, v12, vcc
  v_add_u32 v7, -11, v2
  v_and_b32 v7, 0xfffffff1, v7
  v_cmp_ne_u32 vcc, 0, v7
  s_nop 1
  v_cndmask_b32 v23, 0, v12, vcc
  v_add_u32 v7, -16, v2
  v_and_b32 v7, 0xfffffff1, v7
  v_cmp_ne_u32 vcc, 0, v7
  s_nop 1
  v_cndmask_b32 v24, 0, v12, vcc
  v_add_u32 v7, -17, v2
  v_and_b32 v7, 0xfffffff1, v7
  v_cmp_ne_u32 vcc, 0, v7
  s_nop 1
  v_cndmask_b32 v25, 0, v12, vcc
  v_add_u32 v7, -18, v2
  v_and_b32 v7, 0xfffffff1, v7
  v_cmp_ne_u32 vcc, 0, v7
  s_nop 1
  v_cndmask_b32 v26, 0, v12, vcc
  v_add_u32 v7, -19, v2
  v_and_b32 v7, 0xfffffff1, v7
  v_cmp_ne_u32 vcc, 0, v7
  s_nop 1
  v_cndmask_b32 v27, 0, v12, vcc
  v_add_u32 v7, -24, v2
  v_and_b32 v7, 0xfffffff1, v7
  v_cmp_ne_u32 vcc, 0, v7
  s_nop 1
  v_cndmask_b32 v28, 0, v12, vcc
  v_add_u32 v7, -25, v2
  v_and_b32 v7, 0xfffffff1, v7
  v_cmp_ne_u32 vcc, 0, v7
  s_nop 1
  v_cndmask_b32 v29, 0, v12, vcc
  v_add_u32 v7, -26, v2
  v_and_b32 v7, 0xfffffff1, v7
  v_cmp_ne_u32 vcc, 0, v7
  s_nop 1
  v_cndmask_b32 v30, 0, v12, vcc
  v_add_u32 v7, -27, v2
  v_and_b32 v7, 0xfffffff1, v7
  v_cmp_ne_u32 vcc, 0, v7
  s_nop 1
  v_cndmask_b32 v31, 0, v12, vcc
  v_add_u32 v7, 32, v2
  v_and_b32 v7, 0xfffffff1, v7
  v_cmp_ne_u32 vcc, 0, v7
  s_nop 1
  v_cndmask_b32 v32, 0, v12, vcc
  v_add_u32 v7, 31, v2
  v_and_b32 v7, 0xfffffff1, v7
  v_cmp_ne_u32 vcc, 0, v7
  s_nop 1
  v_cndmask_b32 v33, 0, v12, vcc
  v_add_u32 v7, 30, v2
  v_and_b32 v7, 0xfffffff1, v7
  v_cmp_ne_u32 vcc, 0, v7
  s_nop 1
  v_cndmask_b32 v34, 0, v12, vcc
  v_add_u32 v7, 29, v2
  v_and_b32 v7, 0xfffffff1, v7
  v_cmp_ne_u32 vcc, 0, v7
  s_nop 1
  v_cndmask_b32 v35, 0, v12, vcc
  v_add_u32 v7, 24, v2
  v_and_b32 v7, 0xfffffff1, v7
  v_cmp_ne_u32 vcc, 0, v7
  s_nop 1
  v_cndmask_b32 v36, 0, v12, vcc
  v_add_u32 v7, 23, v2
  v_and_b32 v7, 0xfffffff1, v7
  v_cmp_ne_u32 vcc, 0, v7
  s_nop 1
  v_cndmask_b32 v37, 0, v12, vcc
  v_add_u32 v7, 22, v2
  v_and_b32 v7, 0xfffffff1, v7
  v_cmp_ne_u32 vcc, 0, v7
  s_nop 1
  v_cndmask_b32 v38, 0, v12, vcc
  v_add_u32 v7, 21, v2
  v_and_b32 v7, 0xfffffff1, v7
  v_cmp_ne_u32 vcc, 0, v7
  s_nop 1
  v_cndmask_b32 v39, 0, v12, vcc
  v_add_u32 v7, 16, v2
  v_and_b32 v7, 0xfffffff1, v7
  v_cmp_ne_u32 vcc, 0, v7
  s_nop 1
  v_cndmask_b32 v40, 0, v12, vcc
  v_add_u32 v7, 15, v2
  v_and_b32 v7, 0xfffffff1, v7
  v_cmp_ne_u32 vcc, 0, v7
  s_nop 1
  v_cndmask_b32 v41, 0, v12, vcc
  v_add_u32 v7, 14, v2
  v_and_b32 v7, 0xfffffff1, v7
  v_cmp_ne_u32 vcc, 0, v7
  s_nop 1
  v_cndmask_b32 v42, 0, v12, vcc
  v_add_u32 v7, 13, v2
  v_and_b32 v7, 0xfffffff1, v7
  v_cmp_ne_u32 vcc, 0, v7
  s_nop 1
  v_cndmask_b32 v43, 0, v12, vcc
  v_add_u32 v7, 8, v2
  v_and_b32 v7, 0xfffffff1, v7
  v_cmp_ne_u32 vcc, 0, v7
  s_nop 1
  v_cndmask_b32 v44, 0, v12, vcc
  v_add_u32 v7, 7, v2
  v_and_b32 v7, 0xfffffff1, v7
  v_cmp_ne_u32 vcc, 0, v7
  s_nop 1
  v_cndmask_b32 v45, 0, v12, vcc
  v_add_u32 v7, 6, v2
  v_and_b32 v7, 0xfffffff1, v7
  v_cmp_ne_u32 vcc, 0, v7
  s_nop 1
  v_cndmask_b32 v46, 0, v12, vcc
  v_add_u32 v7, 5, v2
  v_and_b32 v7, 0xfffffff1, v7
  v_cmp_ne_u32 vcc, 0, v7
  s_nop 1
  v_cndmask_b32 v47, 0, v12, vcc
  v_lshrrev_b32 v2, 5, v1
  v_lshlrev_b32 v5, 10, v2
  v_and_b32 v2, 31, v1
  v_lshl_add_u32 v5, v2, 4, v5
  v_lshlrev_b32 v10, 11, v2
  s_lshl_b32 s59, s46, 13
  s_lshl_b32 s51, s54, 9
  s_add_u32 s59, s59, s51
  s_lshl_b32 s63, s46, 12
  v_lshrrev_b32 v2, 5, v1
  v_lshlrev_b32 v6, 11, v2
  v_lshl_add_u32 v10, v2, 3, v10
  v_bfe_u32 v2, v1, 2, 2
  v_lshl_add_u32 v6, v2, 9, v6
  v_bfe_u32 v2, v1, 4, 1
  v_lshl_add_u32 v6, v2, 5, v6
  v_and_b32 v2, 3, v1
  v_lshl_add_u32 v6, v2, 3, v6
  s_lshl_b32 s51, s46, 7
  v_add_u32 v6, s51, v6
  s_lshl_b32 s51, s46, 13
  v_add_u32 v11, s51, v3
  s_waitcnt vmcnt(0)
  s_barrier
  s_add_u32 m0, s63, 0
  s_add_u32 s51, s59, 0
  buffer_load_dwordx4 v5, s[64:67], s51 offen lds
  s_add_u32 m0, s63, 1024
  s_add_u32 s51, s59, 2048
  buffer_load_dwordx4 v5, s[64:67], s51 offen lds
  s_add_u32 m0, s63, 2048
  s_add_u32 s51, s59, 4096
  buffer_load_dwordx4 v5, s[64:67], s51 offen lds
  s_add_u32 m0, s63, 3072
  s_add_u32 s51, s59, 6144
  buffer_load_dwordx4 v5, s[64:67], s51 offen lds
  s_add_u32 m0, s63, 16384
  s_add_u32 s51, s59, 32768
  buffer_load_dwordx4 v5, s[64:67], s51 offen lds
  s_add_u32 m0, s63, 17408
  s_add_u32 s51, s59, 34816
  buffer_load_dwordx4 v5, s[64:67], s51 offen lds
  s_add_u32 m0, s63, 18432
  s_add_u32 s51, s59, 36864
  buffer_load_dwordx4 v5, s[64:67], s51 offen lds
  s_add_u32 m0, s63, 19456
  s_add_u32 s51, s59, 38912
  buffer_load_dwordx4 v5, s[64:67], s51 offen lds
  s_add_u32 m0, s63, 32768
  s_add_u32 s51, s59, 65536
  buffer_load_dwordx4 v5, s[64:67], s51 offen lds
  s_add_u32 m0, s63, 33792
  s_add_u32 s51, s59, 67584
  buffer_load_dwordx4 v5, s[64:67], s51 offen lds
  s_add_u32 m0, s63, 34816
  s_add_u32 s51, s59, 69632
  buffer_load_dwordx4 v5, s[64:67], s51 offen lds
  s_add_u32 m0, s63, 35840
  s_add_u32 s51, s59, 71680
  buffer_load_dwordx4 v5, s[64:67], s51 offen lds
  s_add_u32 m0, s63, 49152
  s_add_u32 s51, s59, 98304
  buffer_load_dwordx4 v5, s[64:67], s51 offen lds
  s_add_u32 m0, s63, 50176
  s_add_u32 s51, s59, 100352
  buffer_load_dwordx4 v5, s[64:67], s51 offen lds
  s_add_u32 m0, s63, 51200
  s_add_u32 s51, s59, 102400
  buffer_load_dwordx4 v5, s[64:67], s51 offen lds
  s_add_u32 m0, s63, 52224
  s_add_u32 s51, s59, 104448
  buffer_load_dwordx4 v5, s[64:67], s51 offen lds
  s_add_u32 m0, s63, 65536
  s_add_u32 s51, s59, 131072
  buffer_load_dwordx4 v5, s[64:67], s51 offen lds
  s_add_u32 m0, s63, 66560
  s_add_u32 s51, s59, 133120
  buffer_load_dwordx4 v5, s[64:67], s51 offen lds
  s_add_u32 m0, s63, 67584
  s_add_u32 s51, s59, 135168
  buffer_load_dwordx4 v5, s[64:67], s51 offen lds
  s_add_u32 m0, s63, 68608
  s_add_u32 s51, s59, 137216
  buffer_load_dwordx4 v5, s[64:67], s51 offen lds
  s_add_u32 m0, s63, 81920
  s_add_u32 s51, s59, 163840
  buffer_load_dwordx4 v5, s[64:67], s51 offen lds
  s_add_u32 m0, s63, 82944
  s_add_u32 s51, s59, 165888
  buffer_load_dwordx4 v5, s[64:67], s51 offen lds
  s_add_u32 m0, s63, 83968
  s_add_u32 s51, s59, 167936
  buffer_load_dwordx4 v5, s[64:67], s51 offen lds
  s_add_u32 m0, s63, 84992
  s_add_u32 s51, s59, 169984
  buffer_load_dwordx4 v5, s[64:67], s51 offen lds
  s_add_u32 m0, s63, 98304
  s_add_u32 s51, s59, 196608
  buffer_load_dwordx4 v5, s[64:67], s51 offen lds
  s_add_u32 m0, s63, 99328
  s_add_u32 s51, s59, 198656
  buffer_load_dwordx4 v5, s[64:67], s51 offen lds
  s_add_u32 m0, s63, 100352
  s_add_u32 s51, s59, 200704
  buffer_load_dwordx4 v5, s[64:67], s51 offen lds
  s_add_u32 m0, s63, 101376
  s_add_u32 s51, s59, 202752
  buffer_load_dwordx4 v5, s[64:67], s51 offen lds
  s_waitcnt vmcnt(24)
  s_barrier
  s_add_u32 m0, s63, 114688
  s_add_u32 s51, s59, 229376
  buffer_load_dwordx4 v5, s[64:67], s51 offen lds
  s_add_u32 m0, s63, 115712
  s_add_u32 s51, s59, 231424
  buffer_load_dwordx4 v5, s[64:67], s51 offen lds
  s_add_u32 m0, s63, 116736
  s_add_u32 s51, s59, 233472
  buffer_load_dwordx4 v5, s[64:67], s51 offen lds
  s_add_u32 m0, s63, 117760
  s_add_u32 s51, s59, 235520
  buffer_load_dwordx4 v5, s[64:67], s51 offen lds
  v_add_u32 v7, 0, v6
  ds_read_b64_tr_b16 a[0:1], v7 offset:0
  ds_read_b64_tr_b16 a[2:3], v7 offset:4096
  ds_read_b64_tr_b16 a[4:5], v7 offset:64
  ds_read_b64_tr_b16 a[6:7], v7 offset:4160
  ds_read_b64_tr_b16 a[8:9], v7 offset:8192
  ds_read_b64_tr_b16 a[10:11], v7 offset:12288
  ds_read_b64_tr_b16 a[12:13], v7 offset:8256
  ds_read_b64_tr_b16 a[14:15], v7 offset:12352
  s_waitcnt vmcnt(24) lgkmcnt(0)
  s_barrier
  s_add_u32 m0, s63, 0
  s_add_u32 s51, s59, 262144
  buffer_load_dwordx4 v5, s[64:67], s51 offen lds
  s_add_u32 m0, s63, 1024
  s_add_u32 s51, s59, 264192
  buffer_load_dwordx4 v5, s[64:67], s51 offen lds
  s_add_u32 m0, s63, 2048
  s_add_u32 s51, s59, 266240
  buffer_load_dwordx4 v5, s[64:67], s51 offen lds
  s_add_u32 m0, s63, 3072
  s_add_u32 s51, s59, 268288
  buffer_load_dwordx4 v5, s[64:67], s51 offen lds
  v_add_u32 v7, 16384, v6
  ds_read_b64_tr_b16 a[16:17], v7 offset:0
  ds_read_b64_tr_b16 a[18:19], v7 offset:4096
  ds_read_b64_tr_b16 a[20:21], v7 offset:64
  ds_read_b64_tr_b16 a[22:23], v7 offset:4160
  ds_read_b64_tr_b16 a[24:25], v7 offset:8192
  ds_read_b64_tr_b16 a[26:27], v7 offset:12288
  ds_read_b64_tr_b16 a[28:29], v7 offset:8256
  ds_read_b64_tr_b16 a[30:31], v7 offset:12352
  s_waitcnt vmcnt(24) lgkmcnt(0)
  s_barrier
  s_add_u32 m0, s63, 16384
  s_add_u32 s51, s59, 294912
  buffer_load_dwordx4 v5, s[64:67], s51 offen lds
  s_add_u32 m0, s63, 17408
  s_add_u32 s51, s59, 296960
  buffer_load_dwordx4 v5, s[64:67], s51 offen lds
  s_add_u32 m0, s63, 18432
  s_add_u32 s51, s59, 299008
  buffer_load_dwordx4 v5, s[64:67], s51 offen lds
  s_add_u32 m0, s63, 19456
  s_add_u32 s51, s59, 301056
  buffer_load_dwordx4 v5, s[64:67], s51 offen lds
  v_add_u32 v7, 32768, v6
  ds_read_b64_tr_b16 a[32:33], v7 offset:0
  ds_read_b64_tr_b16 a[34:35], v7 offset:4096
  ds_read_b64_tr_b16 a[36:37], v7 offset:64
  ds_read_b64_tr_b16 a[38:39], v7 offset:4160
  ds_read_b64_tr_b16 a[40:41], v7 offset:8192
  ds_read_b64_tr_b16 a[42:43], v7 offset:12288
  ds_read_b64_tr_b16 a[44:45], v7 offset:8256
  ds_read_b64_tr_b16 a[46:47], v7 offset:12352
  s_waitcnt vmcnt(24) lgkmcnt(0)
  s_barrier
  s_add_u32 m0, s63, 32768
  s_add_u32 s51, s59, 327680
  buffer_load_dwordx4 v5, s[64:67], s51 offen lds
  s_add_u32 m0, s63, 33792
  s_add_u32 s51, s59, 329728
  buffer_load_dwordx4 v5, s[64:67], s51 offen lds
  s_add_u32 m0, s63, 34816
  s_add_u32 s51, s59, 331776
  buffer_load_dwordx4 v5, s[64:67], s51 offen lds
  s_add_u32 m0, s63, 35840
  s_add_u32 s51, s59, 333824
  buffer_load_dwordx4 v5, s[64:67], s51 offen lds
  v_add_u32 v7, 49152, v6
  ds_read_b64_tr_b16 a[48:49], v7 offset:0
  ds_read_b64_tr_b16 a[50:51], v7 offset:4096
  ds_read_b64_tr_b16 a[52:53], v7 offset:64
  ds_read_b64_tr_b16 a[54:55], v7 offset:4160
  ds_read_b64_tr_b16 a[56:57], v7 offset:8192
  ds_read_b64_tr_b16 a[58:59], v7 offset:12288
  ds_read_b64_tr_b16 a[60:61], v7 offset:8256
  ds_read_b64_tr_b16 a[62:63], v7 offset:12352
  s_waitcnt vmcnt(24) lgkmcnt(0)
  s_barrier
  s_add_u32 m0, s63, 49152
  s_add_u32 s51, s59, 360448
  buffer_load_dwordx4 v5, s[64:67], s51 offen lds
  s_add_u32 m0, s63, 50176
  s_add_u32 s51, s59, 362496
  buffer_load_dwordx4 v5, s[64:67], s51 offen lds
  s_add_u32 m0, s63, 51200
  s_add_u32 s51, s59, 364544
  buffer_load_dwordx4 v5, s[64:67], s51 offen lds
  s_add_u32 m0, s63, 52224
  s_add_u32 s51, s59, 366592
  buffer_load_dwordx4 v5, s[64:67], s51 offen lds
  v_add_u32 v7, 65536, v6
  ds_read_b64_tr_b16 a[64:65], v7 offset:0
  ds_read_b64_tr_b16 a[66:67], v7 offset:4096
  ds_read_b64_tr_b16 a[68:69], v7 offset:64
  ds_read_b64_tr_b16 a[70:71], v7 offset:4160
  ds_read_b64_tr_b16 a[72:73], v7 offset:8192
  ds_read_b64_tr_b16 a[74:75], v7 offset:12288
  ds_read_b64_tr_b16 a[76:77], v7 offset:8256
  ds_read_b64_tr_b16 a[78:79], v7 offset:12352
  s_waitcnt vmcnt(24) lgkmcnt(0)
  s_barrier
  s_add_u32 m0, s63, 65536
  s_add_u32 s51, s59, 393216
  buffer_load_dwordx4 v5, s[64:67], s51 offen lds
  s_add_u32 m0, s63, 66560
  s_add_u32 s51, s59, 395264
  buffer_load_dwordx4 v5, s[64:67], s51 offen lds
  s_add_u32 m0, s63, 67584
  s_add_u32 s51, s59, 397312
  buffer_load_dwordx4 v5, s[64:67], s51 offen lds
  s_add_u32 m0, s63, 68608
  s_add_u32 s51, s59, 399360
  buffer_load_dwordx4 v5, s[64:67], s51 offen lds
  v_add_u32 v7, 81920, v6
  ds_read_b64_tr_b16 a[80:81], v7 offset:0
  ds_read_b64_tr_b16 a[82:83], v7 offset:4096
  ds_read_b64_tr_b16 a[84:85], v7 offset:64
  ds_read_b64_tr_b16 a[86:87], v7 offset:4160
  ds_read_b64_tr_b16 a[88:89], v7 offset:8192
  ds_read_b64_tr_b16 a[90:91], v7 offset:12288
  ds_read_b64_tr_b16 a[92:93], v7 offset:8256
  ds_read_b64_tr_b16 a[94:95], v7 offset:12352
  s_waitcnt vmcnt(24) lgkmcnt(0)
  s_barrier
  s_add_u32 m0, s63, 81920
  s_add_u32 s51, s59, 425984
  buffer_load_dwordx4 v5, s[64:67], s51 offen lds
  s_add_u32 m0, s63, 82944
  s_add_u32 s51, s59, 428032
  buffer_load_dwordx4 v5, s[64:67], s51 offen lds
  s_add_u32 m0, s63, 83968
  s_add_u32 s51, s59, 430080
  buffer_load_dwordx4 v5, s[64:67], s51 offen lds
  s_add_u32 m0, s63, 84992
  s_add_u32 s51, s59, 432128
  buffer_load_dwordx4 v5, s[64:67], s51 offen lds
  v_add_u32 v7, 98304, v6
  ds_read_b64_tr_b16 a[96:97], v7 offset:0
  ds_read_b64_tr_b16 a[98:99], v7 offset:4096
  ds_read_b64_tr_b16 a[100:101], v7 offset:64
  ds_read_b64_tr_b16 a[102:103], v7 offset:4160
  ds_read_b64_tr_b16 a[104:105], v7 offset:8192
  ds_read_b64_tr_b16 a[106:107], v7 offset:12288
  ds_read_b64_tr_b16 a[108:109], v7 offset:8256
  ds_read_b64_tr_b16 a[110:111], v7 offset:12352
  s_waitcnt vmcnt(24) lgkmcnt(0)
  s_barrier
  s_add_u32 m0, s63, 98304
  s_add_u32 s51, s59, 458752
  buffer_load_dwordx4 v5, s[64:67], s51 offen lds
  s_add_u32 m0, s63, 99328
  s_add_u32 s51, s59, 460800
  buffer_load_dwordx4 v5, s[64:67], s51 offen lds
  s_add_u32 m0, s63, 100352
  s_add_u32 s51, s59, 462848
  buffer_load_dwordx4 v5, s[64:67], s51 offen lds
  s_add_u32 m0, s63, 101376
  s_add_u32 s51, s59, 464896
  buffer_load_dwordx4 v5, s[64:67], s51 offen lds
  v_add_u32 v7, 114688, v6
  ds_read_b64_tr_b16 a[112:113], v7 offset:0
  ds_read_b64_tr_b16 a[114:115], v7 offset:4096
  ds_read_b64_tr_b16 a[116:117], v7 offset:64
  ds_read_b64_tr_b16 a[118:119], v7 offset:4160
  ds_read_b64_tr_b16 a[120:121], v7 offset:8192
  ds_read_b64_tr_b16 a[122:123], v7 offset:12288
  ds_read_b64_tr_b16 a[124:125], v7 offset:8256
  ds_read_b64_tr_b16 a[126:127], v7 offset:12352
  s_waitcnt vmcnt(24) lgkmcnt(0)
  s_barrier
  s_add_u32 m0, s63, 114688
  s_add_u32 s51, s59, 491520
  buffer_load_dwordx4 v5, s[64:67], s51 offen lds
  s_add_u32 m0, s63, 115712
  s_add_u32 s51, s59, 493568
  buffer_load_dwordx4 v5, s[64:67], s51 offen lds
  s_add_u32 m0, s63, 116736
  s_add_u32 s51, s59, 495616
  buffer_load_dwordx4 v5, s[64:67], s51 offen lds
  s_add_u32 m0, s63, 117760
  s_add_u32 s51, s59, 497664
  buffer_load_dwordx4 v5, s[64:67], s51 offen lds
  v_add_u32 v7, 0, v6
  ds_read_b64_tr_b16 a[128:129], v7 offset:0
  ds_read_b64_tr_b16 a[130:131], v7 offset:4096
  ds_read_b64_tr_b16 a[132:133], v7 offset:64
  ds_read_b64_tr_b16 a[134:135], v7 offset:4160
  ds_read_b64_tr_b16 a[136:137], v7 offset:8192
  ds_read_b64_tr_b16 a[138:139], v7 offset:12288
  ds_read_b64_tr_b16 a[140:141], v7 offset:8256
  ds_read_b64_tr_b16 a[142:143], v7 offset:12352
  s_waitcnt vmcnt(24) lgkmcnt(0)
  s_barrier
  v_add_u32 v7, 16384, v6
  ds_read_b64_tr_b16 a[144:145], v7 offset:0
  ds_read_b64_tr_b16 a[146:147], v7 offset:4096
  ds_read_b64_tr_b16 a[148:149], v7 offset:64
  ds_read_b64_tr_b16 a[150:151], v7 offset:4160
  ds_read_b64_tr_b16 a[152:153], v7 offset:8192
  ds_read_b64_tr_b16 a[154:155], v7 offset:12288
  ds_read_b64_tr_b16 a[156:157], v7 offset:8256
  ds_read_b64_tr_b16 a[158:159], v7 offset:12352
  s_waitcnt vmcnt(20) lgkmcnt(0)
  s_barrier
  v_add_u32 v7, 32768, v6
  ds_read_b64_tr_b16 a[160:161], v7 offset:0
  ds_read_b64_tr_b16 a[162:163], v7 offset:4096
  ds_read_b64_tr_b16 a[164:165], v7 offset:64
  ds_read_b64_tr_b16 a[166:167], v7 offset:4160
  ds_read_b64_tr_b16 a[168:169], v7 offset:8192
  ds_read_b64_tr_b16 a[170:171], v7 offset:12288
  ds_read_b64_tr_b16 a[172:173], v7 offset:8256
  ds_read_b64_tr_b16 a[174:175], v7 offset:12352
  s_waitcnt vmcnt(16) lgkmcnt(0)
  s_barrier
  v_add_u32 v7, 49152, v6
  ds_read_b64_tr_b16 a[176:177], v7 offset:0
  ds_read_b64_tr_b16 a[178:179], v7 offset:4096
  ds_read_b64_tr_b16 a[180:181], v7 offset:64
  ds_read_b64_tr_b16 a[182:183], v7 offset:4160
  ds_read_b64_tr_b16 a[184:185], v7 offset:8192
  ds_read_b64_tr_b16 a[186:187], v7 offset:12288
  ds_read_b64_tr_b16 a[188:189], v7 offset:8256
  ds_read_b64_tr_b16 a[190:191], v7 offset:12352
  s_waitcnt vmcnt(12) lgkmcnt(0)
  s_barrier
  v_add_u32 v7, 65536, v6
  ds_read_b64_tr_b16 a[192:193], v7 offset:0
  ds_read_b64_tr_b16 a[194:195], v7 offset:4096
  ds_read_b64_tr_b16 a[196:197], v7 offset:64
  ds_read_b64_tr_b16 a[198:199], v7 offset:4160
  ds_read_b64_tr_b16 a[200:201], v7 offset:8192
  ds_read_b64_tr_b16 a[202:203], v7 offset:12288
  ds_read_b64_tr_b16 a[204:205], v7 offset:8256
  ds_read_b64_tr_b16 a[206:207], v7 offset:12352
  s_waitcnt vmcnt(8) lgkmcnt(0)
  s_barrier
  v_add_u32 v7, 81920, v6
  ds_read_b64_tr_b16 a[208:209], v7 offset:0
  ds_read_b64_tr_b16 a[210:211], v7 offset:4096
  ds_read_b64_tr_b16 a[212:213], v7 offset:64
  ds_read_b64_tr_b16 a[214:215], v7 offset:4160
  ds_read_b64_tr_b16 a[216:217], v7 offset:8192
  ds_read_b64_tr_b16 a[218:219], v7 offset:12288
  ds_read_b64_tr_b16 a[220:221], v7 offset:8256
  ds_read_b64_tr_b16 a[222:223], v7 offset:12352
  s_waitcnt vmcnt(4) lgkmcnt(0)
  s_barrier
  v_add_u32 v7, 98304, v6
  ds_read_b64_tr_b16 a[224:225], v7 offset:0
  ds_read_b64_tr_b16 a[226:227], v7 offset:4096
  ds_read_b64_tr_b16 a[228:229], v7 offset:64
  ds_read_b64_tr_b16 a[230:231], v7 offset:4160
  ds_read_b64_tr_b16 a[232:233], v7 offset:8192
  ds_read_b64_tr_b16 a[234:235], v7 offset:12288
  ds_read_b64_tr_b16 a[236:237], v7 offset:8256
  ds_read_b64_tr_b16 a[238:239], v7 offset:12352
  s_waitcnt vmcnt(0) lgkmcnt(0)
  s_barrier
  v_add_u32 v7, 114688, v6
  ds_read_b64_tr_b16 a[240:241], v7 offset:0
  ds_read_b64_tr_b16 a[242:243], v7 offset:4096
  ds_read_b64_tr_b16 a[244:245], v7 offset:64
  ds_read_b64_tr_b16 a[246:247], v7 offset:4160
  ds_read_b64_tr_b16 a[248:249], v7 offset:8192
  ds_read_b64_tr_b16 a[250:251], v7 offset:12288
  ds_read_b64_tr_b16 a[252:253], v7 offset:8256
  ds_read_b64_tr_b16 a[254:255], v7 offset:12352
  s_waitcnt lgkmcnt(0)
L_pa_loop:
  s_add_u32 s51, s46, 32
  s_lshl_b32 s51, s51, 6
  s_add_u32 s51, s51, s53
  s_mul_i32 s55, s51, 24576
  s_lshl_b32 s57, s51, 2
  s_add_u32 s57, s57, 84475904
  s_cmp_eq_u32 s53, 0
  s_cselect_b32 s51, 0, 24576
  s_cselect_b32 s52, 0, 4
  s_cselect_b64 vcc, -1, 0
  s_sub_u32 s56, s55, s51
  s_sub_u32 s62, s57, s52
  v_cndmask_b32 v32, v40, v12, vcc
  v_cndmask_b32 v33, v41, v12, vcc
  v_cndmask_b32 v34, v42, v12, vcc
  v_cndmask_b32 v35, v43, v12, vcc
  v_cndmask_b32 v36, v44, v12, vcc
  v_cndmask_b32 v37, v45, v12, vcc
  v_cndmask_b32 v38, v46, v12, vcc
  v_cndmask_b32 v39, v47, v12, vcc
L_pg_pa1:
  buffer_load_dword v7, off, s[4:7], s57  sc1
  s_sub_u32 s49, s49, 1
  s_cbranch_scc1 L_end
  s_waitcnt vmcnt(0)
  v_cmp_gt_u32 vcc, 2, v7
  s_nop 0
  s_and_b32 vcc_lo, vcc_lo, 1
  s_cbranch_scc0 L_pk_pa1
  s_sleep 4
  s_branch L_pg_pa1
L_pk_pa1:
L_pg_pa2:
  buffer_load_dword v7, off, s[4:7], s62  sc1
  s_sub_u32 s49, s49, 1
  s_cbranch_scc1 L_end
  s_waitcnt vmcnt(0)
  v_cmp_gt_u32 vcc, 2, v7
  s_nop 0
  s_and_b32 vcc_lo, vcc_lo, 1
  s_cbranch_scc0 L_pk_pa2
  s_sleep 4
  s_branch L_pg_pa2
L_pk_pa2:
  s_add_u32 s51, s55, 0
  s_add_u32 s52, s55, 4096
  buffer_load_dwordx4 v[128:131], v3, s[4:7], s51 offen offset:0 sc1
  buffer_load_dwordx4 v[132:135], v3, s[4:7], s51 offen offset:1024 sc1
  buffer_load_dwordx4 v[136:139], v3, s[4:7], s51 offen offset:2048 sc1
  buffer_load_dwordx4 v[140:143], v3, s[4:7], s51 offen offset:3072 sc1
  buffer_load_dwordx4 v[144:147], v3, s[4:7], s52 offen offset:0 sc1
  buffer_load_dwordx4 v[148:151], v3, s[4:7], s52 offen offset:1024 sc1
  buffer_load_dwordx4 v[152:155], v3, s[4:7], s52 offen offset:2048 sc1
  buffer_load_dwordx4 v[156:159], v3, s[4:7], s52 offen offset:3072 sc1
  s_add_u32 s51, s55, 8192
  s_add_u32 s52, s55, 12288
  buffer_load_dwordx4 v[160:163], v4, s[4:7], s51 offen offset:0 sc1
  buffer_load_dwordx4 v[164:167], v4, s[4:7], s51 offen offset:1024 sc1
  buffer_load_dwordx4 v[168:171], v4, s[4:7], s51 offen offset:2048 sc1
  buffer_load_dwordx4 v[172:175], v4, s[4:7], s51 offen offset:3072 sc1
  buffer_load_dwordx4 v[176:179], v4, s[4:7], s52 offen offset:0 sc1
  buffer_load_dwordx4 v[180:183], v4, s[4:7], s52 offen offset:1024 sc1
  buffer_load_dwordx4 v[184:187], v4, s[4:7], s52 offen offset:2048 sc1
  buffer_load_dwordx4 v[188:191], v4, s[4:7], s52 offen offset:3072 sc1
  s_add_u32 s51, s56, 8192
  s_add_u32 s52, s56, 12288
  buffer_load_dwordx4 v[192:195], v4, s[4:7], s51 offen offset:0 sc1
  buffer_load_dwordx4 v[196:199], v4, s[4:7], s51 offen offset:1024 sc1
  buffer_load_dwordx4 v[200:203], v4, s[4:7], s51 offen offset:2048 sc1
  buffer_load_dwordx4 v[204:207], v4, s[4:7], s51 offen offset:3072 sc1
  buffer_load_dwordx4 v[208:211], v4, s[4:7], s52 offen offset:0 sc1
  buffer_load_dwordx4 v[212:215], v4, s[4:7], s52 offen offset:1024 sc1
  buffer_load_dwordx4 v[216:219], v4, s[4:7], s52 offen offset:2048 sc1
  buffer_load_dwordx4 v[220:223], v4, s[4:7], s52 offen offset:3072 sc1
  s_add_u32 s51, s55, 16384
  s_add_u32 s52, s55, 20480
  buffer_load_dwordx4 v[224:227], v3, s[4:7], s51 offen offset:0 sc1
  buffer_load_dwordx4 v[228:231], v3, s[4:7], s51 offen offset:1024 sc1
  buffer_load_dwordx4 v[232:235], v3, s[4:7], s51 offen offset:2048 sc1
  buffer_load_dwordx4 v[236:239], v3, s[4:7], s51 offen offset:3072 sc1
  buffer_load_dwordx4 v[240:243], v3, s[4:7], s52 offen offset:0 sc1
  buffer_load_dwordx4 v[244:247], v3, s[4:7], s52 offen offset:1024 sc1
  buffer_load_dwordx4 v[248:251], v3, s[4:7], s52 offen offset:2048 sc1
  buffer_load_dwordx4 v[252:255], v3, s[4:7], s52 offen offset:3072 sc1
  s_add_u32 s51, s56, 17408
  s_add_u32 s52, s56, 21504
  buffer_load_dwordx4 v[48:51], v3, s[4:7], s51 offen offset:0 sc1
  buffer_load_dwordx4 v[52:55], v3, s[4:7], s51 offen offset:2048 sc1
  buffer_load_dwordx4 v[56:59], v3, s[4:7], s52 offen offset:0 sc1
  buffer_load_dwordx4 v[60:63], v3, s[4:7], s52 offen offset:2048 sc1
  s_barrier
  s_waitcnt vmcnt(27)
  v_mfma_f32_32x32x16_bf16 v[64:79], v[160:163], v[128:131], v[16:31]
  s_waitcnt vmcnt(19)
  v_mfma_f32_32x32x16_bf16 v[80:95], v[192:195], v[128:131], v[24:39]
  s_nop 9
  v_max3_f32 v8, v64, v65, v66
  v_max3_f32 v8, v8, v67, v68
  v_max3_f32 v8, v8, v69, v70
  v_max3_f32 v8, v8, v71, v72
  v_max3_f32 v8, v8, v73, v74
  v_max3_f32 v8, v8, v75, v76
  v_max3_f32 v8, v8, v77, v78
  v_max3_f32 v8, v8, v79, v88
  v_max3_f32 v8, v8, v89, v90
  v_max3_f32 v8, v8, v91, v92
  v_max3_f32 v8, v8, v93, v94
  v_max_f32 v8, v8, v95
  v_mov_b32 v9, v8
  s_nop 1
  v_permlane32_swap_b32 v8, v9
  v_max_f32 v8, v8, v9
  v_mul_f32 v8, s58, v8
  v_fma_f32 v64, v64, s58, -v8
  v_fma_f32 v65, v65, s58, -v8
  v_fma_f32 v66, v66, s58, -v8
  v_fma_f32 v67, v67, s58, -v8
  v_fma_f32 v68, v68, s58, -v8
  v_fma_f32 v69, v69, s58, -v8
  v_fma_f32 v70, v70, s58, -v8
  v_fma_f32 v71, v71, s58, -v8
  v_fma_f32 v72, v72, s58, -v8
  v_fma_f32 v73, v73, s58, -v8
  v_fma_f32 v74, v74, s58, -v8
  v_fma_f32 v75, v75, s58, -v8
  v_fma_f32 v76, v76, s58, -v8
  v_fma_f32 v77, v77, s58, -v8
  v_fma_f32 v78, v78, s58, -v8
  v_fma_f32 v79, v79, s58, -v8
  v_fma_f32 v88, v88, s58, -v8
  v_fma_f32 v89, v89, s58, -v8
  v_fma_f32 v90, v90, s58, -v8
  v_fma_f32 v91, v91, s58, -v8
  v_fma_f32 v92, v92, s58, -v8
  v_fma_f32 v93, v93, s58, -v8
  v_fma_f32 v94, v94, s58, -v8
  v_fma_f32 v95, v95, s58, -v8
  v_exp_f32 v64, v64
  v_exp_f32 v65, v65
  v_exp_f32 v66, v66
  v_exp_f32 v67, v67
  v_exp_f32 v68, v68
  v_exp_f32 v69, v69
  v_exp_f32 v70, v70
  v_exp_f32 v71, v71
  v_exp_f32 v72, v72
  v_exp_f32 v73, v73
  v_exp_f32 v74, v74
  v_exp_f32 v75, v75
  v_exp_f32 v76, v76
  v_exp_f32 v77, v77
  v_exp_f32 v78, v78
  v_exp_f32 v79, v79
  v_exp_f32 v88, v88
  v_exp_f32 v89, v89
  v_exp_f32 v90, v90
  v_exp_f32 v91, v91
  v_exp_f32 v92, v92
  v_exp_f32 v93, v93
  v_exp_f32 v94, v94
  v_exp_f32 v95, v95
  v_add_f32 v8, v64, v65
  v_add_f32 v9, v66, v67
  v_add_f32 v8, v8, v68
  v_add_f32 v9, v9, v69
  v_add_f32 v8, v8, v70
  v_add_f32 v9, v9, v71
  v_add_f32 v8, v8, v72
  v_add_f32 v9, v9, v73
  v_add_f32 v8, v8, v74
  v_add_f32 v9, v9, v75
  v_add_f32 v8, v8, v76
  v_add_f32 v9, v9, v77
  v_add_f32 v8, v8, v78
  v_add_f32 v9, v9, v79
  v_add_f32 v8, v8, v88
  v_add_f32 v9, v9, v89
  v_add_f32 v8, v8, v90
  v_add_f32 v9, v9, v91
  v_add_f32 v8, v8, v92
  v_add_f32 v9, v9, v93
  v_add_f32 v8, v8, v94
  v_add_f32 v9, v9, v95
  v_add_f32 v8, v8, v9
  v_mov_b32 v9, v8
  s_nop 1
  v_permlane32_swap_b32 v8, v9
  v_add_f32 v8, v8, v9
  v_rcp_f32 v8, v8
  v_cvt_pk_bf16_f32 v112, v64, v65
  v_cvt_pk_bf16_f32 v113, v66, v67
  v_cvt_pk_bf16_f32 v114, v68, v69
  v_cvt_pk_bf16_f32 v115, v70, v71
  v_cvt_pk_bf16_f32 v116, v72, v73
  v_cvt_pk_bf16_f32 v117, v74, v75
  v_cvt_pk_bf16_f32 v118, v76, v77
  v_cvt_pk_bf16_f32 v119, v78, v79
  v_cvt_pk_bf16_f32 v120, v88, v89
  v_cvt_pk_bf16_f32 v121, v90, v91
  v_cvt_pk_bf16_f32 v122, v92, v93
  v_cvt_pk_bf16_f32 v123, v94, v95
  s_waitcnt vmcnt(11)
  v_mfma_f32_32x32x16_bf16 v[96:111], v[224:227], v[112:115], 0
  s_waitcnt vmcnt(10)
  v_mfma_f32_32x32x16_bf16 v[96:111], v[228:231], v[116:119], v[96:111]
  s_waitcnt vmcnt(3)
  v_mfma_f32_32x32x16_bf16 v[96:111], v[48:51], v[120:123], v[96:111]
  s_nop 11
  v_mul_f32 v96, v96, v8
  v_mul_f32 v97, v97, v8
  v_mul_f32 v98, v98, v8
  v_mul_f32 v99, v99, v8
  v_mul_f32 v100, v100, v8
  v_mul_f32 v101, v101, v8
  v_mul_f32 v102, v102, v8
  v_mul_f32 v103, v103, v8
  v_cvt_pk_bf16_f32 v124, v96, v97
  v_cvt_pk_bf16_f32 v125, v98, v99
  v_cvt_pk_bf16_f32 v126, v100, v101
  v_cvt_pk_bf16_f32 v127, v102, v103
  ds_write_b128 v11, v[124:127] offset:0
  v_mfma_f32_32x32x16_bf16 v[64:79], v[164:167], v[132:135], v[16:31]
  v_mfma_f32_32x32x16_bf16 v[80:95], v[196:199], v[132:135], v[24:39]
  s_nop 10
  v_max3_f32 v8, v64, v65, v66
  v_max3_f32 v8, v8, v67, v68
  v_max3_f32 v8, v8, v69, v70
  v_max3_f32 v8, v8, v71, v72
  v_max3_f32 v8, v8, v73, v74
  v_max3_f32 v8, v8, v75, v76
  v_max3_f32 v8, v8, v77, v78
  v_max3_f32 v8, v8, v79, v88
  v_max3_f32 v8, v8, v89, v90
  v_max3_f32 v8, v8, v91, v92
  v_max3_f32 v8, v8, v93, v94
  v_max_f32 v8, v8, v95
  v_mov_b32 v9, v8
  s_nop 1
  v_permlane32_swap_b32 v8, v9
  v_max_f32 v8, v8, v9
  v_mul_f32 v8, s58, v8
  v_fma_f32 v64, v64, s58, -v8
  v_fma_f32 v65, v65, s58, -v8
  v_fma_f32 v66, v66, s58, -v8
  v_fma_f32 v67, v67, s58, -v8
  v_fma_f32 v68, v68, s58, -v8
  v_fma_f32 v69, v69, s58, -v8
  v_fma_f32 v70, v70, s58, -v8
  v_fma_f32 v71, v71, s58, -v8
  v_fma_f32 v72, v72, s58, -v8
  v_fma_f32 v73, v73, s58, -v8
  v_fma_f32 v74, v74, s58, -v8
  v_fma_f32 v75, v75, s58, -v8
  v_fma_f32 v76, v76, s58, -v8
  v_fma_f32 v77, v77, s58, -v8
  v_fma_f32 v78, v78, s58, -v8
  v_fma_f32 v79, v79, s58, -v8
  v_fma_f32 v88, v88, s58, -v8
  v_fma_f32 v89, v89, s58, -v8
  v_fma_f32 v90, v90, s58, -v8
  v_fma_f32 v91, v91, s58, -v8
  v_fma_f32 v92, v92, s58, -v8
  v_fma_f32 v93, v93, s58, -v8
  v_fma_f32 v94, v94, s58, -v8
  v_fma_f32 v95, v95, s58, -v8
  v_exp_f32 v64, v64
  v_exp_f32 v65, v65
  v_exp_f32 v66, v66
  v_exp_f32 v67, v67
  v_exp_f32 v68, v68
  v_exp_f32 v69, v69
  v_exp_f32 v70, v70
  v_exp_f32 v71, v71
  v_exp_f32 v72, v72
  v_exp_f32 v73, v73
  v_exp_f32 v74, v74
  v_exp_f32 v75, v75
  v_exp_f32 v76, v76
  v_exp_f32 v77, v77
  v_exp_f32 v78, v78
  v_exp_f32 v79, v79
  v_exp_f32 v88, v88
  v_exp_f32 v89, v89
  v_exp_f32 v90, v90
  v_exp_f32 v91, v91
  v_exp_f32 v92, v92
  v_exp_f32 v93, v93
  v_exp_f32 v94, v94
  v_exp_f32 v95, v95
  v_add_f32 v8, v64, v65
  v_add_f32 v9, v66, v67
  v_add_f32 v8, v8, v68
  v_add_f32 v9, v9, v69
  v_add_f32 v8, v8, v70
  v_add_f32 v9, v9, v71
  v_add_f32 v8, v8, v72
  v_add_f32 v9, v9, v73
  v_add_f32 v8, v8, v74
  v_add_f32 v9, v9, v75
  v_add_f32 v8, v8, v76
  v_add_f32 v9, v9, v77
  v_add_f32 v8, v8, v78
  v_add_f32 v9, v9, v79
  v_add_f32 v8, v8, v88
  v_add_f32 v9, v9, v89
  v_add_f32 v8, v8, v90
  v_add_f32 v9, v9, v91
  v_add_f32 v8, v8, v92
  v_add_f32 v9, v9, v93
  v_add_f32 v8, v8, v94
  v_add_f32 v9, v9, v95
  v_add_f32 v8, v8, v9
  v_mov_b32 v9, v8
  s_nop 1
  v_permlane32_swap_b32 v8, v9
  v_add_f32 v8, v8, v9
  v_rcp_f32 v8, v8
  v_cvt_pk_bf16_f32 v112, v64, v65
  v_cvt_pk_bf16_f32 v113, v66, v67
  v_cvt_pk_bf16_f32 v114, v68, v69
  v_cvt_pk_bf16_f32 v115, v70, v71
  v_cvt_pk_bf16_f32 v116, v72, v73
  v_cvt_pk_bf16_f32 v117, v74, v75
  v_cvt_pk_bf16_f32 v118, v76, v77
  v_cvt_pk_bf16_f32 v119, v78, v79
  v_cvt_pk_bf16_f32 v120, v88, v89
  v_cvt_pk_bf16_f32 v121, v90, v91
  v_cvt_pk_bf16_f32 v122, v92, v93
  v_cvt_pk_bf16_f32 v123, v94, v95
  v_mfma_f32_32x32x16_bf16 v[96:111], v[224:227], v[112:115], 0
  v_mfma_f32_32x32x16_bf16 v[96:111], v[228:231], v[116:119], v[96:111]
  v_mfma_f32_32x32x16_bf16 v[96:111], v[48:51], v[120:123], v[96:111]
  s_nop 11
  v_mul_f32 v104, v104, v8
  v_mul_f32 v105, v105, v8
  v_mul_f32 v106, v106, v8
  v_mul_f32 v107, v107, v8
  v_mul_f32 v108, v108, v8
  v_mul_f32 v109, v109, v8
  v_mul_f32 v110, v110, v8
  v_mul_f32 v111, v111, v8
  v_cvt_pk_bf16_f32 v124, v104, v105
  v_cvt_pk_bf16_f32 v125, v106, v107
  v_cvt_pk_bf16_f32 v126, v108, v109
  v_cvt_pk_bf16_f32 v127, v110, v111
  ds_write_b128 v11, v[124:127] offset:1024
  v_mfma_f32_32x32x16_bf16 v[64:79], v[168:171], v[136:139], v[16:31]
  v_mfma_f32_32x32x16_bf16 v[80:95], v[200:203], v[136:139], v[24:39]
  s_nop 10
  v_max3_f32 v8, v64, v65, v66
  v_max3_f32 v8, v8, v67, v68
  v_max3_f32 v8, v8, v69, v70
  v_max3_f32 v8, v8, v71, v72
  v_max3_f32 v8, v8, v73, v74
  v_max3_f32 v8, v8, v75, v76
  v_max3_f32 v8, v8, v77, v78
  v_max3_f32 v8, v8, v79, v88
  v_max3_f32 v8, v8, v89, v90
  v_max3_f32 v8, v8, v91, v92
  v_max3_f32 v8, v8, v93, v94
  v_max_f32 v8, v8, v95
  v_mov_b32 v9, v8
  s_nop 1
  v_permlane32_swap_b32 v8, v9
  v_max_f32 v8, v8, v9
  v_mul_f32 v8, s58, v8
  v_fma_f32 v64, v64, s58, -v8
  v_fma_f32 v65, v65, s58, -v8
  v_fma_f32 v66, v66, s58, -v8
  v_fma_f32 v67, v67, s58, -v8
  v_fma_f32 v68, v68, s58, -v8
  v_fma_f32 v69, v69, s58, -v8
  v_fma_f32 v70, v70, s58, -v8
  v_fma_f32 v71, v71, s58, -v8
  v_fma_f32 v72, v72, s58, -v8
  v_fma_f32 v73, v73, s58, -v8
  v_fma_f32 v74, v74, s58, -v8
  v_fma_f32 v75, v75, s58, -v8
  v_fma_f32 v76, v76, s58, -v8
  v_fma_f32 v77, v77, s58, -v8
  v_fma_f32 v78, v78, s58, -v8
  v_fma_f32 v79, v79, s58, -v8
  v_fma_f32 v88, v88, s58, -v8
  v_fma_f32 v89, v89, s58, -v8
  v_fma_f32 v90, v90, s58, -v8
  v_fma_f32 v91, v91, s58, -v8
  v_fma_f32 v92, v92, s58, -v8
  v_fma_f32 v93, v93, s58, -v8
  v_fma_f32 v94, v94, s58, -v8
  v_fma_f32 v95, v95, s58, -v8
  v_exp_f32 v64, v64
  v_exp_f32 v65, v65
  v_exp_f32 v66, v66
  v_exp_f32 v67, v67
  v_exp_f32 v68, v68
  v_exp_f32 v69, v69
  v_exp_f32 v70, v70
  v_exp_f32 v71, v71
  v_exp_f32 v72, v72
  v_exp_f32 v73, v73
  v_exp_f32 v74, v74
  v_exp_f32 v75, v75
  v_exp_f32 v76, v76
  v_exp_f32 v77, v77
  v_exp_f32 v78, v78
  v_exp_f32 v79, v79
  v_exp_f32 v88, v88
  v_exp_f32 v89, v89
  v_exp_f32 v90, v90
  v_exp_f32 v91, v91
  v_exp_f32 v92, v92
  v_exp_f32 v93, v93
  v_exp_f32 v94, v94
  v_exp_f32 v95, v95
  v_add_f32 v8, v64, v65
  v_add_f32 v9, v66, v67
  v_add_f32 v8, v8, v68
  v_add_f32 v9, v9, v69
  v_add_f32 v8, v8, v70
  v_add_f32 v9, v9, v71
  v_add_f32 v8, v8, v72
  v_add_f32 v9, v9, v73
  v_add_f32 v8, v8, v74
  v_add_f32 v9, v9, v75
  v_add_f32 v8, v8, v76
  v_add_f32 v9, v9, v77
  v_add_f32 v8, v8, v78
  v_add_f32 v9, v9, v79
  v_add_f32 v8, v8, v88
  v_add_f32 v9, v9, v89
  v_add_f32 v8, v8, v90
  v_add_f32 v9, v9, v91
  v_add_f32 v8, v8, v92
  v_add_f32 v9, v9, v93
  v_add_f32 v8, v8, v94
  v_add_f32 v9, v9, v95
  v_add_f32 v8, v8, v9
  v_mov_b32 v9, v8
  s_nop 1
  v_permlane32_swap_b32 v8, v9
  v_add_f32 v8, v8, v9
  v_rcp_f32 v8, v8
  v_cvt_pk_bf16_f32 v112, v64, v65
  v_cvt_pk_bf16_f32 v113, v66, v67
  v_cvt_pk_bf16_f32 v114, v68, v69
  v_cvt_pk_bf16_f32 v115, v70, v71
  v_cvt_pk_bf16_f32 v116, v72, v73
  v_cvt_pk_bf16_f32 v117, v74, v75
  v_cvt_pk_bf16_f32 v118, v76, v77
  v_cvt_pk_bf16_f32 v119, v78, v79
  v_cvt_pk_bf16_f32 v120, v88, v89
  v_cvt_pk_bf16_f32 v121, v90, v91
  v_cvt_pk_bf16_f32 v122, v92, v93
  v_cvt_pk_bf16_f32 v123, v94, v95
  v_mfma_f32_32x32x16_bf16 v[96:111], v[232:235], v[112:115], 0
  v_mfma_f32_32x32x16_bf16 v[96:111], v[236:239], v[116:119], v[96:111]
  s_waitcnt vmcnt(2)
  v_mfma_f32_32x32x16_bf16 v[96:111], v[52:55], v[120:123], v[96:111]
  s_nop 11
  v_mul_f32 v96, v96, v8
  v_mul_f32 v97, v97, v8
  v_mul_f32 v98, v98, v8
  v_mul_f32 v99, v99, v8
  v_mul_f32 v100, v100, v8
  v_mul_f32 v101, v101, v8
  v_mul_f32 v102, v102, v8
  v_mul_f32 v103, v103, v8
  v_cvt_pk_bf16_f32 v124, v96, v97
  v_cvt_pk_bf16_f32 v125, v98, v99
  v_cvt_pk_bf16_f32 v126, v100, v101
  v_cvt_pk_bf16_f32 v127, v102, v103
  ds_write_b128 v11, v[124:127] offset:2048
  v_mfma_f32_32x32x16_bf16 v[64:79], v[172:175], v[140:143], v[16:31]
  v_mfma_f32_32x32x16_bf16 v[80:95], v[204:207], v[140:143], v[24:39]
  s_nop 10
  v_max3_f32 v8, v64, v65, v66
  v_max3_f32 v8, v8, v67, v68
  v_max3_f32 v8, v8, v69, v70
  v_max3_f32 v8, v8, v71, v72
  v_max3_f32 v8, v8, v73, v74
  v_max3_f32 v8, v8, v75, v76
  v_max3_f32 v8, v8, v77, v78
  v_max3_f32 v8, v8, v79, v88
  v_max3_f32 v8, v8, v89, v90
  v_max3_f32 v8, v8, v91, v92
  v_max3_f32 v8, v8, v93, v94
  v_max_f32 v8, v8, v95
  v_mov_b32 v9, v8
  s_nop 1
  v_permlane32_swap_b32 v8, v9
  v_max_f32 v8, v8, v9
  v_mul_f32 v8, s58, v8
  v_fma_f32 v64, v64, s58, -v8
  v_fma_f32 v65, v65, s58, -v8
  v_fma_f32 v66, v66, s58, -v8
  v_fma_f32 v67, v67, s58, -v8
  v_fma_f32 v68, v68, s58, -v8
  v_fma_f32 v69, v69, s58, -v8
  v_fma_f32 v70, v70, s58, -v8
  v_fma_f32 v71, v71, s58, -v8
  v_fma_f32 v72, v72, s58, -v8
  v_fma_f32 v73, v73, s58, -v8
  v_fma_f32 v74, v74, s58, -v8
  v_fma_f32 v75, v75, s58, -v8
  v_fma_f32 v76, v76, s58, -v8
  v_fma_f32 v77, v77, s58, -v8
  v_fma_f32 v78, v78, s58, -v8
  v_fma_f32 v79, v79, s58, -v8
  v_fma_f32 v88, v88, s58, -v8
  v_fma_f32 v89, v89, s58, -v8
  v_fma_f32 v90, v90, s58, -v8
  v_fma_f32 v91, v91, s58, -v8
  v_fma_f32 v92, v92, s58, -v8
  v_fma_f32 v93, v93, s58, -v8
  v_fma_f32 v94, v94, s58, -v8
  v_fma_f32 v95, v95, s58, -v8
  v_exp_f32 v64, v64
  v_exp_f32 v65, v65
  v_exp_f32 v66, v66
  v_exp_f32 v67, v67
  v_exp_f32 v68, v68
  v_exp_f32 v69, v69
  v_exp_f32 v70, v70
  v_exp_f32 v71, v71
  v_exp_f32 v72, v72
  v_exp_f32 v73, v73
  v_exp_f32 v74, v74
  v_exp_f32 v75, v75
  v_exp_f32 v76, v76
  v_exp_f32 v77, v77
  v_exp_f32 v78, v78
  v_exp_f32 v79, v79
  v_exp_f32 v88, v88
  v_exp_f32 v89, v89
  v_exp_f32 v90, v90
  v_exp_f32 v91, v91
  v_exp_f32 v92, v92
  v_exp_f32 v93, v93
  v_exp_f32 v94, v94
  v_exp_f32 v95, v95
  v_add_f32 v8, v64, v65
  v_add_f32 v9, v66, v67
  v_add_f32 v8, v8, v68
  v_add_f32 v9, v9, v69
  v_add_f32 v8, v8, v70
  v_add_f32 v9, v9, v71
  v_add_f32 v8, v8, v72
  v_add_f32 v9, v9, v73
  v_add_f32 v8, v8, v74
  v_add_f32 v9, v9, v75
  v_add_f32 v8, v8, v76
  v_add_f32 v9, v9, v77
  v_add_f32 v8, v8, v78
  v_add_f32 v9, v9, v79
  v_add_f32 v8, v8, v88
  v_add_f32 v9, v9, v89
  v_add_f32 v8, v8, v90
  v_add_f32 v9, v9, v91
  v_add_f32 v8, v8, v92
  v_add_f32 v9, v9, v93
  v_add_f32 v8, v8, v94
  v_add_f32 v9, v9, v95
  v_add_f32 v8, v8, v9
  v_mov_b32 v9, v8
  s_nop 1
  v_permlane32_swap_b32 v8, v9
  v_add_f32 v8, v8, v9
  v_rcp_f32 v8, v8
  v_cvt_pk_bf16_f32 v112, v64, v65
  v_cvt_pk_bf16_f32 v113, v66, v67
  v_cvt_pk_bf16_f32 v114, v68, v69
  v_cvt_pk_bf16_f32 v115, v70, v71
  v_cvt_pk_bf16_f32 v116, v72, v73
  v_cvt_pk_bf16_f32 v117, v74, v75
  v_cvt_pk_bf16_f32 v118, v76, v77
  v_cvt_pk_bf16_f32 v119, v78, v79
  v_cvt_pk_bf16_f32 v120, v88, v89
  v_cvt_pk_bf16_f32 v121, v90, v91
  v_cvt_pk_bf16_f32 v122, v92, v93
  v_cvt_pk_bf16_f32 v123, v94, v95
  v_mfma_f32_32x32x16_bf16 v[96:111], v[232:235], v[112:115], 0
  v_mfma_f32_32x32x16_bf16 v[96:111], v[236:239], v[116:119], v[96:111]
  v_mfma_f32_32x32x16_bf16 v[96:111], v[52:55], v[120:123], v[96:111]
  s_nop 11
  v_mul_f32 v104, v104, v8
  v_mul_f32 v105, v105, v8
  v_mul_f32 v106, v106, v8
  v_mul_f32 v107, v107, v8
  v_mul_f32 v108, v108, v8
  v_mul_f32 v109, v109, v8
  v_mul_f32 v110, v110, v8
  v_mul_f32 v111, v111, v8
  v_cvt_pk_bf16_f32 v124, v104, v105
  v_cvt_pk_bf16_f32 v125, v106, v107
  v_cvt_pk_bf16_f32 v126, v108, v109
  v_cvt_pk_bf16_f32 v127, v110, v111
  ds_write_b128 v11, v[124:127] offset:3072
  v_mfma_f32_32x32x16_bf16 v[64:79], v[176:179], v[144:147], v[16:31]
  v_mfma_f32_32x32x16_bf16 v[80:95], v[208:211], v[144:147], v[24:39]
  s_nop 10
  v_max3_f32 v8, v64, v65, v66
  v_max3_f32 v8, v8, v67, v68
  v_max3_f32 v8, v8, v69, v70
  v_max3_f32 v8, v8, v71, v72
  v_max3_f32 v8, v8, v73, v74
  v_max3_f32 v8, v8, v75, v76
  v_max3_f32 v8, v8, v77, v78
  v_max3_f32 v8, v8, v79, v88
  v_max3_f32 v8, v8, v89, v90
  v_max3_f32 v8, v8, v91, v92
  v_max3_f32 v8, v8, v93, v94
  v_max_f32 v8, v8, v95
  v_mov_b32 v9, v8
  s_nop 1
  v_permlane32_swap_b32 v8, v9
  v_max_f32 v8, v8, v9
  v_mul_f32 v8, s58, v8
  v_fma_f32 v64, v64, s58, -v8
  v_fma_f32 v65, v65, s58, -v8
  v_fma_f32 v66, v66, s58, -v8
  v_fma_f32 v67, v67, s58, -v8
  v_fma_f32 v68, v68, s58, -v8
  v_fma_f32 v69, v69, s58, -v8
  v_fma_f32 v70, v70, s58, -v8
  v_fma_f32 v71, v71, s58, -v8
  v_fma_f32 v72, v72, s58, -v8
  v_fma_f32 v73, v73, s58, -v8
  v_fma_f32 v74, v74, s58, -v8
  v_fma_f32 v75, v75, s58, -v8
  v_fma_f32 v76, v76, s58, -v8
  v_fma_f32 v77, v77, s58, -v8
  v_fma_f32 v78, v78, s58, -v8
  v_fma_f32 v79, v79, s58, -v8
  v_fma_f32 v88, v88, s58, -v8
  v_fma_f32 v89, v89, s58, -v8
  v_fma_f32 v90, v90, s58, -v8
  v_fma_f32 v91, v91, s58, -v8
  v_fma_f32 v92, v92, s58, -v8
  v_fma_f32 v93, v93, s58, -v8
  v_fma_f32 v94, v94, s58, -v8
  v_fma_f32 v95, v95, s58, -v8
  v_exp_f32 v64, v64
  v_exp_f32 v65, v65
  v_exp_f32 v66, v66
  v_exp_f32 v67, v67
  v_exp_f32 v68, v68
  v_exp_f32 v69, v69
  v_exp_f32 v70, v70
  v_exp_f32 v71, v71
  v_exp_f32 v72, v72
  v_exp_f32 v73, v73
  v_exp_f32 v74, v74
  v_exp_f32 v75, v75
  v_exp_f32 v76, v76
  v_exp_f32 v77, v77
  v_exp_f32 v78, v78
  v_exp_f32 v79, v79
  v_exp_f32 v88, v88
  v_exp_f32 v89, v89
  v_exp_f32 v90, v90
  v_exp_f32 v91, v91
  v_exp_f32 v92, v92
  v_exp_f32 v93, v93
  v_exp_f32 v94, v94
  v_exp_f32 v95, v95
  v_add_f32 v8, v64, v65
  v_add_f32 v9, v66, v67
  v_add_f32 v8, v8, v68
  v_add_f32 v9, v9, v69
  v_add_f32 v8, v8, v70
  v_add_f32 v9, v9, v71
  v_add_f32 v8, v8, v72
  v_add_f32 v9, v9, v73
  v_add_f32 v8, v8, v74
  v_add_f32 v9, v9, v75
  v_add_f32 v8, v8, v76
  v_add_f32 v9, v9, v77
  v_add_f32 v8, v8, v78
  v_add_f32 v9, v9, v79
  v_add_f32 v8, v8, v88
  v_add_f32 v9, v9, v89
  v_add_f32 v8, v8, v90
  v_add_f32 v9, v9, v91
  v_add_f32 v8, v8, v92
  v_add_f32 v9, v9, v93
  v_add_f32 v8, v8, v94
  v_add_f32 v9, v9, v95
  v_add_f32 v8, v8, v9
  v_mov_b32 v9, v8
  s_nop 1
  v_permlane32_swap_b32 v8, v9
  v_add_f32 v8, v8, v9
  v_rcp_f32 v8, v8
  v_cvt_pk_bf16_f32 v112, v64, v65
  v_cvt_pk_bf16_f32 v113, v66, v67
  v_cvt_pk_bf16_f32 v114, v68, v69
  v_cvt_pk_bf16_f32 v115, v70, v71
  v_cvt_pk_bf16_f32 v116, v72, v73
  v_cvt_pk_bf16_f32 v117, v74, v75
  v_cvt_pk_bf16_f32 v118, v76, v77
  v_cvt_pk_bf16_f32 v119, v78, v79
  v_cvt_pk_bf16_f32 v120, v88, v89
  v_cvt_pk_bf16_f32 v121, v90, v91
  v_cvt_pk_bf16_f32 v122, v92, v93
  v_cvt_pk_bf16_f32 v123, v94, v95
  v_mfma_f32_32x32x16_bf16 v[96:111], v[240:243], v[112:115], 0
  v_mfma_f32_32x32x16_bf16 v[96:111], v[244:247], v[116:119], v[96:111]
  s_waitcnt vmcnt(1)
  v_mfma_f32_32x32x16_bf16 v[96:111], v[56:59], v[120:123], v[96:111]
  s_nop 11
  v_mul_f32 v96, v96, v8
  v_mul_f32 v97, v97, v8
  v_mul_f32 v98, v98, v8
  v_mul_f32 v99, v99, v8
  v_mul_f32 v100, v100, v8
  v_mul_f32 v101, v101, v8
  v_mul_f32 v102, v102, v8
  v_mul_f32 v103, v103, v8
  v_cvt_pk_bf16_f32 v124, v96, v97
  v_cvt_pk_bf16_f32 v125, v98, v99
  v_cvt_pk_bf16_f32 v126, v100, v101
  v_cvt_pk_bf16_f32 v127, v102, v103
  ds_write_b128 v11, v[124:127] offset:4096
  v_mfma_f32_32x32x16_bf16 v[64:79], v[180:183], v[148:151], v[16:31]
  v_mfma_f32_32x32x16_bf16 v[80:95], v[212:215], v[148:151], v[24:39]
  s_nop 10
  v_max3_f32 v8, v64, v65, v66
  v_max3_f32 v8, v8, v67, v68
  v_max3_f32 v8, v8, v69, v70
  v_max3_f32 v8, v8, v71, v72
  v_max3_f32 v8, v8, v73, v74
  v_max3_f32 v8, v8, v75, v76
  v_max3_f32 v8, v8, v77, v78
  v_max3_f32 v8, v8, v79, v88
  v_max3_f32 v8, v8, v89, v90
  v_max3_f32 v8, v8, v91, v92
  v_max3_f32 v8, v8, v93, v94
  v_max_f32 v8, v8, v95
  v_mov_b32 v9, v8
  s_nop 1
  v_permlane32_swap_b32 v8, v9
  v_max_f32 v8, v8, v9
  v_mul_f32 v8, s58, v8
  v_fma_f32 v64, v64, s58, -v8
  v_fma_f32 v65, v65, s58, -v8
  v_fma_f32 v66, v66, s58, -v8
  v_fma_f32 v67, v67, s58, -v8
  v_fma_f32 v68, v68, s58, -v8
  v_fma_f32 v69, v69, s58, -v8
  v_fma_f32 v70, v70, s58, -v8
  v_fma_f32 v71, v71, s58, -v8
  v_fma_f32 v72, v72, s58, -v8
  v_fma_f32 v73, v73, s58, -v8
  v_fma_f32 v74, v74, s58, -v8
  v_fma_f32 v75, v75, s58, -v8
  v_fma_f32 v76, v76, s58, -v8
  v_fma_f32 v77, v77, s58, -v8
  v_fma_f32 v78, v78, s58, -v8
  v_fma_f32 v79, v79, s58, -v8
  v_fma_f32 v88, v88, s58, -v8
  v_fma_f32 v89, v89, s58, -v8
  v_fma_f32 v90, v90, s58, -v8
  v_fma_f32 v91, v91, s58, -v8
  v_fma_f32 v92, v92, s58, -v8
  v_fma_f32 v93, v93, s58, -v8
  v_fma_f32 v94, v94, s58, -v8
  v_fma_f32 v95, v95, s58, -v8
  v_exp_f32 v64, v64
  v_exp_f32 v65, v65
  v_exp_f32 v66, v66
  v_exp_f32 v67, v67
  v_exp_f32 v68, v68
  v_exp_f32 v69, v69
  v_exp_f32 v70, v70
  v_exp_f32 v71, v71
  v_exp_f32 v72, v72
  v_exp_f32 v73, v73
  v_exp_f32 v74, v74
  v_exp_f32 v75, v75
  v_exp_f32 v76, v76
  v_exp_f32 v77, v77
  v_exp_f32 v78, v78
  v_exp_f32 v79, v79
  v_exp_f32 v88, v88
  v_exp_f32 v89, v89
  v_exp_f32 v90, v90
  v_exp_f32 v91, v91
  v_exp_f32 v92, v92
  v_exp_f32 v93, v93
  v_exp_f32 v94, v94
  v_exp_f32 v95, v95
  v_add_f32 v8, v64, v65
  v_add_f32 v9, v66, v67
  v_add_f32 v8, v8, v68
  v_add_f32 v9, v9, v69
  v_add_f32 v8, v8, v70
  v_add_f32 v9, v9, v71
  v_add_f32 v8, v8, v72
  v_add_f32 v9, v9, v73
  v_add_f32 v8, v8, v74
  v_add_f32 v9, v9, v75
  v_add_f32 v8, v8, v76
  v_add_f32 v9, v9, v77
  v_add_f32 v8, v8, v78
  v_add_f32 v9, v9, v79
  v_add_f32 v8, v8, v88
  v_add_f32 v9, v9, v89
  v_add_f32 v8, v8, v90
  v_add_f32 v9, v9, v91
  v_add_f32 v8, v8, v92
  v_add_f32 v9, v9, v93
  v_add_f32 v8, v8, v94
  v_add_f32 v9, v9, v95
  v_add_f32 v8, v8, v9
  v_mov_b32 v9, v8
  s_nop 1
  v_permlane32_swap_b32 v8, v9
  v_add_f32 v8, v8, v9
  v_rcp_f32 v8, v8
  v_cvt_pk_bf16_f32 v112, v64, v65
  v_cvt_pk_bf16_f32 v113, v66, v67
  v_cvt_pk_bf16_f32 v114, v68, v69
  v_cvt_pk_bf16_f32 v115, v70, v71
  v_cvt_pk_bf16_f32 v116, v72, v73
  v_cvt_pk_bf16_f32 v117, v74, v75
  v_cvt_pk_bf16_f32 v118, v76, v77
  v_cvt_pk_bf16_f32 v119, v78, v79
  v_cvt_pk_bf16_f32 v120, v88, v89
  v_cvt_pk_bf16_f32 v121, v90, v91
  v_cvt_pk_bf16_f32 v122, v92, v93
  v_cvt_pk_bf16_f32 v123, v94, v95
  v_mfma_f32_32x32x16_bf16 v[96:111], v[240:243], v[112:115], 0
  v_mfma_f32_32x32x16_bf16 v[96:111], v[244:247], v[116:119], v[96:111]
  v_mfma_f32_32x32x16_bf16 v[96:111], v[56:59], v[120:123], v[96:111]
  s_nop 11
  v_mul_f32 v104, v104, v8
  v_mul_f32 v105, v105, v8
  v_mul_f32 v106, v106, v8
  v_mul_f32 v107, v107, v8
  v_mul_f32 v108, v108, v8
  v_mul_f32 v109, v109, v8
  v_mul_f32 v110, v110, v8
  v_mul_f32 v111, v111, v8
  v_cvt_pk_bf16_f32 v124, v104, v105
  v_cvt_pk_bf16_f32 v125, v106, v107
  v_cvt_pk_bf16_f32 v126, v108, v109
  v_cvt_pk_bf16_f32 v127, v110, v111
  ds_write_b128 v11, v[124:127] offset:5120
  v_mfma_f32_32x32x16_bf16 v[64:79], v[184:187], v[152:155], v[16:31]
  v_mfma_f32_32x32x16_bf16 v[80:95], v[216:219], v[152:155], v[24:39]
  s_nop 10
  v_max3_f32 v8, v64, v65, v66
  v_max3_f32 v8, v8, v67, v68
  v_max3_f32 v8, v8, v69, v70
  v_max3_f32 v8, v8, v71, v72
  v_max3_f32 v8, v8, v73, v74
  v_max3_f32 v8, v8, v75, v76
  v_max3_f32 v8, v8, v77, v78
  v_max3_f32 v8, v8, v79, v88
  v_max3_f32 v8, v8, v89, v90
  v_max3_f32 v8, v8, v91, v92
  v_max3_f32 v8, v8, v93, v94
  v_max_f32 v8, v8, v95
  v_mov_b32 v9, v8
  s_nop 1
  v_permlane32_swap_b32 v8, v9
  v_max_f32 v8, v8, v9
  v_mul_f32 v8, s58, v8
  v_fma_f32 v64, v64, s58, -v8
  v_fma_f32 v65, v65, s58, -v8
  v_fma_f32 v66, v66, s58, -v8
  v_fma_f32 v67, v67, s58, -v8
  v_fma_f32 v68, v68, s58, -v8
  v_fma_f32 v69, v69, s58, -v8
  v_fma_f32 v70, v70, s58, -v8
  v_fma_f32 v71, v71, s58, -v8
  v_fma_f32 v72, v72, s58, -v8
  v_fma_f32 v73, v73, s58, -v8
  v_fma_f32 v74, v74, s58, -v8
  v_fma_f32 v75, v75, s58, -v8
  v_fma_f32 v76, v76, s58, -v8
  v_fma_f32 v77, v77, s58, -v8
  v_fma_f32 v78, v78, s58, -v8
  v_fma_f32 v79, v79, s58, -v8
  v_fma_f32 v88, v88, s58, -v8
  v_fma_f32 v89, v89, s58, -v8
  v_fma_f32 v90, v90, s58, -v8
  v_fma_f32 v91, v91, s58, -v8
  v_fma_f32 v92, v92, s58, -v8
  v_fma_f32 v93, v93, s58, -v8
  v_fma_f32 v94, v94, s58, -v8
  v_fma_f32 v95, v95, s58, -v8
  v_exp_f32 v64, v64
  v_exp_f32 v65, v65
  v_exp_f32 v66, v66
  v_exp_f32 v67, v67
  v_exp_f32 v68, v68
  v_exp_f32 v69, v69
  v_exp_f32 v70, v70
  v_exp_f32 v71, v71
  v_exp_f32 v72, v72
  v_exp_f32 v73, v73
  v_exp_f32 v74, v74
  v_exp_f32 v75, v75
  v_exp_f32 v76, v76
  v_exp_f32 v77, v77
  v_exp_f32 v78, v78
  v_exp_f32 v79, v79
  v_exp_f32 v88, v88
  v_exp_f32 v89, v89
  v_exp_f32 v90, v90
  v_exp_f32 v91, v91
  v_exp_f32 v92, v92
  v_exp_f32 v93, v93
  v_exp_f32 v94, v94
  v_exp_f32 v95, v95
  v_add_f32 v8, v64, v65
  v_add_f32 v9, v66, v67
  v_add_f32 v8, v8, v68
  v_add_f32 v9, v9, v69
  v_add_f32 v8, v8, v70
  v_add_f32 v9, v9, v71
  v_add_f32 v8, v8, v72
  v_add_f32 v9, v9, v73
  v_add_f32 v8, v8, v74
  v_add_f32 v9, v9, v75
  v_add_f32 v8, v8, v76
  v_add_f32 v9, v9, v77
  v_add_f32 v8, v8, v78
  v_add_f32 v9, v9, v79
  v_add_f32 v8, v8, v88
  v_add_f32 v9, v9, v89
  v_add_f32 v8, v8, v90
  v_add_f32 v9, v9, v91
  v_add_f32 v8, v8, v92
  v_add_f32 v9, v9, v93
  v_add_f32 v8, v8, v94
  v_add_f32 v9, v9, v95
  v_add_f32 v8, v8, v9
  v_mov_b32 v9, v8
  s_nop 1
  v_permlane32_swap_b32 v8, v9
  v_add_f32 v8, v8, v9
  v_rcp_f32 v8, v8
  v_cvt_pk_bf16_f32 v112, v64, v65
  v_cvt_pk_bf16_f32 v113, v66, v67
  v_cvt_pk_bf16_f32 v114, v68, v69
  v_cvt_pk_bf16_f32 v115, v70, v71
  v_cvt_pk_bf16_f32 v116, v72, v73
  v_cvt_pk_bf16_f32 v117, v74, v75
  v_cvt_pk_bf16_f32 v118, v76, v77
  v_cvt_pk_bf16_f32 v119, v78, v79
  v_cvt_pk_bf16_f32 v120, v88, v89
  v_cvt_pk_bf16_f32 v121, v90, v91
  v_cvt_pk_bf16_f32 v122, v92, v93
  v_cvt_pk_bf16_f32 v123, v94, v95
  v_mfma_f32_32x32x16_bf16 v[96:111], v[248:251], v[112:115], 0
  v_mfma_f32_32x32x16_bf16 v[96:111], v[252:255], v[116:119], v[96:111]
  s_waitcnt vmcnt(0)
  v_mfma_f32_32x32x16_bf16 v[96:111], v[60:63], v[120:123], v[96:111]
  s_nop 11
  v_mul_f32 v96, v96, v8
  v_mul_f32 v97, v97, v8
  v_mul_f32 v98, v98, v8
  v_mul_f32 v99, v99, v8
  v_mul_f32 v100, v100, v8
  v_mul_f32 v101, v101, v8
  v_mul_f32 v102, v102, v8
  v_mul_f32 v103, v103, v8
  v_cvt_pk_bf16_f32 v124, v96, v97
  v_cvt_pk_bf16_f32 v125, v98, v99
  v_cvt_pk_bf16_f32 v126, v100, v101
  v_cvt_pk_bf16_f32 v127, v102, v103
  ds_write_b128 v11, v[124:127] offset:6144
  v_mfma_f32_32x32x16_bf16 v[64:79], v[188:191], v[156:159], v[16:31]
  v_mfma_f32_32x32x16_bf16 v[80:95], v[220:223], v[156:159], v[24:39]
  s_nop 10
  v_max3_f32 v8, v64, v65, v66
  v_max3_f32 v8, v8, v67, v68
  v_max3_f32 v8, v8, v69, v70
  v_max3_f32 v8, v8, v71, v72
  v_max3_f32 v8, v8, v73, v74
  v_max3_f32 v8, v8, v75, v76
  v_max3_f32 v8, v8, v77, v78
  v_max3_f32 v8, v8, v79, v88
  v_max3_f32 v8, v8, v89, v90
  v_max3_f32 v8, v8, v91, v92
  v_max3_f32 v8, v8, v93, v94
  v_max_f32 v8, v8, v95
  v_mov_b32 v9, v8
  s_nop 1
  v_permlane32_swap_b32 v8, v9
  v_max_f32 v8, v8, v9
  v_mul_f32 v8, s58, v8
  v_fma_f32 v64, v64, s58, -v8
  v_fma_f32 v65, v65, s58, -v8
  v_fma_f32 v66, v66, s58, -v8
  v_fma_f32 v67, v67, s58, -v8
  v_fma_f32 v68, v68, s58, -v8
  v_fma_f32 v69, v69, s58, -v8
  v_fma_f32 v70, v70, s58, -v8
  v_fma_f32 v71, v71, s58, -v8
  v_fma_f32 v72, v72, s58, -v8
  v_fma_f32 v73, v73, s58, -v8
  v_fma_f32 v74, v74, s58, -v8
  v_fma_f32 v75, v75, s58, -v8
  v_fma_f32 v76, v76, s58, -v8
  v_fma_f32 v77, v77, s58, -v8
  v_fma_f32 v78, v78, s58, -v8
  v_fma_f32 v79, v79, s58, -v8
  v_fma_f32 v88, v88, s58, -v8
  v_fma_f32 v89, v89, s58, -v8
  v_fma_f32 v90, v90, s58, -v8
  v_fma_f32 v91, v91, s58, -v8
  v_fma_f32 v92, v92, s58, -v8
  v_fma_f32 v93, v93, s58, -v8
  v_fma_f32 v94, v94, s58, -v8
  v_fma_f32 v95, v95, s58, -v8
  v_exp_f32 v64, v64
  v_exp_f32 v65, v65
  v_exp_f32 v66, v66
  v_exp_f32 v67, v67
  v_exp_f32 v68, v68
  v_exp_f32 v69, v69
  v_exp_f32 v70, v70
  v_exp_f32 v71, v71
  v_exp_f32 v72, v72
  v_exp_f32 v73, v73
  v_exp_f32 v74, v74
  v_exp_f32 v75, v75
  v_exp_f32 v76, v76
  v_exp_f32 v77, v77
  v_exp_f32 v78, v78
  v_exp_f32 v79, v79
  v_exp_f32 v88, v88
  v_exp_f32 v89, v89
  v_exp_f32 v90, v90
  v_exp_f32 v91, v91
  v_exp_f32 v92, v92
  v_exp_f32 v93, v93
  v_exp_f32 v94, v94
  v_exp_f32 v95, v95
  v_add_f32 v8, v64, v65
  v_add_f32 v9, v66, v67
  v_add_f32 v8, v8, v68
  v_add_f32 v9, v9, v69
  v_add_f32 v8, v8, v70
  v_add_f32 v9, v9, v71
  v_add_f32 v8, v8, v72
  v_add_f32 v9, v9, v73
  v_add_f32 v8, v8, v74
  v_add_f32 v9, v9, v75
  v_add_f32 v8, v8, v76
  v_add_f32 v9, v9, v77
  v_add_f32 v8, v8, v78
  v_add_f32 v9, v9, v79
  v_add_f32 v8, v8, v88
  v_add_f32 v9, v9, v89
  v_add_f32 v8, v8, v90
  v_add_f32 v9, v9, v91
  v_add_f32 v8, v8, v92
  v_add_f32 v9, v9, v93
  v_add_f32 v8, v8, v94
  v_add_f32 v9, v9, v95
  v_add_f32 v8, v8, v9
  v_mov_b32 v9, v8
  s_nop 1
  v_permlane32_swap_b32 v8, v9
  v_add_f32 v8, v8, v9
  v_rcp_f32 v8, v8
  v_cvt_pk_bf16_f32 v112, v64, v65
  v_cvt_pk_bf16_f32 v113, v66, v67
  v_cvt_pk_bf16_f32 v114, v68, v69
  v_cvt_pk_bf16_f32 v115, v70, v71
  v_cvt_pk_bf16_f32 v116, v72, v73
  v_cvt_pk_bf16_f32 v117, v74, v75
  v_cvt_pk_bf16_f32 v118, v76, v77
  v_cvt_pk_bf16_f32 v119, v78, v79
  v_cvt_pk_bf16_f32 v120, v88, v89
  v_cvt_pk_bf16_f32 v121, v90, v91
  v_cvt_pk_bf16_f32 v122, v92, v93
  v_cvt_pk_bf16_f32 v123, v94, v95
  v_mfma_f32_32x32x16_bf16 v[96:111], v[248:251], v[112:115], 0
  v_mfma_f32_32x32x16_bf16 v[96:111], v[252:255], v[116:119], v[96:111]
  v_mfma_f32_32x32x16_bf16 v[96:111], v[60:63], v[120:123], v[96:111]
  s_nop 11
  v_mul_f32 v104, v104, v8
  v_mul_f32 v105, v105, v8
  v_mul_f32 v106, v106, v8
  v_mul_f32 v107, v107, v8
  v_mul_f32 v108, v108, v8
  v_mul_f32 v109, v109, v8
  v_mul_f32 v110, v110, v8
  v_mul_f32 v111, v111, v8
  v_cvt_pk_bf16_f32 v124, v104, v105
  v_cvt_pk_bf16_f32 v125, v106, v107
  v_cvt_pk_bf16_f32 v126, v108, v109
  v_cvt_pk_bf16_f32 v127, v110, v111
  ds_write_b128 v11, v[124:127] offset:7168
  s_waitcnt lgkmcnt(0)
  s_barrier
  ds_read_b128 v[128:131], v3 offset:0
  ds_read_b128 v[132:135], v3 offset:1024
  ds_read_b128 v[136:139], v3 offset:2048
  ds_read_b128 v[140:143], v3 offset:3072
  ds_read_b128 v[144:147], v3 offset:4096
  ds_read_b128 v[148:151], v3 offset:5120
  ds_read_b128 v[152:155], v3 offset:6144
  ds_read_b128 v[156:159], v3 offset:7168
  ds_read_b128 v[160:163], v3 offset:8192
  s_waitcnt lgkmcnt(8)
  v_mfma_f32_32x32x16_bf16 v[64:79], a[0:3], v[128:131], 0
  v_mfma_f32_32x32x16_bf16 v[80:95], a[4:7], v[128:131], 0
  ds_read_b128 v[164:167], v3 offset:9216
  s_waitcnt lgkmcnt(8)
  v_mfma_f32_32x32x16_bf16 v[64:79], a[8:11], v[132:135], v[64:79]
  v_mfma_f32_32x32x16_bf16 v[80:95], a[12:15], v[132:135], v[80:95]
  ds_read_b128 v[168:171], v3 offset:10240
  s_waitcnt lgkmcnt(8)
  v_mfma_f32_32x32x16_bf16 v[64:79], a[16:19], v[136:139], v[64:79]
  v_mfma_f32_32x32x16_bf16 v[80:95], a[20:23], v[136:139], v[80:95]
  ds_read_b128 v[172:175], v3 offset:11264
  s_waitcnt lgkmcnt(8)
  v_mfma_f32_32x32x16_bf16 v[64:79], a[24:27], v[140:143], v[64:79]
  v_mfma_f32_32x32x16_bf16 v[80:95], a[28:31], v[140:143], v[80:95]
  ds_read_b128 v[176:179], v3 offset:12288
  s_waitcnt lgkmcnt(8)
  v_mfma_f32_32x32x16_bf16 v[64:79], a[32:35], v[144:147], v[64:79]
  v_mfma_f32_32x32x16_bf16 v[80:95], a[36:39], v[144:147], v[80:95]
  ds_read_b128 v[180:183], v3 offset:13312
  s_waitcnt lgkmcnt(8)
  v_mfma_f32_32x32x16_bf16 v[64:79], a[40:43], v[148:151], v[64:79]
  v_mfma_f32_32x32x16_bf16 v[80:95], a[44:47], v[148:151], v[80:95]
  ds_read_b128 v[184:187], v3 offset:14336
  s_waitcnt lgkmcnt(8)
  v_mfma_f32_32x32x16_bf16 v[64:79], a[48:51], v[152:155], v[64:79]
  v_mfma_f32_32x32x16_bf16 v[80:95], a[52:55], v[152:155], v[80:95]
  ds_read_b128 v[188:191], v3 offset:15360
  s_waitcnt lgkmcnt(8)
  v_mfma_f32_32x32x16_bf16 v[64:79], a[56:59], v[156:159], v[64:79]
  v_mfma_f32_32x32x16_bf16 v[80:95], a[60:63], v[156:159], v[80:95]
  ds_read_b128 v[192:195], v3 offset:16384
  s_waitcnt lgkmcnt(8)
  v_mfma_f32_32x32x16_bf16 v[64:79], a[64:67], v[160:163], v[64:79]
  v_mfma_f32_32x32x16_bf16 v[80:95], a[68:71], v[160:163], v[80:95]
  ds_read_b128 v[196:199], v3 offset:17408
  s_waitcnt lgkmcnt(8)
  v_mfma_f32_32x32x16_bf16 v[64:79], a[72:75], v[164:167], v[64:79]
  v_mfma_f32_32x32x16_bf16 v[80:95], a[76:79], v[164:167], v[80:95]
  ds_read_b128 v[200:203], v3 offset:18432
  s_waitcnt lgkmcnt(8)
  v_mfma_f32_32x32x16_bf16 v[64:79], a[80:83], v[168:171], v[64:79]
  v_mfma_f32_32x32x16_bf16 v[80:95], a[84:87], v[168:171], v[80:95]
  ds_read_b128 v[204:207], v3 offset:19456
  s_waitcnt lgkmcnt(8)
  v_mfma_f32_32x32x16_bf16 v[64:79], a[88:91], v[172:175], v[64:79]
  v_mfma_f32_32x32x16_bf16 v[80:95], a[92:95], v[172:175], v[80:95]
  ds_read_b128 v[208:211], v3 offset:20480
  s_waitcnt lgkmcnt(8)
  v_mfma_f32_32x32x16_bf16 v[64:79], a[96:99], v[176:179], v[64:79]
  v_mfma_f32_32x32x16_bf16 v[80:95], a[100:103], v[176:179], v[80:95]
  ds_read_b128 v[212:215], v3 offset:21504
  s_waitcnt lgkmcnt(8)
  v_mfma_f32_32x32x16_bf16 v[64:79], a[104:107], v[180:183], v[64:79]
  v_mfma_f32_32x32x16_bf16 v[80:95], a[108:111], v[180:183], v[80:95]
  ds_read_b128 v[216:219], v3 offset:22528
  s_waitcnt lgkmcnt(8)
  v_mfma_f32_32x32x16_bf16 v[64:79], a[112:115], v[184:187], v[64:79]
  v_mfma_f32_32x32x16_bf16 v[80:95], a[116:119], v[184:187], v[80:95]
  ds_read_b128 v[220:223], v3 offset:23552
  s_waitcnt lgkmcnt(8)
  v_mfma_f32_32x32x16_bf16 v[64:79], a[120:123], v[188:191], v[64:79]
  v_mfma_f32_32x32x16_bf16 v[80:95], a[124:127], v[188:191], v[80:95]
  ds_read_b128 v[224:227], v3 offset:24576
  s_waitcnt lgkmcnt(8)
  v_mfma_f32_32x32x16_bf16 v[64:79], a[128:131], v[192:195], v[64:79]
  v_mfma_f32_32x32x16_bf16 v[80:95], a[132:135], v[192:195], v[80:95]
  ds_read_b128 v[228:231], v3 offset:25600
  s_waitcnt lgkmcnt(8)
  v_mfma_f32_32x32x16_bf16 v[64:79], a[136:139], v[196:199], v[64:79]
  v_mfma_f32_32x32x16_bf16 v[80:95], a[140:143], v[196:199], v[80:95]
  ds_read_b128 v[232:235], v3 offset:26624
  s_waitcnt lgkmcnt(8)
  v_mfma_f32_32x32x16_bf16 v[64:79], a[144:147], v[200:203], v[64:79]
  v_mfma_f32_32x32x16_bf16 v[80:95], a[148:151], v[200:203], v[80:95]
  ds_read_b128 v[236:239], v3 offset:27648
  s_waitcnt lgkmcnt(8)
  v_mfma_f32_32x32x16_bf16 v[64:79], a[152:155], v[204:207], v[64:79]
  v_mfma_f32_32x32x16_bf16 v[80:95], a[156:159], v[204:207], v[80:95]
  ds_read_b128 v[240:243], v3 offset:28672
  s_waitcnt lgkmcnt(8)
  v_mfma_f32_32x32x16_bf16 v[64:79], a[160:163], v[208:211], v[64:79]
  v_mfma_f32_32x32x16_bf16 v[80:95], a[164:167], v[208:211], v[80:95]
  ds_read_b128 v[244:247], v3 offset:29696
  s_waitcnt lgkmcnt(8)
  v_mfma_f32_32x32x16_bf16 v[64:79], a[168:171], v[212:215], v[64:79]
  v_mfma_f32_32x32x16_bf16 v[80:95], a[172:175], v[212:215], v[80:95]
  ds_read_b128 v[248:251], v3 offset:30720
  s_waitcnt lgkmcnt(8)
  v_mfma_f32_32x32x16_bf16 v[64:79], a[176:179], v[216:219], v[64:79]
  v_mfma_f32_32x32x16_bf16 v[80:95], a[180:183], v[216:219], v[80:95]
  ds_read_b128 v[252:255], v3 offset:31744
  s_waitcnt lgkmcnt(8)
  v_mfma_f32_32x32x16_bf16 v[64:79], a[184:187], v[220:223], v[64:79]
  v_mfma_f32_32x32x16_bf16 v[80:95], a[188:191], v[220:223], v[80:95]
  s_waitcnt lgkmcnt(7)
  v_mfma_f32_32x32x16_bf16 v[64:79], a[192:195], v[224:227], v[64:79]
  v_mfma_f32_32x32x16_bf16 v[80:95], a[196:199], v[224:227], v[80:95]
  s_waitcnt lgkmcnt(6)
  v_mfma_f32_32x32x16_bf16 v[64:79], a[200:203], v[228:231], v[64:79]
  v_mfma_f32_32x32x16_bf16 v[80:95], a[204:207], v[228:231], v[80:95]
  s_waitcnt lgkmcnt(5)
  v_mfma_f32_32x32x16_bf16 v[64:79], a[208:211], v[232:235], v[64:79]
  v_mfma_f32_32x32x16_bf16 v[80:95], a[212:215], v[232:235], v[80:95]
  s_waitcnt lgkmcnt(4)
  v_mfma_f32_32x32x16_bf16 v[64:79], a[216:219], v[236:239], v[64:79]
  v_mfma_f32_32x32x16_bf16 v[80:95], a[220:223], v[236:239], v[80:95]
  s_waitcnt lgkmcnt(3)
  v_mfma_f32_32x32x16_bf16 v[64:79], a[224:227], v[240:243], v[64:79]
  v_mfma_f32_32x32x16_bf16 v[80:95], a[228:231], v[240:243], v[80:95]
  s_waitcnt lgkmcnt(2)
  v_mfma_f32_32x32x16_bf16 v[64:79], a[232:235], v[244:247], v[64:79]
  v_mfma_f32_32x32x16_bf16 v[80:95], a[236:239], v[244:247], v[80:95]
  s_waitcnt lgkmcnt(1)
  v_mfma_f32_32x32x16_bf16 v[64:79], a[240:243], v[248:251], v[64:79]
  v_mfma_f32_32x32x16_bf16 v[80:95], a[244:247], v[248:251], v[80:95]
  s_waitcnt lgkmcnt(0)
  v_mfma_f32_32x32x16_bf16 v[64:79], a[248:251], v[252:255], v[64:79]
  v_mfma_f32_32x32x16_bf16 v[80:95], a[252:255], v[252:255], v[80:95]
  s_lshl_b32 s51, s53, 16
  s_lshl_b32 s52, s54, 9
  s_add_u32 s51, s51, s52
  s_lshl_b32 s52, s46, 7
  s_add_u32 s51, s51, s52
  s_nop 5
  v_cvt_pk_bf16_f32 v96, v64, v65
  v_cvt_pk_bf16_f32 v97, v66, v67
  buffer_store_dwordx2 v[96:97], v10, s[68:71], s51 offen offset:0
  v_cvt_pk_bf16_f32 v98, v68, v69
  v_cvt_pk_bf16_f32 v99, v70, v71
  buffer_store_dwordx2 v[98:99], v10, s[68:71], s51 offen offset:16
  v_cvt_pk_bf16_f32 v100, v72, v73
  v_cvt_pk_bf16_f32 v101, v74, v75
  buffer_store_dwordx2 v[100:101], v10, s[68:71], s51 offen offset:32
  v_cvt_pk_bf16_f32 v102, v76, v77
  v_cvt_pk_bf16_f32 v103, v78, v79
  buffer_store_dwordx2 v[102:103], v10, s[68:71], s51 offen offset:48
  v_cvt_pk_bf16_f32 v104, v80, v81
  v_cvt_pk_bf16_f32 v105, v82, v83
  buffer_store_dwordx2 v[104:105], v10, s[68:71], s51 offen offset:64
  v_cvt_pk_bf16_f32 v106, v84, v85
  v_cvt_pk_bf16_f32 v107, v86, v87
  buffer_store_dwordx2 v[106:107], v10, s[68:71], s51 offen offset:80
  v_cvt_pk_bf16_f32 v108, v88, v89
  v_cvt_pk_bf16_f32 v109, v90, v91
  buffer_store_dwordx2 v[108:109], v10, s[68:71], s51 offen offset:96
  v_cvt_pk_bf16_f32 v110, v92, v93
  v_cvt_pk_bf16_f32 v111, v94, v95
  buffer_store_dwordx2 v[110:111], v10, s[68:71], s51 offen offset:112
  s_add_u32 s53, s53, 16
  s_cmp_lt_u32 s53, 64
  s_cbranch_scc1 L_pa_loop
  s_branch L_end
L_reclaim:
  s_mov_b32 s0, s48
  s_movk_i32 s49, 600
L_rc_word:
  v_readfirstlane_b32 s1, v127
  s_nop 0
  s_cmp_eq_u32 s1, -1
  s_cbranch_scc0 L_rc_try
  s_add_u32 s0, s0, 1
  s_and_b32 s0, s0, 7
  s_mov_b32 s1, 0
L_rc_try:
  s_sub_u32 s49, s49, 1
  s_cselect_b32 s0, 64, s0
  s_cbranch_scc1 L_rc_got
  s_mov_b32 s38, s1
  s_mov_b32 s39, s1
  s_and_b32 s1, s47, 31
  s_add_u32 s1, s1, s2
  s_and_b32 s1, s1, 31
  s_lshr_b64 s[38:39], s[38:39], s1
  s_ff0_i32_b32 s38, s38
  s_add_u32 s1, s1, s38
  s_and_b32 s1, s1, 31
  s_lshl_b32 s39, 1, s1
  v_mov_b32 v127, s39
  s_lshl_b32 s39, s0, 2
  s_mov_b64 exec, 1
  buffer_atomic_or v127, off, s[8:11], s39 sc0
  s_mov_b64 exec, -1
  s_waitcnt vmcnt(0)
  v_readfirstlane_b32 s39, v127
  s_nop 0
  s_bitcmp1_b32 s39, s1
  s_cbranch_scc1 L_rc_word
L_rc_got:
  s_lshl_b32 s0, s0, 5
  s_or_b32 s0, s0, s1
  v_mov_b32 v127, s0
  v_mov_b32 v126, 33408
  ds_write_b32 v126, v127
  s_waitcnt lgkmcnt(0)
  s_barrier
L_restart:
  s_cmp_ge_u32 s0, 256
  s_cbranch_scc1 L_end
  s_mov_b32 s49, 400000
  s_and_b32 s47, s0, 255
  s_mov_b32 s101, 1
  v_mbcnt_lo_u32_b32 v0, -1, 0
  v_mbcnt_hi_u32_b32 v0, -1, v0
  s_waitcnt vmcnt(0) lgkmcnt(0)
  s_barrier
  s_branch L_dispatch
L_end:
  s_endpgm
.section .rodata,"a"
.p2align 6
.amdhsa_kernel concat_heads__sliding_local_dilated__memory_aug_recurrent_mem_tr__prompt_kernel
  .amdhsa_next_free_vgpr 512
  .amdhsa_next_free_sgpr 102
  .amdhsa_accum_offset 256
  .amdhsa_group_segment_fixed_size 0
  .amdhsa_kernarg_size 104
  .amdhsa_user_sgpr_count 2
  .amdhsa_user_sgpr_kernarg_segment_ptr 1
  .amdhsa_system_sgpr_workgroup_id_x 1
.end_amdhsa_kernel
```
